```python
import torch

def _softmax(x, axis=-1):
    return torch.softmax(x, dim=axis)

def _gelu(x):
    return torch.nn.functional.gelu(x, approximate='tanh')

def _silu(x):
    return torch.nn.functional.silu(x)

def _sigmoid(x):
    return torch.sigmoid(x)

def _layernorm(x, axis=-1, eps=1e-05):
    m = x.mean(dim=axis, keepdim=True)
    v = x.var(dim=axis, keepdim=True, unbiased=False)
    return (x - m) / torch.sqrt(v + eps)

def _scatter_add(tgt, idx, src, axis=0):
    return tgt.clone().index_add_(axis, idx, src)

def _segment_sum(src, seg, n):
    out = torch.zeros((n,) + src.shape[1:], dtype=src.dtype)
    return out.index_add_(0, seg, src)

def _pad(x, pw):
    flat = tuple((v for pair in reversed(pw) for v in pair))
    return torch.nn.functional.pad(x, flat)
kernel_name = 'gated_mix__sliding_block__memory_aug_recurrent_mem_tr__prompt'

def setup_inputs():

    _w = lambda a: (lambda t: t.to(torch.bfloat16) if t.is_floating_point() else t)(torch.as_tensor(a))

    def _A_setup():
        B, S, D = (1, 2048, 448)
        return {'x': _w((lambda *s: torch.randn(*s, dtype=torch.bfloat16) * 0.05)(B, S, D)), 'wqkv': _w((lambda *s: torch.randn(*s, dtype=torch.bfloat16) * 1.6)(D, 3 * D)), 'wo': _w((lambda *s: torch.randn(*s, dtype=torch.bfloat16) * 0.05)(D, D))}
    _A_in = _A_setup()

    def _B_setup():
        B, S, Dm = (1, 2048, 448)
        H, Dh = (16, 256)
        M, seg = (8, 32)
        seg = min(seg, S)
        S = S // seg * seg
        return {'x': _w((lambda *s: torch.randn(*s, dtype=torch.bfloat16) * 0.05)(B, S, Dm)), 'mem0': _w((lambda *s: torch.randn(*s, dtype=torch.bfloat16) * 1.6)(B, M, Dm)), 'Wq': _w((lambda *s: torch.randn(*s, dtype=torch.bfloat16) * 0.8)(Dm, H, Dh) * Dm ** (-0.5)), 'Wk': _w((lambda *s: torch.randn(*s, dtype=torch.bfloat16) * 0.8)(Dm, H, Dh) * Dm ** (-0.5)), 'Wv': _w((lambda *s: torch.randn(*s, dtype=torch.bfloat16) * 1.6)(Dm, H, Dh) * Dm ** (-0.5)), 'Wo': _w((lambda *s: torch.randn(*s, dtype=torch.bfloat16) * 1.6)(H, Dh, Dm) * (H * Dh) ** (-0.5)), 'seg_len': seg}
    _B_in = _B_setup()
    return {'A_x': _A_in['x'], 'A_wqkv': _A_in['wqkv'], 'A_wo': _A_in['wo'], 'B_x': _B_in['x'], 'B_mem0': _B_in['mem0'], 'B_Wq': _B_in['Wq'], 'B_Wk': _B_in['Wk'], 'B_Wv': _B_in['Wv'], 'B_Wo': _B_in['Wo'], 'B_seg_len': _B_in['seg_len'], 'gate_w': _w((lambda *s: torch.randn(*s, dtype=torch.bfloat16) * 0.05)(448) * 16.0)}

def reference(A_x, A_wqkv, A_wo, B_x, B_mem0, B_Wq, B_Wk, B_Wv, B_Wo, B_seg_len, gate_w):

    def _A_ref(x, wqkv, wo):
        B, S, D = x.shape
        H = 16
        Dh = D // H
        W = 256
        qkv = (lambda x, *d: x.permute(*d))((x @ wqkv).reshape(B, S, 3, H, Dh), 2, 0, 3, 1, 4)
        q, k, v = (qkv[0], qkv[1], qkv[2])
        scores = torch.einsum('bhqd,bhkd->bhqk', q, k) * Dh ** (-0.5)
        idx = torch.arange(S)
        mask = (idx[:, None] - idx[None, :] >= 0) & (idx[:, None] - idx[None, :] < W)
        scores = torch.where(mask[None, None], scores, -1000000000.0)
        p = _softmax(scores, axis=-1)
        o = torch.einsum('bhqk,bhkd->bhqd', p, v)
        return (lambda x, *d: x.permute(*d))(o, 0, 2, 1, 3).reshape(B, S, D) @ wo

    def _B_ref(x, mem0, Wq, Wk, Wv, Wo, seg_len):
        B, S, Dm = x.shape
        H, Dh = (Wq.shape[1], Wq.shape[2])
        M = mem0.shape[1]
        scale = Dh ** (-0.5)
        n_seg = S // seg_len
        L = M + seg_len
        idx = torch.arange(L)
        mask = (idx[:, None] < M) | (idx[:, None] >= idx[None, :])
        mem = mem0
        outs = []
        for s in range(n_seg):
            xs = x[:, s * seg_len:(s + 1) * seg_len, :].clone()
            h = torch.concatenate([mem, xs], axis=1)
            q = torch.einsum('btd,dhe->bhte', h, Wq)
            k = torch.einsum('btd,dhe->bhte', h, Wk)
            v = torch.einsum('btd,dhe->bhte', h, Wv)
            scores = torch.einsum('bhqe,bhke->bhqk', q, k) * scale
            scores = torch.where(mask[None, None], scores, -1000000000.0)
            p = _softmax(scores, axis=-1)
            o = torch.einsum('bhqk,bhke->bhqe', p, v)
            o = torch.einsum('bhte,hed->btd', o, Wo)
            mem = o[:, :M, :].clone()
            outs.append(o[:, M:, :])
        return torch.concatenate(outs, axis=1)
    x = A_x
    g = _sigmoid((x * gate_w).sum(-1, keepdims=True))
    a = _A_ref(x, A_wqkv, A_wo)
    b = _B_ref(x, B_mem0, B_Wq, B_Wk, B_Wv, B_Wo, B_seg_len)
    return g * a + (1 - g) * b
```

```asm
; @launch kernel=main_kernel grid=(256,1,1) block=(256,1,1) lds=86080
.amdgcn_target "amdgcn-amd-amdhsa--gfx950"
.text
.globl main_kernel
.p2align 8
.type main_kernel,@function
main_kernel:
  s_load_dwordx2 s[4:5], s[0:1], 0
  s_load_dwordx2 s[6:7], s[0:1], 96
  s_load_dwordx2 s[8:9], s[0:1], 104
  v_lshrrev_b32 v1, 6, v0
  v_and_b32 v2, 63, v0
  v_readfirstlane_b32 s10, v1
  s_waitcnt lgkmcnt(0)
  s_cmp_ge_u32 s2, 256
  s_nop 2
  s_cbranch_scc1 CEXIT_1
  s_memrealtime s[96:97]
  s_mov_b32 s3, s2
  s_lshl_b32 s12, s2, 2
  s_add_u32 s12, s12, s10
  s_cmp_lg_u32 s12, 1
  s_nop 1
  s_cbranch_scc1 EZ0_10
  v_lshlrev_b32 v3, 4, v2
  v_add_u32 v3, 103366656, v3
  v_mov_b32 v4, 0
  v_mov_b32 v5, 0
  v_mov_b32 v6, 0
  v_mov_b32 v7, 0
  global_store_dwordx4 v3, v[4:7], s[8:9] sc0 sc1
  global_store_dwordx4 v3, v[4:7], s[8:9] offset:1024 sc0 sc1
  v_mov_b32 v8, 128
  v_mov_b32 v9, 1
  s_waitcnt vmcnt(0)
  global_store_dword v8, v9, s[6:7] sc0 sc1
  s_nop 1
EZ0_10:
  v_and_b32 v3, 15, v2
  v_lshrrev_b32 v4, 4, v2
  v_mul_u32_u24 v5, 896, v3
  v_lshlrev_b32 v56, 4, v2
  v_add_u32 v57, 103313408, v56
  s_cmp_lg_u32 s10, 0
  s_nop 1
  s_cbranch_scc1 SP1_12
  s_lshr_b32 s12, s2, 2
  s_mul_i32 s12, s12, 28672
  s_and_b32 s14, s2, 3
  s_mul_i32 s13, s14, 224
  s_add_u32 s13, s13, s12
  v_add_u32 v5, s13, v5
  v_lshl_add_u32 v6, v4, 4, v5
  v_lshl_add_u32 v7, v4, 3, v5
  v_add_u32 v8, 14336, v6
  v_add_u32 v9, 14336, v7
  s_mul_i32 s13, s2, 7168
  s_add_u32 s13, s13, 101478400
  v_add_u32 v57, s13, v56
  global_load_dwordx4 v[64:67], v6, s[4:5] offset:0
  global_load_dwordx4 v[68:71], v6, s[4:5] offset:64
  global_load_dwordx4 v[72:75], v6, s[4:5] offset:128
  global_load_dwordx2 v[88:89], v7, s[4:5] offset:192
  global_load_dwordx4 v[76:79], v8, s[4:5] offset:0
  global_load_dwordx4 v[80:83], v8, s[4:5] offset:64
  global_load_dwordx4 v[84:87], v8, s[4:5] offset:128
  global_load_dwordx2 v[90:91], v9, s[4:5] offset:192
  s_nop 1
  s_branch SPD_14
SP1_12:
  s_cmp_lg_u32 s10, 1
  s_nop 1
  s_cbranch_scc1 SP3_13
  s_lshr_b32 s12, s2, 1
  s_mul_i32 s12, s12, 14336
  s_and_b32 s13, s2, 1
  s_mul_i32 s13, s13, 448
  s_add_u32 s12, s12, s13
  v_lshrrev_b32 v6, 1, v4
  v_lshl_add_u32 v5, v6, 5, v5
  v_and_b32 v6, 1, v4
  v_lshl_add_u32 v5, v6, 3, v5
  v_add_u32 v5, s12, v5
  s_mul_i32 s13, s2, 7168
  s_add_u32 s13, s13, 4096
  v_add_u32 v57, s13, v56
  global_load_dwordx2 v[64:65], v5, s[4:5] offset:0
  global_load_dwordx2 v[66:67], v5, s[4:5] offset:16
  global_load_dwordx2 v[68:69], v5, s[4:5] offset:64
  global_load_dwordx2 v[70:71], v5, s[4:5] offset:80
  global_load_dwordx2 v[72:73], v5, s[4:5] offset:128
  global_load_dwordx2 v[74:75], v5, s[4:5] offset:144
  global_load_dwordx2 v[76:77], v5, s[4:5] offset:192
  global_load_dwordx2 v[78:79], v5, s[4:5] offset:208
  global_load_dwordx2 v[80:81], v5, s[4:5] offset:256
  global_load_dwordx2 v[82:83], v5, s[4:5] offset:272
  global_load_dwordx2 v[84:85], v5, s[4:5] offset:320
  global_load_dwordx2 v[86:87], v5, s[4:5] offset:336
  global_load_dwordx2 v[88:89], v5, s[4:5] offset:384
  global_load_dwordx2 v[90:91], v5, s[4:5] offset:400
  s_nop 1
  s_branch SPD_14
SP3_13:
  s_load_dwordx2 s[14:15], s[0:1], 32
  s_min_u32 s12, s2, 6
  s_lshl_b32 s12, s12, 7
  v_and_b32 v6, 7, v2
  v_lshrrev_b32 v7, 3, v2
  v_mul_u32_u24 v6, 896, v6
  v_lshl_add_u32 v6, v7, 4, v6
  v_add_u32 v6, s12, v6
  s_waitcnt lgkmcnt(0)
  global_load_dwordx4 v[64:67], v6, s[14:15]
  s_nop 1
SPD_14:
  s_load_dwordx2 s[12:13], s[0:1], 40
  s_load_dwordx2 s[14:15], s[0:1], 48
  s_load_dwordx2 s[16:17], s[0:1], 56
  s_load_dwordx2 s[18:19], s[0:1], 64
  s_bfe_u32 s20, s2, 0x10003
  s_bfe_u32 s21, s2, 0x20004
  s_bfe_u32 s22, s2, 0x10006
  s_lshl_b32 s22, s22, 3
  s_and_b32 s23, s2, 7
  s_add_u32 s22, s22, s23
  s_mul_i32 s20, s20, 7
  s_lshl_b32 s23, s10, 1
  s_add_u32 s23, s23, s20
  s_add_u32 s24, s23, 1
  s_add_u32 s20, s20, 6
  s_min_u32 s24, s24, s20
  v_and_b32 v3, 15, v2
  v_lshrrev_b32 v4, 4, v2
  v_lshrrev_b32 v5, 3, v3
  v_lshlrev_b32 v5, 4, v5
  v_bfe_u32 v6, v3, 1, 1
  v_lshl_add_u32 v5, v6, 3, v5
  v_bfe_u32 v6, v3, 2, 1
  v_lshl_add_u32 v5, v6, 2, v5
  v_and_b32 v6, 1, v3
  v_add_u32 v5, v5, v6
  s_lshl_b32 s25, s22, 9
  v_lshlrev_b32 v5, 13, v5
  v_lshl_add_u32 v5, v4, 4, v5
  v_add_u32 v5, s25, v5
  s_lshl_b32 s26, s23, 18
  v_add_u32 v6, s26, v5
  v_add_u32 v7, 16384, v6
  s_lshl_b32 s26, s24, 18
  v_add_u32 v8, s26, v5
  v_add_u32 v9, 16384, v8
  v_lshlrev_b32 v10, 4, v2
  s_lshl_b32 s23, s23, 10
  s_lshl_b32 s24, s24, 10
  s_mul_i32 s27, s10, 14336
  s_waitcnt lgkmcnt(0)
  s_cmp_ge_u32 s2, 128
  s_nop 1
  s_cbranch_scc1 FM1_15
  s_mul_i32 s26, s21, 917504
  s_add_u32 s26, s26, s25
  v_lshlrev_b32 v11, 13, v3
  v_lshl_add_u32 v11, v4, 4, v11
  v_add_u32 v11, s26, v11
  s_mul_i32 s30, s10, 14
  s_add_u32 s26, s30, 0
  s_lshr_b32 s31, s26, 3
  s_and_b32 s26, s26, 7
  s_lshl_b32 s31, s31, 17
  s_lshl_b32 s26, s26, 6
  s_add_u32 s26, s26, s31
  v_add_u32 v14, s26, v11
  s_add_u32 m0, s27, 0
  s_nop 0
  global_load_lds_dwordx4 v14, s[14:15]
  s_add_u32 s26, s30, 1
  s_lshr_b32 s31, s26, 3
  s_and_b32 s26, s26, 7
  s_lshl_b32 s31, s31, 17
  s_lshl_b32 s26, s26, 6
  s_add_u32 s26, s26, s31
  v_add_u32 v14, s26, v11
  s_add_u32 m0, s27, 1024
  s_nop 0
  global_load_lds_dwordx4 v14, s[14:15]
  s_add_u32 s26, s30, 2
  s_lshr_b32 s31, s26, 3
  s_and_b32 s26, s26, 7
  s_lshl_b32 s31, s31, 17
  s_lshl_b32 s26, s26, 6
  s_add_u32 s26, s26, s31
  v_add_u32 v14, s26, v11
  s_add_u32 m0, s27, 2048
  s_nop 0
  global_load_lds_dwordx4 v14, s[14:15]
  s_add_u32 s26, s30, 3
  s_lshr_b32 s31, s26, 3
  s_and_b32 s26, s26, 7
  s_lshl_b32 s31, s31, 17
  s_lshl_b32 s26, s26, 6
  s_add_u32 s26, s26, s31
  v_add_u32 v14, s26, v11
  s_add_u32 m0, s27, 3072
  s_nop 0
  global_load_lds_dwordx4 v14, s[14:15]
  s_add_u32 s26, s30, 4
  s_lshr_b32 s31, s26, 3
  s_and_b32 s26, s26, 7
  s_lshl_b32 s31, s31, 17
  s_lshl_b32 s26, s26, 6
  s_add_u32 s26, s26, s31
  v_add_u32 v14, s26, v11
  s_add_u32 m0, s27, 4096
  s_nop 0
  global_load_lds_dwordx4 v14, s[14:15]
  s_add_u32 s26, s30, 5
  s_lshr_b32 s31, s26, 3
  s_and_b32 s26, s26, 7
  s_lshl_b32 s31, s31, 17
  s_lshl_b32 s26, s26, 6
  s_add_u32 s26, s26, s31
  v_add_u32 v14, s26, v11
  s_add_u32 m0, s27, 5120
  s_nop 0
  global_load_lds_dwordx4 v14, s[14:15]
  s_add_u32 s26, s30, 6
  s_lshr_b32 s31, s26, 3
  s_and_b32 s26, s26, 7
  s_lshl_b32 s31, s31, 17
  s_lshl_b32 s26, s26, 6
  s_add_u32 s26, s26, s31
  v_add_u32 v14, s26, v11
  s_add_u32 m0, s27, 6144
  s_nop 0
  global_load_lds_dwordx4 v14, s[14:15]
  s_add_u32 s26, s30, 7
  s_lshr_b32 s31, s26, 3
  s_and_b32 s26, s26, 7
  s_lshl_b32 s31, s31, 17
  s_lshl_b32 s26, s26, 6
  s_add_u32 s26, s26, s31
  v_add_u32 v14, s26, v11
  s_add_u32 m0, s27, 7168
  s_nop 0
  global_load_lds_dwordx4 v14, s[14:15]
  s_add_u32 s26, s30, 8
  s_lshr_b32 s31, s26, 3
  s_and_b32 s26, s26, 7
  s_lshl_b32 s31, s31, 17
  s_lshl_b32 s26, s26, 6
  s_add_u32 s26, s26, s31
  v_add_u32 v14, s26, v11
  s_add_u32 m0, s27, 8192
  s_nop 0
  global_load_lds_dwordx4 v14, s[14:15]
  s_add_u32 s26, s30, 9
  s_lshr_b32 s31, s26, 3
  s_and_b32 s26, s26, 7
  s_lshl_b32 s31, s31, 17
  s_lshl_b32 s26, s26, 6
  s_add_u32 s26, s26, s31
  v_add_u32 v14, s26, v11
  s_add_u32 m0, s27, 9216
  s_nop 0
  global_load_lds_dwordx4 v14, s[14:15]
  s_add_u32 s26, s30, 10
  s_lshr_b32 s31, s26, 3
  s_and_b32 s26, s26, 7
  s_lshl_b32 s31, s31, 17
  s_lshl_b32 s26, s26, 6
  s_add_u32 s26, s26, s31
  v_add_u32 v14, s26, v11
  s_add_u32 m0, s27, 10240
  s_nop 0
  global_load_lds_dwordx4 v14, s[14:15]
  s_add_u32 s26, s30, 11
  s_lshr_b32 s31, s26, 3
  s_and_b32 s26, s26, 7
  s_lshl_b32 s31, s31, 17
  s_lshl_b32 s26, s26, 6
  s_add_u32 s26, s26, s31
  v_add_u32 v14, s26, v11
  s_add_u32 m0, s27, 11264
  s_nop 0
  global_load_lds_dwordx4 v14, s[14:15]
  s_add_u32 s26, s30, 12
  s_lshr_b32 s31, s26, 3
  s_and_b32 s26, s26, 7
  s_lshl_b32 s31, s31, 17
  s_lshl_b32 s26, s26, 6
  s_add_u32 s26, s26, s31
  v_add_u32 v14, s26, v11
  s_add_u32 m0, s27, 12288
  s_nop 0
  global_load_lds_dwordx4 v14, s[14:15]
  s_add_u32 s26, s30, 13
  s_lshr_b32 s31, s26, 3
  s_and_b32 s26, s26, 7
  s_lshl_b32 s31, s31, 17
  s_lshl_b32 s26, s26, 6
  s_add_u32 s26, s26, s31
  v_add_u32 v14, s26, v11
  s_add_u32 m0, s27, 13312
  s_nop 0
  global_load_lds_dwordx4 v14, s[14:15]
  global_load_dwordx4 a[64:67], v6, s[12:13] offset:0
  global_load_dwordx4 a[68:71], v6, s[12:13] offset:64
  global_load_dwordx4 a[72:75], v6, s[12:13] offset:128
  global_load_dwordx4 a[76:79], v6, s[12:13] offset:192
  global_load_dwordx4 a[80:83], v6, s[12:13] offset:256
  global_load_dwordx4 a[84:87], v6, s[12:13] offset:320
  global_load_dwordx4 a[88:91], v6, s[12:13] offset:384
  global_load_dwordx4 a[92:95], v6, s[12:13] offset:448
  global_load_dwordx4 a[96:99], v7, s[12:13] offset:0
  global_load_dwordx4 a[100:103], v7, s[12:13] offset:64
  global_load_dwordx4 a[104:107], v7, s[12:13] offset:128
  global_load_dwordx4 a[108:111], v7, s[12:13] offset:192
  global_load_dwordx4 a[112:115], v7, s[12:13] offset:256
  global_load_dwordx4 a[116:119], v7, s[12:13] offset:320
  global_load_dwordx4 a[120:123], v7, s[12:13] offset:384
  global_load_dwordx4 a[124:127], v7, s[12:13] offset:448
  global_load_dwordx4 a[128:131], v8, s[12:13] offset:0
  global_load_dwordx4 a[132:135], v8, s[12:13] offset:64
  global_load_dwordx4 a[136:139], v8, s[12:13] offset:128
  global_load_dwordx4 a[140:143], v8, s[12:13] offset:192
  global_load_dwordx4 a[144:147], v8, s[12:13] offset:256
  global_load_dwordx4 a[148:151], v8, s[12:13] offset:320
  global_load_dwordx4 a[152:155], v8, s[12:13] offset:384
  global_load_dwordx4 a[156:159], v8, s[12:13] offset:448
  global_load_dwordx4 a[160:163], v9, s[12:13] offset:0
  global_load_dwordx4 a[164:167], v9, s[12:13] offset:64
  global_load_dwordx4 a[168:171], v9, s[12:13] offset:128
  global_load_dwordx4 a[172:175], v9, s[12:13] offset:192
  global_load_dwordx4 a[176:179], v9, s[12:13] offset:256
  global_load_dwordx4 a[180:183], v9, s[12:13] offset:320
  global_load_dwordx4 a[184:187], v9, s[12:13] offset:384
  global_load_dwordx4 a[188:191], v9, s[12:13] offset:448
  s_mul_i32 s26, s22, 401408
  s_mul_i32 s31, s21, 100352
  s_add_u32 s26, s26, s31
  s_add_u32 s26, s26, 1835008
  v_add_u32 v13, s26, v10
  v_add_u32 v12, s23, v13
  v_add_u32 v13, s24, v13
  s_mov_b32 s28, 0x3db8aa3b
  s_mov_b32 s29, s28
  s_getreg_b32 s92, hwreg(HW_REG_XCC_ID, 0, 4)
  s_lshl_b32 s93, s92, 2
  v_mov_b32 v52, s93
  v_mov_b32 v53, 1
  s_add_u32 s92, s92, 1
  s_cmp_eq_u32 s10, 3
  s_cselect_b64 exec, 1, 0
  global_atomic_add v54, v52, v53, s[6:7] sc0 sc1
  s_mov_b64 exec, -1
  s_waitcnt vmcnt(32)
  s_barrier
  ds_read_b128 v[16:19], v10 offset:0
  ds_read_b128 v[20:23], v10 offset:1024
  ds_read_b128 v[24:27], v10 offset:2048
  ds_read_b128 v[28:31], v10 offset:3072
  ds_read_b128 v[32:35], v10 offset:4096
  ds_read_b128 v[36:39], v10 offset:5120
  s_waitcnt lgkmcnt(5)
  s_waitcnt vmcnt(0)
  v_readfirstlane_b32 s93, v54
  v_mov_b32 v52, 64
  v_mov_b32 v54, s92
  v_mov_b32 v55, 0
  s_lshl_b32 s12, s93, 2
  s_add_u32 s12, s12, s10
  s_cmp_eq_u32 s12, 127
  s_cselect_b64 exec, 1, 0
  global_atomic_cmpswap v52, v[54:55], s[6:7] sc1
  s_mov_b64 exec, -1
  s_cmp_ge_u32 s10, 2
  s_nop 1
  s_cbranch_scc1 SQ2_16
  s_cmp_eq_u32 s10, 0
  s_nop 1
  s_cbranch_scc1 SQS_18
  v_swap_b32 v65, v66
  v_swap_b32 v69, v70
  v_swap_b32 v73, v74
  v_swap_b32 v77, v78
  v_swap_b32 v81, v82
  v_swap_b32 v85, v86
  v_swap_b32 v89, v90
  s_nop 1
SQS_18:
  global_store_dwordx4 v57, v[64:67], s[8:9] offset:-4096 sc0 sc1
  global_store_dwordx4 v57, v[68:71], s[8:9] offset:-3072 sc0 sc1
  global_store_dwordx4 v57, v[72:75], s[8:9] offset:-2048 sc0 sc1
  global_store_dwordx4 v57, v[76:79], s[8:9] offset:-1024 sc0 sc1
  global_store_dwordx4 v57, v[80:83], s[8:9] offset:0 sc0 sc1
  global_store_dwordx4 v57, v[84:87], s[8:9] offset:1024 sc0 sc1
  global_store_dwordx4 v57, v[88:91], s[8:9] offset:2048 sc0 sc1
  s_nop 1
  s_branch SQD_19
SQ2_16:
  v_mov_b32 v68, -1
  v_mov_b32 v69, -1
  v_mov_b32 v70, -1
  v_mov_b32 v71, -1
  s_lshl_b32 s12, s2, 1
  s_add_u32 s12, s12, s10
  s_sub_u32 s12, s12, 2
  s_mul_i32 s12, s12, 3
  s_add_u32 s13, s12, 0
  s_mov_b32 s14, 85203968
  s_cmp_ge_u32 s13, 448
  s_cselect_b32 s14, 85204992, s14
  s_cmp_ge_u32 s13, 1088
  s_cselect_b32 s14, 99900416, s14
  s_lshl_b32 s13, s13, 10
  s_add_u32 s13, s13, s14
  v_add_u32 v58, s13, v56
  global_store_dwordx4 v58, v[68:71], s[8:9] sc0 sc1
  s_add_u32 s13, s12, 1
  s_mov_b32 s14, 85203968
  s_cmp_ge_u32 s13, 448
  s_cselect_b32 s14, 85204992, s14
  s_cmp_ge_u32 s13, 1088
  s_cselect_b32 s14, 99900416, s14
  s_lshl_b32 s13, s13, 10
  s_add_u32 s13, s13, s14
  v_add_u32 v59, s13, v56
  global_store_dwordx4 v59, v[68:71], s[8:9] sc0 sc1
  s_add_u32 s13, s12, 2
  s_mov_b32 s14, 85203968
  s_cmp_ge_u32 s13, 448
  s_cselect_b32 s14, 85204992, s14
  s_cmp_ge_u32 s13, 1088
  s_cselect_b32 s14, 99900416, s14
  s_lshl_b32 s13, s13, 10
  s_add_u32 s13, s13, s14
  v_add_u32 v60, s13, v56
  global_store_dwordx4 v60, v[68:71], s[8:9] sc0 sc1
  s_cmp_eq_u32 s10, 3
  s_nop 1
  s_cbranch_scc1 SQ3_17
  s_cmp_ge_u32 s2, 28
  s_nop 1
  s_cbranch_scc1 SQD_19
  s_lshl_b32 s13, s2, 10
  s_add_u32 s13, s13, 103337984
  v_add_u32 v61, s13, v56
  v_mov_b32 v72, 0
  v_mov_b32 v73, 0
  v_mov_b32 v74, 0
  v_mov_b32 v75, 0
  global_store_dwordx4 v61, v[72:75], s[8:9] sc0 sc1
  s_nop 1
  s_branch SQD_19
SQ3_17:
  s_cmp_ge_u32 s2, 7
  s_nop 1
  s_cbranch_scc1 SQD_19
  s_lshl_b32 s13, s2, 10
  s_add_u32 s13, s13, 85196800
  v_add_u32 v61, s13, v56
  v_add_u32 v62, 15810560, v61
  v_min_u32 v64, -2, v64
  v_min_u32 v65, -2, v65
  v_min_u32 v66, -2, v66
  v_min_u32 v67, -2, v67
  global_store_dwordx4 v61, v[64:67], s[8:9] sc0 sc1
  global_store_dwordx4 v62, v[64:67], s[8:9] sc0 sc1
  s_nop 1
SQD_19:
  v_mfma_f32_16x16x32_bf16 v[192:195], a[64:67], v[16:19], 0
  ds_read_b128 v[40:43], v10 offset:6144
  v_mfma_f32_16x16x32_bf16 v[196:199], a[96:99], v[16:19], 0
  v_mfma_f32_16x16x32_bf16 v[200:203], a[128:131], v[16:19], 0
  v_mfma_f32_16x16x32_bf16 v[204:207], a[160:163], v[16:19], 0
  s_waitcnt lgkmcnt(5)
  v_mfma_f32_16x16x32_bf16 v[192:195], a[68:71], v[20:23], v[192:195]
  ds_read_b128 v[44:47], v10 offset:7168
  v_mfma_f32_16x16x32_bf16 v[196:199], a[100:103], v[20:23], v[196:199]
  v_mfma_f32_16x16x32_bf16 v[200:203], a[132:135], v[20:23], v[200:203]
  v_mfma_f32_16x16x32_bf16 v[204:207], a[164:167], v[20:23], v[204:207]
  s_waitcnt lgkmcnt(5)
  v_mfma_f32_16x16x32_bf16 v[192:195], a[72:75], v[24:27], v[192:195]
  ds_read_b128 v[16:19], v10 offset:8192
  v_mfma_f32_16x16x32_bf16 v[196:199], a[104:107], v[24:27], v[196:199]
  v_mfma_f32_16x16x32_bf16 v[200:203], a[136:139], v[24:27], v[200:203]
  v_mfma_f32_16x16x32_bf16 v[204:207], a[168:171], v[24:27], v[204:207]
  s_waitcnt lgkmcnt(5)
  v_mfma_f32_16x16x32_bf16 v[192:195], a[76:79], v[28:31], v[192:195]
  ds_read_b128 v[20:23], v10 offset:9216
  v_mfma_f32_16x16x32_bf16 v[196:199], a[108:111], v[28:31], v[196:199]
  v_mfma_f32_16x16x32_bf16 v[200:203], a[140:143], v[28:31], v[200:203]
  v_mfma_f32_16x16x32_bf16 v[204:207], a[172:175], v[28:31], v[204:207]
  s_waitcnt lgkmcnt(5)
  v_mfma_f32_16x16x32_bf16 v[192:195], a[80:83], v[32:35], v[192:195]
  ds_read_b128 v[24:27], v10 offset:10240
  v_mfma_f32_16x16x32_bf16 v[196:199], a[112:115], v[32:35], v[196:199]
  v_mfma_f32_16x16x32_bf16 v[200:203], a[144:147], v[32:35], v[200:203]
  v_mfma_f32_16x16x32_bf16 v[204:207], a[176:179], v[32:35], v[204:207]
  s_waitcnt lgkmcnt(5)
  v_mfma_f32_16x16x32_bf16 v[192:195], a[84:87], v[36:39], v[192:195]
  ds_read_b128 v[28:31], v10 offset:11264
  v_mfma_f32_16x16x32_bf16 v[196:199], a[116:119], v[36:39], v[196:199]
  v_mfma_f32_16x16x32_bf16 v[200:203], a[148:151], v[36:39], v[200:203]
  v_mfma_f32_16x16x32_bf16 v[204:207], a[180:183], v[36:39], v[204:207]
  s_waitcnt lgkmcnt(5)
  v_mfma_f32_16x16x32_bf16 v[192:195], a[88:91], v[40:43], v[192:195]
  ds_read_b128 v[32:35], v10 offset:12288
  v_mfma_f32_16x16x32_bf16 v[196:199], a[120:123], v[40:43], v[196:199]
  v_mfma_f32_16x16x32_bf16 v[200:203], a[152:155], v[40:43], v[200:203]
  v_mfma_f32_16x16x32_bf16 v[204:207], a[184:187], v[40:43], v[204:207]
  s_waitcnt lgkmcnt(5)
  v_mfma_f32_16x16x32_bf16 v[192:195], a[92:95], v[44:47], v[192:195]
  ds_read_b128 v[36:39], v10 offset:13312
  v_mfma_f32_16x16x32_bf16 v[196:199], a[124:127], v[44:47], v[196:199]
  v_mfma_f32_16x16x32_bf16 v[200:203], a[156:159], v[44:47], v[200:203]
  v_mfma_f32_16x16x32_bf16 v[204:207], a[188:191], v[44:47], v[204:207]
  s_waitcnt lgkmcnt(5)
  v_mfma_f32_16x16x32_bf16 v[208:211], a[64:67], v[16:19], 0
  ds_read_b128 v[40:43], v10 offset:14336
  v_mfma_f32_16x16x32_bf16 v[212:215], a[96:99], v[16:19], 0
  v_mfma_f32_16x16x32_bf16 v[216:219], a[128:131], v[16:19], 0
  v_mfma_f32_16x16x32_bf16 v[220:223], a[160:163], v[16:19], 0
  s_waitcnt lgkmcnt(5)
  v_mfma_f32_16x16x32_bf16 v[208:211], a[68:71], v[20:23], v[208:211]
  ds_read_b128 v[44:47], v10 offset:15360
  v_mfma_f32_16x16x32_bf16 v[212:215], a[100:103], v[20:23], v[212:215]
  v_pk_mul_f32 v[224:225], v[192:193], s[28:29]
  v_mfma_f32_16x16x32_bf16 v[216:219], a[132:135], v[20:23], v[216:219]
  v_pk_mul_f32 v[226:227], v[194:195], s[28:29]
  v_mfma_f32_16x16x32_bf16 v[220:223], a[164:167], v[20:23], v[220:223]
  v_pk_mul_f32 v[228:229], v[196:197], s[28:29]
  s_waitcnt lgkmcnt(5)
  v_mfma_f32_16x16x32_bf16 v[208:211], a[72:75], v[24:27], v[208:211]
  ds_read_b128 v[16:19], v10 offset:16384
  v_mfma_f32_16x16x32_bf16 v[212:215], a[104:107], v[24:27], v[212:215]
  v_pk_mul_f32 v[230:231], v[198:199], s[28:29]
  v_mfma_f32_16x16x32_bf16 v[216:219], a[136:139], v[24:27], v[216:219]
  v_cvt_pk_bf16_f32 v232, v224, v225
  v_mfma_f32_16x16x32_bf16 v[220:223], a[168:171], v[24:27], v[220:223]
  v_cvt_pk_bf16_f32 v233, v226, v227
  s_waitcnt lgkmcnt(5)
  v_mfma_f32_16x16x32_bf16 v[208:211], a[76:79], v[28:31], v[208:211]
  ds_read_b128 v[20:23], v10 offset:17408
  v_mfma_f32_16x16x32_bf16 v[212:215], a[108:111], v[28:31], v[212:215]
  v_cvt_pk_bf16_f32 v234, v228, v229
  v_mfma_f32_16x16x32_bf16 v[216:219], a[140:143], v[28:31], v[216:219]
  v_cvt_pk_bf16_f32 v235, v230, v231
  v_mfma_f32_16x16x32_bf16 v[220:223], a[172:175], v[28:31], v[220:223]
  global_store_dwordx4 v12, v[232:235], s[8:9] sc0 sc1
  s_waitcnt lgkmcnt(5)
  v_mfma_f32_16x16x32_bf16 v[208:211], a[80:83], v[32:35], v[208:211]
  ds_read_b128 v[24:27], v10 offset:18432
  v_mfma_f32_16x16x32_bf16 v[212:215], a[112:115], v[32:35], v[212:215]
  v_add_u32 v12, 14336, v12
  v_mfma_f32_16x16x32_bf16 v[216:219], a[144:147], v[32:35], v[216:219]
  v_pk_mul_f32 v[236:237], v[200:201], s[28:29]
  v_mfma_f32_16x16x32_bf16 v[220:223], a[176:179], v[32:35], v[220:223]
  v_pk_mul_f32 v[238:239], v[202:203], s[28:29]
  s_waitcnt lgkmcnt(5)
  v_mfma_f32_16x16x32_bf16 v[208:211], a[84:87], v[36:39], v[208:211]
  ds_read_b128 v[28:31], v10 offset:19456
  v_mfma_f32_16x16x32_bf16 v[212:215], a[116:119], v[36:39], v[212:215]
  v_pk_mul_f32 v[240:241], v[204:205], s[28:29]
  v_mfma_f32_16x16x32_bf16 v[216:219], a[148:151], v[36:39], v[216:219]
  v_pk_mul_f32 v[242:243], v[206:207], s[28:29]
  v_mfma_f32_16x16x32_bf16 v[220:223], a[180:183], v[36:39], v[220:223]
  v_cvt_pk_bf16_f32 v244, v236, v237
  s_waitcnt lgkmcnt(5)
  v_mfma_f32_16x16x32_bf16 v[208:211], a[88:91], v[40:43], v[208:211]
  ds_read_b128 v[32:35], v10 offset:20480
  v_mfma_f32_16x16x32_bf16 v[212:215], a[120:123], v[40:43], v[212:215]
  v_cvt_pk_bf16_f32 v245, v238, v239
  v_mfma_f32_16x16x32_bf16 v[216:219], a[152:155], v[40:43], v[216:219]
  v_cvt_pk_bf16_f32 v246, v240, v241
  v_mfma_f32_16x16x32_bf16 v[220:223], a[184:187], v[40:43], v[220:223]
  v_cvt_pk_bf16_f32 v247, v242, v243
  s_waitcnt lgkmcnt(5)
  v_mfma_f32_16x16x32_bf16 v[208:211], a[92:95], v[44:47], v[208:211]
  ds_read_b128 v[36:39], v10 offset:21504
  v_mfma_f32_16x16x32_bf16 v[212:215], a[124:127], v[44:47], v[212:215]
  global_store_dwordx4 v13, v[244:247], s[8:9] sc0 sc1
  v_mfma_f32_16x16x32_bf16 v[216:219], a[156:159], v[44:47], v[216:219]
  s_nop 0
  v_add_u32 v13, 14336, v13
  v_mfma_f32_16x16x32_bf16 v[220:223], a[188:191], v[44:47], v[220:223]
  s_waitcnt lgkmcnt(5)
  v_mfma_f32_16x16x32_bf16 v[192:195], a[64:67], v[16:19], 0
  ds_read_b128 v[40:43], v10 offset:22528
  v_mfma_f32_16x16x32_bf16 v[196:199], a[96:99], v[16:19], 0
  v_mfma_f32_16x16x32_bf16 v[200:203], a[128:131], v[16:19], 0
  v_mfma_f32_16x16x32_bf16 v[204:207], a[160:163], v[16:19], 0
  s_waitcnt lgkmcnt(5)
  v_mfma_f32_16x16x32_bf16 v[192:195], a[68:71], v[20:23], v[192:195]
  ds_read_b128 v[44:47], v10 offset:23552
  v_mfma_f32_16x16x32_bf16 v[196:199], a[100:103], v[20:23], v[196:199]
  v_pk_mul_f32 v[224:225], v[208:209], s[28:29]
  v_mfma_f32_16x16x32_bf16 v[200:203], a[132:135], v[20:23], v[200:203]
  v_pk_mul_f32 v[226:227], v[210:211], s[28:29]
  v_mfma_f32_16x16x32_bf16 v[204:207], a[164:167], v[20:23], v[204:207]
  v_pk_mul_f32 v[228:229], v[212:213], s[28:29]
  s_waitcnt lgkmcnt(5)
  v_mfma_f32_16x16x32_bf16 v[192:195], a[72:75], v[24:27], v[192:195]
  ds_read_b128 v[16:19], v10 offset:24576
  v_mfma_f32_16x16x32_bf16 v[196:199], a[104:107], v[24:27], v[196:199]
  v_pk_mul_f32 v[230:231], v[214:215], s[28:29]
  v_mfma_f32_16x16x32_bf16 v[200:203], a[136:139], v[24:27], v[200:203]
  v_cvt_pk_bf16_f32 v232, v224, v225
  v_mfma_f32_16x16x32_bf16 v[204:207], a[168:171], v[24:27], v[204:207]
  v_cvt_pk_bf16_f32 v233, v226, v227
  s_waitcnt lgkmcnt(5)
  v_mfma_f32_16x16x32_bf16 v[192:195], a[76:79], v[28:31], v[192:195]
  ds_read_b128 v[20:23], v10 offset:25600
  v_mfma_f32_16x16x32_bf16 v[196:199], a[108:111], v[28:31], v[196:199]
  v_cvt_pk_bf16_f32 v234, v228, v229
  v_mfma_f32_16x16x32_bf16 v[200:203], a[140:143], v[28:31], v[200:203]
  v_cvt_pk_bf16_f32 v235, v230, v231
  v_mfma_f32_16x16x32_bf16 v[204:207], a[172:175], v[28:31], v[204:207]
  global_store_dwordx4 v12, v[232:235], s[8:9] sc0 sc1
  s_waitcnt lgkmcnt(5)
  v_mfma_f32_16x16x32_bf16 v[192:195], a[80:83], v[32:35], v[192:195]
  ds_read_b128 v[24:27], v10 offset:26624
  v_mfma_f32_16x16x32_bf16 v[196:199], a[112:115], v[32:35], v[196:199]
  v_add_u32 v12, 14336, v12
  v_mfma_f32_16x16x32_bf16 v[200:203], a[144:147], v[32:35], v[200:203]
  v_pk_mul_f32 v[236:237], v[216:217], s[28:29]
  v_mfma_f32_16x16x32_bf16 v[204:207], a[176:179], v[32:35], v[204:207]
  v_pk_mul_f32 v[238:239], v[218:219], s[28:29]
  s_waitcnt lgkmcnt(5)
  v_mfma_f32_16x16x32_bf16 v[192:195], a[84:87], v[36:39], v[192:195]
  ds_read_b128 v[28:31], v10 offset:27648
  v_mfma_f32_16x16x32_bf16 v[196:199], a[116:119], v[36:39], v[196:199]
  v_pk_mul_f32 v[240:241], v[220:221], s[28:29]
  v_mfma_f32_16x16x32_bf16 v[200:203], a[148:151], v[36:39], v[200:203]
  v_pk_mul_f32 v[242:243], v[222:223], s[28:29]
  v_mfma_f32_16x16x32_bf16 v[204:207], a[180:183], v[36:39], v[204:207]
  v_cvt_pk_bf16_f32 v244, v236, v237
  s_waitcnt lgkmcnt(5)
  v_mfma_f32_16x16x32_bf16 v[192:195], a[88:91], v[40:43], v[192:195]
  ds_read_b128 v[32:35], v10 offset:28672
  v_mfma_f32_16x16x32_bf16 v[196:199], a[120:123], v[40:43], v[196:199]
  v_cvt_pk_bf16_f32 v245, v238, v239
  v_mfma_f32_16x16x32_bf16 v[200:203], a[152:155], v[40:43], v[200:203]
  v_cvt_pk_bf16_f32 v246, v240, v241
  v_mfma_f32_16x16x32_bf16 v[204:207], a[184:187], v[40:43], v[204:207]
  v_cvt_pk_bf16_f32 v247, v242, v243
  s_waitcnt lgkmcnt(5)
  v_mfma_f32_16x16x32_bf16 v[192:195], a[92:95], v[44:47], v[192:195]
  ds_read_b128 v[36:39], v10 offset:29696
  v_mfma_f32_16x16x32_bf16 v[196:199], a[124:127], v[44:47], v[196:199]
  global_store_dwordx4 v13, v[244:247], s[8:9] sc0 sc1
  v_mfma_f32_16x16x32_bf16 v[200:203], a[156:159], v[44:47], v[200:203]
  s_nop 0
  v_add_u32 v13, 14336, v13
  v_mfma_f32_16x16x32_bf16 v[204:207], a[188:191], v[44:47], v[204:207]
  s_waitcnt lgkmcnt(5)
  v_mfma_f32_16x16x32_bf16 v[208:211], a[64:67], v[16:19], 0
  ds_read_b128 v[40:43], v10 offset:30720
  v_mfma_f32_16x16x32_bf16 v[212:215], a[96:99], v[16:19], 0
  v_mfma_f32_16x16x32_bf16 v[216:219], a[128:131], v[16:19], 0
  v_mfma_f32_16x16x32_bf16 v[220:223], a[160:163], v[16:19], 0
  s_waitcnt lgkmcnt(5)
  v_mfma_f32_16x16x32_bf16 v[208:211], a[68:71], v[20:23], v[208:211]
  ds_read_b128 v[44:47], v10 offset:31744
  v_mfma_f32_16x16x32_bf16 v[212:215], a[100:103], v[20:23], v[212:215]
  v_pk_mul_f32 v[224:225], v[192:193], s[28:29]
  v_mfma_f32_16x16x32_bf16 v[216:219], a[132:135], v[20:23], v[216:219]
  v_pk_mul_f32 v[226:227], v[194:195], s[28:29]
  v_mfma_f32_16x16x32_bf16 v[220:223], a[164:167], v[20:23], v[220:223]
  v_pk_mul_f32 v[228:229], v[196:197], s[28:29]
  s_waitcnt lgkmcnt(5)
  v_mfma_f32_16x16x32_bf16 v[208:211], a[72:75], v[24:27], v[208:211]
  ds_read_b128 v[16:19], v10 offset:32768
  v_mfma_f32_16x16x32_bf16 v[212:215], a[104:107], v[24:27], v[212:215]
  v_pk_mul_f32 v[230:231], v[198:199], s[28:29]
  v_mfma_f32_16x16x32_bf16 v[216:219], a[136:139], v[24:27], v[216:219]
  v_cvt_pk_bf16_f32 v232, v224, v225
  v_mfma_f32_16x16x32_bf16 v[220:223], a[168:171], v[24:27], v[220:223]
  v_cvt_pk_bf16_f32 v233, v226, v227
  s_waitcnt lgkmcnt(5)
  v_mfma_f32_16x16x32_bf16 v[208:211], a[76:79], v[28:31], v[208:211]
  ds_read_b128 v[20:23], v10 offset:33792
  v_mfma_f32_16x16x32_bf16 v[212:215], a[108:111], v[28:31], v[212:215]
  v_cvt_pk_bf16_f32 v234, v228, v229
  v_mfma_f32_16x16x32_bf16 v[216:219], a[140:143], v[28:31], v[216:219]
  v_cvt_pk_bf16_f32 v235, v230, v231
  v_mfma_f32_16x16x32_bf16 v[220:223], a[172:175], v[28:31], v[220:223]
  global_store_dwordx4 v12, v[232:235], s[8:9] sc0 sc1
  s_waitcnt lgkmcnt(5)
  v_mfma_f32_16x16x32_bf16 v[208:211], a[80:83], v[32:35], v[208:211]
  ds_read_b128 v[24:27], v10 offset:34816
  v_mfma_f32_16x16x32_bf16 v[212:215], a[112:115], v[32:35], v[212:215]
  v_add_u32 v12, 14336, v12
  v_mfma_f32_16x16x32_bf16 v[216:219], a[144:147], v[32:35], v[216:219]
  v_pk_mul_f32 v[236:237], v[200:201], s[28:29]
  v_mfma_f32_16x16x32_bf16 v[220:223], a[176:179], v[32:35], v[220:223]
  v_pk_mul_f32 v[238:239], v[202:203], s[28:29]
  s_waitcnt lgkmcnt(5)
  v_mfma_f32_16x16x32_bf16 v[208:211], a[84:87], v[36:39], v[208:211]
  ds_read_b128 v[28:31], v10 offset:35840
  v_mfma_f32_16x16x32_bf16 v[212:215], a[116:119], v[36:39], v[212:215]
  v_pk_mul_f32 v[240:241], v[204:205], s[28:29]
  v_mfma_f32_16x16x32_bf16 v[216:219], a[148:151], v[36:39], v[216:219]
  v_pk_mul_f32 v[242:243], v[206:207], s[28:29]
  v_mfma_f32_16x16x32_bf16 v[220:223], a[180:183], v[36:39], v[220:223]
  v_cvt_pk_bf16_f32 v244, v236, v237
  s_waitcnt lgkmcnt(5)
  v_mfma_f32_16x16x32_bf16 v[208:211], a[88:91], v[40:43], v[208:211]
  ds_read_b128 v[32:35], v10 offset:36864
  v_mfma_f32_16x16x32_bf16 v[212:215], a[120:123], v[40:43], v[212:215]
  v_cvt_pk_bf16_f32 v245, v238, v239
  v_mfma_f32_16x16x32_bf16 v[216:219], a[152:155], v[40:43], v[216:219]
  v_cvt_pk_bf16_f32 v246, v240, v241
  v_mfma_f32_16x16x32_bf16 v[220:223], a[184:187], v[40:43], v[220:223]
  v_cvt_pk_bf16_f32 v247, v242, v243
  s_waitcnt lgkmcnt(5)
  v_mfma_f32_16x16x32_bf16 v[208:211], a[92:95], v[44:47], v[208:211]
  ds_read_b128 v[36:39], v10 offset:37888
  v_mfma_f32_16x16x32_bf16 v[212:215], a[124:127], v[44:47], v[212:215]
  global_store_dwordx4 v13, v[244:247], s[8:9] sc0 sc1
  v_mfma_f32_16x16x32_bf16 v[216:219], a[156:159], v[44:47], v[216:219]
  s_nop 0
  v_add_u32 v13, 14336, v13
  v_mfma_f32_16x16x32_bf16 v[220:223], a[188:191], v[44:47], v[220:223]
  s_waitcnt lgkmcnt(5)
  v_mfma_f32_16x16x32_bf16 v[192:195], a[64:67], v[16:19], 0
  ds_read_b128 v[40:43], v10 offset:38912
  v_mfma_f32_16x16x32_bf16 v[196:199], a[96:99], v[16:19], 0
  v_mfma_f32_16x16x32_bf16 v[200:203], a[128:131], v[16:19], 0
  v_mfma_f32_16x16x32_bf16 v[204:207], a[160:163], v[16:19], 0
  s_waitcnt lgkmcnt(5)
  v_mfma_f32_16x16x32_bf16 v[192:195], a[68:71], v[20:23], v[192:195]
  ds_read_b128 v[44:47], v10 offset:39936
  v_mfma_f32_16x16x32_bf16 v[196:199], a[100:103], v[20:23], v[196:199]
  v_pk_mul_f32 v[224:225], v[208:209], s[28:29]
  v_mfma_f32_16x16x32_bf16 v[200:203], a[132:135], v[20:23], v[200:203]
  v_pk_mul_f32 v[226:227], v[210:211], s[28:29]
  v_mfma_f32_16x16x32_bf16 v[204:207], a[164:167], v[20:23], v[204:207]
  v_pk_mul_f32 v[228:229], v[212:213], s[28:29]
  s_waitcnt lgkmcnt(5)
  v_mfma_f32_16x16x32_bf16 v[192:195], a[72:75], v[24:27], v[192:195]
  ds_read_b128 v[16:19], v10 offset:40960
  v_mfma_f32_16x16x32_bf16 v[196:199], a[104:107], v[24:27], v[196:199]
  v_pk_mul_f32 v[230:231], v[214:215], s[28:29]
  v_mfma_f32_16x16x32_bf16 v[200:203], a[136:139], v[24:27], v[200:203]
  v_cvt_pk_bf16_f32 v232, v224, v225
  v_mfma_f32_16x16x32_bf16 v[204:207], a[168:171], v[24:27], v[204:207]
  v_cvt_pk_bf16_f32 v233, v226, v227
  s_waitcnt lgkmcnt(5)
  v_mfma_f32_16x16x32_bf16 v[192:195], a[76:79], v[28:31], v[192:195]
  ds_read_b128 v[20:23], v10 offset:41984
  v_mfma_f32_16x16x32_bf16 v[196:199], a[108:111], v[28:31], v[196:199]
  v_cvt_pk_bf16_f32 v234, v228, v229
  v_mfma_f32_16x16x32_bf16 v[200:203], a[140:143], v[28:31], v[200:203]
  v_cvt_pk_bf16_f32 v235, v230, v231
  v_mfma_f32_16x16x32_bf16 v[204:207], a[172:175], v[28:31], v[204:207]
  global_store_dwordx4 v12, v[232:235], s[8:9] sc0 sc1
  s_waitcnt lgkmcnt(5)
  v_mfma_f32_16x16x32_bf16 v[192:195], a[80:83], v[32:35], v[192:195]
  ds_read_b128 v[24:27], v10 offset:43008
  v_mfma_f32_16x16x32_bf16 v[196:199], a[112:115], v[32:35], v[196:199]
  v_add_u32 v12, 14336, v12
  v_mfma_f32_16x16x32_bf16 v[200:203], a[144:147], v[32:35], v[200:203]
  v_pk_mul_f32 v[236:237], v[216:217], s[28:29]
  v_mfma_f32_16x16x32_bf16 v[204:207], a[176:179], v[32:35], v[204:207]
  v_pk_mul_f32 v[238:239], v[218:219], s[28:29]
  s_waitcnt lgkmcnt(5)
  v_mfma_f32_16x16x32_bf16 v[192:195], a[84:87], v[36:39], v[192:195]
  ds_read_b128 v[28:31], v10 offset:44032
  v_mfma_f32_16x16x32_bf16 v[196:199], a[116:119], v[36:39], v[196:199]
  v_pk_mul_f32 v[240:241], v[220:221], s[28:29]
  v_mfma_f32_16x16x32_bf16 v[200:203], a[148:151], v[36:39], v[200:203]
  v_pk_mul_f32 v[242:243], v[222:223], s[28:29]
  v_mfma_f32_16x16x32_bf16 v[204:207], a[180:183], v[36:39], v[204:207]
  v_cvt_pk_bf16_f32 v244, v236, v237
  s_waitcnt lgkmcnt(5)
  v_mfma_f32_16x16x32_bf16 v[192:195], a[88:91], v[40:43], v[192:195]
  ds_read_b128 v[32:35], v10 offset:45056
  v_mfma_f32_16x16x32_bf16 v[196:199], a[120:123], v[40:43], v[196:199]
  v_cvt_pk_bf16_f32 v245, v238, v239
  v_mfma_f32_16x16x32_bf16 v[200:203], a[152:155], v[40:43], v[200:203]
  v_cvt_pk_bf16_f32 v246, v240, v241
  v_mfma_f32_16x16x32_bf16 v[204:207], a[184:187], v[40:43], v[204:207]
  v_cvt_pk_bf16_f32 v247, v242, v243
  s_waitcnt lgkmcnt(5)
  v_mfma_f32_16x16x32_bf16 v[192:195], a[92:95], v[44:47], v[192:195]
  ds_read_b128 v[36:39], v10 offset:46080
  v_mfma_f32_16x16x32_bf16 v[196:199], a[124:127], v[44:47], v[196:199]
  global_store_dwordx4 v13, v[244:247], s[8:9] sc0 sc1
  v_mfma_f32_16x16x32_bf16 v[200:203], a[156:159], v[44:47], v[200:203]
  s_nop 0
  v_add_u32 v13, 14336, v13
  v_mfma_f32_16x16x32_bf16 v[204:207], a[188:191], v[44:47], v[204:207]
  s_waitcnt lgkmcnt(5)
  v_mfma_f32_16x16x32_bf16 v[208:211], a[64:67], v[16:19], 0
  ds_read_b128 v[40:43], v10 offset:47104
  v_mfma_f32_16x16x32_bf16 v[212:215], a[96:99], v[16:19], 0
  v_mfma_f32_16x16x32_bf16 v[216:219], a[128:131], v[16:19], 0
  v_mfma_f32_16x16x32_bf16 v[220:223], a[160:163], v[16:19], 0
  s_waitcnt lgkmcnt(5)
  v_mfma_f32_16x16x32_bf16 v[208:211], a[68:71], v[20:23], v[208:211]
  ds_read_b128 v[44:47], v10 offset:48128
  v_mfma_f32_16x16x32_bf16 v[212:215], a[100:103], v[20:23], v[212:215]
  v_pk_mul_f32 v[224:225], v[192:193], s[28:29]
  v_mfma_f32_16x16x32_bf16 v[216:219], a[132:135], v[20:23], v[216:219]
  v_pk_mul_f32 v[226:227], v[194:195], s[28:29]
  v_mfma_f32_16x16x32_bf16 v[220:223], a[164:167], v[20:23], v[220:223]
  v_pk_mul_f32 v[228:229], v[196:197], s[28:29]
  s_waitcnt lgkmcnt(5)
  v_mfma_f32_16x16x32_bf16 v[208:211], a[72:75], v[24:27], v[208:211]
  ds_read_b128 v[16:19], v10 offset:49152
  v_mfma_f32_16x16x32_bf16 v[212:215], a[104:107], v[24:27], v[212:215]
  v_pk_mul_f32 v[230:231], v[198:199], s[28:29]
  v_mfma_f32_16x16x32_bf16 v[216:219], a[136:139], v[24:27], v[216:219]
  v_cvt_pk_bf16_f32 v232, v224, v225
  v_mfma_f32_16x16x32_bf16 v[220:223], a[168:171], v[24:27], v[220:223]
  v_cvt_pk_bf16_f32 v233, v226, v227
  s_waitcnt lgkmcnt(5)
  v_mfma_f32_16x16x32_bf16 v[208:211], a[76:79], v[28:31], v[208:211]
  ds_read_b128 v[20:23], v10 offset:50176
  v_mfma_f32_16x16x32_bf16 v[212:215], a[108:111], v[28:31], v[212:215]
  v_cvt_pk_bf16_f32 v234, v228, v229
  v_mfma_f32_16x16x32_bf16 v[216:219], a[140:143], v[28:31], v[216:219]
  v_cvt_pk_bf16_f32 v235, v230, v231
  v_mfma_f32_16x16x32_bf16 v[220:223], a[172:175], v[28:31], v[220:223]
  global_store_dwordx4 v12, v[232:235], s[8:9] sc0 sc1
  s_waitcnt lgkmcnt(5)
  v_mfma_f32_16x16x32_bf16 v[208:211], a[80:83], v[32:35], v[208:211]
  ds_read_b128 v[24:27], v10 offset:51200
  v_mfma_f32_16x16x32_bf16 v[212:215], a[112:115], v[32:35], v[212:215]
  v_add_u32 v12, 14336, v12
  v_mfma_f32_16x16x32_bf16 v[216:219], a[144:147], v[32:35], v[216:219]
  v_pk_mul_f32 v[236:237], v[200:201], s[28:29]
  v_mfma_f32_16x16x32_bf16 v[220:223], a[176:179], v[32:35], v[220:223]
  v_pk_mul_f32 v[238:239], v[202:203], s[28:29]
  s_waitcnt lgkmcnt(5)
  v_mfma_f32_16x16x32_bf16 v[208:211], a[84:87], v[36:39], v[208:211]
  ds_read_b128 v[28:31], v10 offset:52224
  v_mfma_f32_16x16x32_bf16 v[212:215], a[116:119], v[36:39], v[212:215]
  v_pk_mul_f32 v[240:241], v[204:205], s[28:29]
  v_mfma_f32_16x16x32_bf16 v[216:219], a[148:151], v[36:39], v[216:219]
  v_pk_mul_f32 v[242:243], v[206:207], s[28:29]
  v_mfma_f32_16x16x32_bf16 v[220:223], a[180:183], v[36:39], v[220:223]
  v_cvt_pk_bf16_f32 v244, v236, v237
  s_waitcnt lgkmcnt(5)
  v_mfma_f32_16x16x32_bf16 v[208:211], a[88:91], v[40:43], v[208:211]
  ds_read_b128 v[32:35], v10 offset:53248
  v_mfma_f32_16x16x32_bf16 v[212:215], a[120:123], v[40:43], v[212:215]
  v_cvt_pk_bf16_f32 v245, v238, v239
  v_mfma_f32_16x16x32_bf16 v[216:219], a[152:155], v[40:43], v[216:219]
  v_cvt_pk_bf16_f32 v246, v240, v241
  v_mfma_f32_16x16x32_bf16 v[220:223], a[184:187], v[40:43], v[220:223]
  v_cvt_pk_bf16_f32 v247, v242, v243
  s_waitcnt lgkmcnt(5)
  v_mfma_f32_16x16x32_bf16 v[208:211], a[92:95], v[44:47], v[208:211]
  ds_read_b128 v[36:39], v10 offset:54272
  v_mfma_f32_16x16x32_bf16 v[212:215], a[124:127], v[44:47], v[212:215]
  global_store_dwordx4 v13, v[244:247], s[8:9] sc0 sc1
  v_mfma_f32_16x16x32_bf16 v[216:219], a[156:159], v[44:47], v[216:219]
  s_nop 0
  v_add_u32 v13, 14336, v13
  v_mfma_f32_16x16x32_bf16 v[220:223], a[188:191], v[44:47], v[220:223]
  s_waitcnt lgkmcnt(5)
  v_mfma_f32_16x16x32_bf16 v[192:195], a[64:67], v[16:19], 0
  ds_read_b128 v[40:43], v10 offset:55296
  v_mfma_f32_16x16x32_bf16 v[196:199], a[96:99], v[16:19], 0
  v_mfma_f32_16x16x32_bf16 v[200:203], a[128:131], v[16:19], 0
  v_mfma_f32_16x16x32_bf16 v[204:207], a[160:163], v[16:19], 0
  s_waitcnt lgkmcnt(5)
  v_mfma_f32_16x16x32_bf16 v[192:195], a[68:71], v[20:23], v[192:195]
  ds_read_b128 v[44:47], v10 offset:56320
  v_mfma_f32_16x16x32_bf16 v[196:199], a[100:103], v[20:23], v[196:199]
  v_pk_mul_f32 v[224:225], v[208:209], s[28:29]
  v_mfma_f32_16x16x32_bf16 v[200:203], a[132:135], v[20:23], v[200:203]
  v_pk_mul_f32 v[226:227], v[210:211], s[28:29]
  v_mfma_f32_16x16x32_bf16 v[204:207], a[164:167], v[20:23], v[204:207]
  v_pk_mul_f32 v[228:229], v[212:213], s[28:29]
  s_waitcnt lgkmcnt(5)
  v_mfma_f32_16x16x32_bf16 v[192:195], a[72:75], v[24:27], v[192:195]
  v_pk_mul_f32 v[230:231], v[214:215], s[28:29]
  v_mfma_f32_16x16x32_bf16 v[196:199], a[104:107], v[24:27], v[196:199]
  v_cvt_pk_bf16_f32 v232, v224, v225
  v_mfma_f32_16x16x32_bf16 v[200:203], a[136:139], v[24:27], v[200:203]
  v_cvt_pk_bf16_f32 v233, v226, v227
  v_mfma_f32_16x16x32_bf16 v[204:207], a[168:171], v[24:27], v[204:207]
  v_cvt_pk_bf16_f32 v234, v228, v229
  s_waitcnt lgkmcnt(4)
  v_mfma_f32_16x16x32_bf16 v[192:195], a[76:79], v[28:31], v[192:195]
  v_cvt_pk_bf16_f32 v235, v230, v231
  v_mfma_f32_16x16x32_bf16 v[196:199], a[108:111], v[28:31], v[196:199]
  global_store_dwordx4 v12, v[232:235], s[8:9] sc0 sc1
  v_mfma_f32_16x16x32_bf16 v[200:203], a[140:143], v[28:31], v[200:203]
  s_nop 0
  v_add_u32 v12, 14336, v12
  v_mfma_f32_16x16x32_bf16 v[204:207], a[172:175], v[28:31], v[204:207]
  v_pk_mul_f32 v[236:237], v[216:217], s[28:29]
  s_waitcnt lgkmcnt(3)
  v_mfma_f32_16x16x32_bf16 v[192:195], a[80:83], v[32:35], v[192:195]
  v_pk_mul_f32 v[238:239], v[218:219], s[28:29]
  v_mfma_f32_16x16x32_bf16 v[196:199], a[112:115], v[32:35], v[196:199]
  v_pk_mul_f32 v[240:241], v[220:221], s[28:29]
  v_mfma_f32_16x16x32_bf16 v[200:203], a[144:147], v[32:35], v[200:203]
  v_pk_mul_f32 v[242:243], v[222:223], s[28:29]
  v_mfma_f32_16x16x32_bf16 v[204:207], a[176:179], v[32:35], v[204:207]
  v_cvt_pk_bf16_f32 v244, v236, v237
  s_waitcnt lgkmcnt(2)
  v_mfma_f32_16x16x32_bf16 v[192:195], a[84:87], v[36:39], v[192:195]
  v_cvt_pk_bf16_f32 v245, v238, v239
  v_mfma_f32_16x16x32_bf16 v[196:199], a[116:119], v[36:39], v[196:199]
  v_cvt_pk_bf16_f32 v246, v240, v241
  v_mfma_f32_16x16x32_bf16 v[200:203], a[148:151], v[36:39], v[200:203]
  v_cvt_pk_bf16_f32 v247, v242, v243
  v_mfma_f32_16x16x32_bf16 v[204:207], a[180:183], v[36:39], v[204:207]
  global_store_dwordx4 v13, v[244:247], s[8:9] sc0 sc1
  s_waitcnt lgkmcnt(1)
  v_mfma_f32_16x16x32_bf16 v[192:195], a[88:91], v[40:43], v[192:195]
  v_add_u32 v13, 14336, v13
  v_mfma_f32_16x16x32_bf16 v[196:199], a[120:123], v[40:43], v[196:199]
  v_mfma_f32_16x16x32_bf16 v[200:203], a[152:155], v[40:43], v[200:203]
  v_mfma_f32_16x16x32_bf16 v[204:207], a[184:187], v[40:43], v[204:207]
  s_waitcnt lgkmcnt(0)
  v_mfma_f32_16x16x32_bf16 v[192:195], a[92:95], v[44:47], v[192:195]
  v_mfma_f32_16x16x32_bf16 v[196:199], a[124:127], v[44:47], v[196:199]
  v_mfma_f32_16x16x32_bf16 v[200:203], a[156:159], v[44:47], v[200:203]
  v_mfma_f32_16x16x32_bf16 v[204:207], a[188:191], v[44:47], v[204:207]
  s_nop 4
  v_pk_mul_f32 v[224:225], v[192:193], s[28:29]
  v_pk_mul_f32 v[226:227], v[194:195], s[28:29]
  v_pk_mul_f32 v[228:229], v[196:197], s[28:29]
  v_pk_mul_f32 v[230:231], v[198:199], s[28:29]
  v_cvt_pk_bf16_f32 v232, v224, v225
  v_cvt_pk_bf16_f32 v233, v226, v227
  v_cvt_pk_bf16_f32 v234, v228, v229
  v_cvt_pk_bf16_f32 v235, v230, v231
  global_store_dwordx4 v12, v[232:235], s[8:9] sc0 sc1
  s_nop 1
  v_add_u32 v12, 14336, v12
  v_pk_mul_f32 v[236:237], v[200:201], s[28:29]
  v_pk_mul_f32 v[238:239], v[202:203], s[28:29]
  v_pk_mul_f32 v[240:241], v[204:205], s[28:29]
  v_pk_mul_f32 v[242:243], v[206:207], s[28:29]
  v_cvt_pk_bf16_f32 v244, v236, v237
  v_cvt_pk_bf16_f32 v245, v238, v239
  v_cvt_pk_bf16_f32 v246, v240, v241
  v_cvt_pk_bf16_f32 v247, v242, v243
  global_store_dwordx4 v13, v[244:247], s[8:9] sc0 sc1
  s_nop 1
  v_add_u32 v13, 14336, v13
  s_nop 1
  s_branch P1E1_11
FM1_15:
  s_mul_i32 s26, s22, 229376
  s_mul_i32 s31, s21, 224
  s_add_u32 s26, s26, s31
  s_mul_i32 s31, s10, 57344
  s_add_u32 s26, s26, s31
  v_add_u32 v14, 0, v2
  v_mul_u32_u24 v15, 4682, v14
  v_lshrrev_b32 v15, 16, v15
  v_mul_u32_u24 v16, 672, v15
  v_lshl_add_u32 v16, v14, 4, v16
  v_add_u32 v16, s26, v16
  v_add_u32 v17, 28672, v16
  s_add_u32 m0, s27, 0
  s_nop 0
  global_load_lds_dwordx4 v16, s[18:19]
  s_add_u32 m0, s27, 7168
  s_nop 0
  global_load_lds_dwordx4 v17, s[18:19]
  v_add_u32 v14, 64, v2
  v_mul_u32_u24 v15, 4682, v14
  v_lshrrev_b32 v15, 16, v15
  v_mul_u32_u24 v16, 672, v15
  v_lshl_add_u32 v16, v14, 4, v16
  v_add_u32 v16, s26, v16
  v_add_u32 v17, 28672, v16
  s_add_u32 m0, s27, 1024
  s_nop 0
  global_load_lds_dwordx4 v16, s[18:19]
  s_add_u32 m0, s27, 8192
  s_nop 0
  global_load_lds_dwordx4 v17, s[18:19]
  v_add_u32 v14, 128, v2
  v_mul_u32_u24 v15, 4682, v14
  v_lshrrev_b32 v15, 16, v15
  v_mul_u32_u24 v16, 672, v15
  v_lshl_add_u32 v16, v14, 4, v16
  v_add_u32 v16, s26, v16
  v_add_u32 v17, 28672, v16
  s_add_u32 m0, s27, 2048
  s_nop 0
  global_load_lds_dwordx4 v16, s[18:19]
  s_add_u32 m0, s27, 9216
  s_nop 0
  global_load_lds_dwordx4 v17, s[18:19]
  v_add_u32 v14, 192, v2
  v_mul_u32_u24 v15, 4682, v14
  v_lshrrev_b32 v15, 16, v15
  v_mul_u32_u24 v16, 672, v15
  v_lshl_add_u32 v16, v14, 4, v16
  v_add_u32 v16, s26, v16
  v_add_u32 v17, 28672, v16
  s_add_u32 m0, s27, 3072
  s_nop 0
  global_load_lds_dwordx4 v16, s[18:19]
  s_add_u32 m0, s27, 10240
  s_nop 0
  global_load_lds_dwordx4 v17, s[18:19]
  v_add_u32 v14, 256, v2
  v_mul_u32_u24 v15, 4682, v14
  v_lshrrev_b32 v15, 16, v15
  v_mul_u32_u24 v16, 672, v15
  v_lshl_add_u32 v16, v14, 4, v16
  v_add_u32 v16, s26, v16
  v_add_u32 v17, 28672, v16
  s_add_u32 m0, s27, 4096
  s_nop 0
  global_load_lds_dwordx4 v16, s[18:19]
  s_add_u32 m0, s27, 11264
  s_nop 0
  global_load_lds_dwordx4 v17, s[18:19]
  v_add_u32 v14, 320, v2
  v_mul_u32_u24 v15, 4682, v14
  v_lshrrev_b32 v15, 16, v15
  v_mul_u32_u24 v16, 672, v15
  v_lshl_add_u32 v16, v14, 4, v16
  v_add_u32 v16, s26, v16
  v_add_u32 v17, 28672, v16
  s_add_u32 m0, s27, 5120
  s_nop 0
  global_load_lds_dwordx4 v16, s[18:19]
  s_add_u32 m0, s27, 12288
  s_nop 0
  global_load_lds_dwordx4 v17, s[18:19]
  v_add_u32 v14, 384, v2
  v_mul_u32_u24 v15, 4682, v14
  v_lshrrev_b32 v15, 16, v15
  v_mul_u32_u24 v16, 672, v15
  v_lshl_add_u32 v16, v14, 4, v16
  v_add_u32 v16, s26, v16
  v_add_u32 v17, 28672, v16
  s_add_u32 m0, s27, 6144
  s_nop 0
  global_load_lds_dwordx4 v16, s[18:19]
  s_add_u32 m0, s27, 13312
  s_nop 0
  global_load_lds_dwordx4 v17, s[18:19]
  global_load_dwordx4 a[64:67], v6, s[16:17] offset:0
  global_load_dwordx4 a[68:71], v6, s[16:17] offset:64
  global_load_dwordx4 a[72:75], v6, s[16:17] offset:128
  global_load_dwordx4 a[76:79], v6, s[16:17] offset:192
  global_load_dwordx4 a[80:83], v6, s[16:17] offset:256
  global_load_dwordx4 a[84:87], v6, s[16:17] offset:320
  global_load_dwordx4 a[88:91], v6, s[16:17] offset:384
  global_load_dwordx4 a[92:95], v6, s[16:17] offset:448
  global_load_dwordx4 a[96:99], v7, s[16:17] offset:0
  global_load_dwordx4 a[100:103], v7, s[16:17] offset:64
  global_load_dwordx4 a[104:107], v7, s[16:17] offset:128
  global_load_dwordx4 a[108:111], v7, s[16:17] offset:192
  global_load_dwordx4 a[112:115], v7, s[16:17] offset:256
  global_load_dwordx4 a[116:119], v7, s[16:17] offset:320
  global_load_dwordx4 a[120:123], v7, s[16:17] offset:384
  global_load_dwordx4 a[124:127], v7, s[16:17] offset:448
  global_load_dwordx4 a[128:131], v8, s[16:17] offset:0
  global_load_dwordx4 a[132:135], v8, s[16:17] offset:64
  global_load_dwordx4 a[136:139], v8, s[16:17] offset:128
  global_load_dwordx4 a[140:143], v8, s[16:17] offset:192
  global_load_dwordx4 a[144:147], v8, s[16:17] offset:256
  global_load_dwordx4 a[148:151], v8, s[16:17] offset:320
  global_load_dwordx4 a[152:155], v8, s[16:17] offset:384
  global_load_dwordx4 a[156:159], v8, s[16:17] offset:448
  global_load_dwordx4 a[160:163], v9, s[16:17] offset:0
  global_load_dwordx4 a[164:167], v9, s[16:17] offset:64
  global_load_dwordx4 a[168:171], v9, s[16:17] offset:128
  global_load_dwordx4 a[172:175], v9, s[16:17] offset:192
  global_load_dwordx4 a[176:179], v9, s[16:17] offset:256
  global_load_dwordx4 a[180:183], v9, s[16:17] offset:320
  global_load_dwordx4 a[184:187], v9, s[16:17] offset:384
  global_load_dwordx4 a[188:191], v9, s[16:17] offset:448
  v_lshrrev_b32 v11, 2, v3
  v_lshl_add_u32 v11, v4, 3, v11
  v_mul_u32_u24 v11, 224, v11
  v_and_b32 v14, 3, v3
  v_lshl_add_u32 v11, v14, 3, v11
  s_mul_i32 s31, s21, 7
  s_lshr_b32 s26, s31, 1
  s_mul_i32 s26, s26, 458752
  s_and_b32 s31, s31, 1
  s_mul_i32 s30, s31, 14336
  s_add_u32 s26, s26, s30
  s_mul_i32 s30, s22, 28672
  s_add_u32 s26, s26, s30
  s_add_u32 s26, s26, 8257536
  v_add_u32 v13, s26, v10
  v_add_u32 v12, s23, v13
  v_add_u32 v13, s24, v13
  s_cmp_eq_u32 s31, 0
  s_mov_b32 s30, 14336
  s_cselect_b32 s30, s30, 444416
  s_mov_b32 s28, 1.0
  s_mov_b32 s29, 1.0
  s_getreg_b32 s92, hwreg(HW_REG_XCC_ID, 0, 4)
  s_lshl_b32 s93, s92, 2
  v_mov_b32 v52, s93
  v_mov_b32 v53, 1
  s_add_u32 s92, s92, 1
  s_cmp_eq_u32 s10, 3
  s_cselect_b64 exec, 1, 0
  global_atomic_add v54, v52, v53, s[6:7] sc0 sc1
  s_mov_b64 exec, -1
  s_waitcnt vmcnt(32)
  s_barrier
  ds_read_b64_tr_b16 v[16:17], v11 offset:0
  ds_read_b64_tr_b16 v[18:19], v11 offset:896
  ds_read_b64_tr_b16 v[20:21], v11 offset:7168
  ds_read_b64_tr_b16 v[22:23], v11 offset:8064
  ds_read_b64_tr_b16 v[24:25], v11 offset:14336
  ds_read_b64_tr_b16 v[26:27], v11 offset:15232
  ds_read_b64_tr_b16 v[28:29], v11 offset:21504
  ds_read_b64_tr_b16 v[30:31], v11 offset:22400
  ds_read_b64_tr_b16 v[32:33], v11 offset:28672
  ds_read_b64_tr_b16 v[34:35], v11 offset:29568
  ds_read_b64_tr_b16 v[36:37], v11 offset:35840
  ds_read_b64_tr_b16 v[38:39], v11 offset:36736
  s_waitcnt lgkmcnt(10)
  s_waitcnt vmcnt(0)
  v_readfirstlane_b32 s93, v54
  v_mov_b32 v52, 64
  v_mov_b32 v54, s92
  v_mov_b32 v55, 0
  s_lshl_b32 s12, s93, 2
  s_add_u32 s12, s12, s10
  s_cmp_eq_u32 s12, 127
  s_cselect_b64 exec, 1, 0
  global_atomic_cmpswap v52, v[54:55], s[6:7] sc1
  s_mov_b64 exec, -1
  s_cmp_ge_u32 s10, 2
  s_nop 1
  s_cbranch_scc1 SQ2_20
  s_cmp_eq_u32 s10, 0
  s_nop 1
  s_cbranch_scc1 SQS_22
  v_swap_b32 v65, v66
  v_swap_b32 v69, v70
  v_swap_b32 v73, v74
  v_swap_b32 v77, v78
  v_swap_b32 v81, v82
  v_swap_b32 v85, v86
  v_swap_b32 v89, v90
  s_nop 1
SQS_22:
  global_store_dwordx4 v57, v[64:67], s[8:9] offset:-4096 sc0 sc1
  global_store_dwordx4 v57, v[68:71], s[8:9] offset:-3072 sc0 sc1
  global_store_dwordx4 v57, v[72:75], s[8:9] offset:-2048 sc0 sc1
  global_store_dwordx4 v57, v[76:79], s[8:9] offset:-1024 sc0 sc1
  global_store_dwordx4 v57, v[80:83], s[8:9] offset:0 sc0 sc1
  global_store_dwordx4 v57, v[84:87], s[8:9] offset:1024 sc0 sc1
  global_store_dwordx4 v57, v[88:91], s[8:9] offset:2048 sc0 sc1
  s_nop 1
  s_branch SQD_23
SQ2_20:
  v_mov_b32 v68, -1
  v_mov_b32 v69, -1
  v_mov_b32 v70, -1
  v_mov_b32 v71, -1
  s_lshl_b32 s12, s2, 1
  s_add_u32 s12, s12, s10
  s_sub_u32 s12, s12, 2
  s_mul_i32 s12, s12, 3
  s_add_u32 s13, s12, 0
  s_mov_b32 s14, 85203968
  s_cmp_ge_u32 s13, 448
  s_cselect_b32 s14, 85204992, s14
  s_cmp_ge_u32 s13, 1088
  s_cselect_b32 s14, 99900416, s14
  s_lshl_b32 s13, s13, 10
  s_add_u32 s13, s13, s14
  v_add_u32 v58, s13, v56
  global_store_dwordx4 v58, v[68:71], s[8:9] sc0 sc1
  s_add_u32 s13, s12, 1
  s_mov_b32 s14, 85203968
  s_cmp_ge_u32 s13, 448
  s_cselect_b32 s14, 85204992, s14
  s_cmp_ge_u32 s13, 1088
  s_cselect_b32 s14, 99900416, s14
  s_lshl_b32 s13, s13, 10
  s_add_u32 s13, s13, s14
  v_add_u32 v59, s13, v56
  global_store_dwordx4 v59, v[68:71], s[8:9] sc0 sc1
  s_add_u32 s13, s12, 2
  s_mov_b32 s14, 85203968
  s_cmp_ge_u32 s13, 448
  s_cselect_b32 s14, 85204992, s14
  s_cmp_ge_u32 s13, 1088
  s_cselect_b32 s14, 99900416, s14
  s_lshl_b32 s13, s13, 10
  s_add_u32 s13, s13, s14
  v_add_u32 v60, s13, v56
  global_store_dwordx4 v60, v[68:71], s[8:9] sc0 sc1
  s_cmp_eq_u32 s10, 3
  s_nop 1
  s_cbranch_scc1 SQ3_21
  s_cmp_ge_u32 s2, 28
  s_nop 1
  s_cbranch_scc1 SQD_23
  s_lshl_b32 s13, s2, 10
  s_add_u32 s13, s13, 103337984
  v_add_u32 v61, s13, v56
  v_mov_b32 v72, 0
  v_mov_b32 v73, 0
  v_mov_b32 v74, 0
  v_mov_b32 v75, 0
  global_store_dwordx4 v61, v[72:75], s[8:9] sc0 sc1
  s_nop 1
  s_branch SQD_23
SQ3_21:
  s_cmp_ge_u32 s2, 7
  s_nop 1
  s_cbranch_scc1 SQD_23
  s_lshl_b32 s13, s2, 10
  s_add_u32 s13, s13, 85196800
  v_add_u32 v61, s13, v56
  v_add_u32 v62, 15810560, v61
  v_min_u32 v64, -2, v64
  v_min_u32 v65, -2, v65
  v_min_u32 v66, -2, v66
  v_min_u32 v67, -2, v67
  global_store_dwordx4 v61, v[64:67], s[8:9] sc0 sc1
  global_store_dwordx4 v62, v[64:67], s[8:9] sc0 sc1
  s_nop 1
SQD_23:
  v_mfma_f32_16x16x32_bf16 v[192:195], a[64:67], v[16:19], 0
  ds_read_b64_tr_b16 v[40:41], v11 offset:43008
  ds_read_b64_tr_b16 v[42:43], v11 offset:43904
  v_mfma_f32_16x16x32_bf16 v[196:199], a[96:99], v[16:19], 0
  v_mfma_f32_16x16x32_bf16 v[200:203], a[128:131], v[16:19], 0
  v_mfma_f32_16x16x32_bf16 v[204:207], a[160:163], v[16:19], 0
  s_waitcnt lgkmcnt(10)
  v_mfma_f32_16x16x32_bf16 v[192:195], a[68:71], v[20:23], v[192:195]
  ds_read_b64_tr_b16 v[44:45], v11 offset:50176
  ds_read_b64_tr_b16 v[46:47], v11 offset:51072
  v_mfma_f32_16x16x32_bf16 v[196:199], a[100:103], v[20:23], v[196:199]
  v_mfma_f32_16x16x32_bf16 v[200:203], a[132:135], v[20:23], v[200:203]
  v_mfma_f32_16x16x32_bf16 v[204:207], a[164:167], v[20:23], v[204:207]
  s_waitcnt lgkmcnt(10)
  v_mfma_f32_16x16x32_bf16 v[192:195], a[72:75], v[24:27], v[192:195]
  ds_read_b64_tr_b16 v[16:17], v11 offset:32
  ds_read_b64_tr_b16 v[18:19], v11 offset:928
  v_mfma_f32_16x16x32_bf16 v[196:199], a[104:107], v[24:27], v[196:199]
  v_mfma_f32_16x16x32_bf16 v[200:203], a[136:139], v[24:27], v[200:203]
  v_mfma_f32_16x16x32_bf16 v[204:207], a[168:171], v[24:27], v[204:207]
  s_waitcnt lgkmcnt(10)
  v_mfma_f32_16x16x32_bf16 v[192:195], a[76:79], v[28:31], v[192:195]
  ds_read_b64_tr_b16 v[20:21], v11 offset:7200
  ds_read_b64_tr_b16 v[22:23], v11 offset:8096
  v_mfma_f32_16x16x32_bf16 v[196:199], a[108:111], v[28:31], v[196:199]
  v_mfma_f32_16x16x32_bf16 v[200:203], a[140:143], v[28:31], v[200:203]
  v_mfma_f32_16x16x32_bf16 v[204:207], a[172:175], v[28:31], v[204:207]
  s_waitcnt lgkmcnt(10)
  v_mfma_f32_16x16x32_bf16 v[192:195], a[80:83], v[32:35], v[192:195]
  ds_read_b64_tr_b16 v[24:25], v11 offset:14368
  ds_read_b64_tr_b16 v[26:27], v11 offset:15264
  v_mfma_f32_16x16x32_bf16 v[196:199], a[112:115], v[32:35], v[196:199]
  v_mfma_f32_16x16x32_bf16 v[200:203], a[144:147], v[32:35], v[200:203]
  v_mfma_f32_16x16x32_bf16 v[204:207], a[176:179], v[32:35], v[204:207]
  s_waitcnt lgkmcnt(10)
  v_mfma_f32_16x16x32_bf16 v[192:195], a[84:87], v[36:39], v[192:195]
  ds_read_b64_tr_b16 v[28:29], v11 offset:21536
  ds_read_b64_tr_b16 v[30:31], v11 offset:22432
  v_mfma_f32_16x16x32_bf16 v[196:199], a[116:119], v[36:39], v[196:199]
  v_mfma_f32_16x16x32_bf16 v[200:203], a[148:151], v[36:39], v[200:203]
  v_mfma_f32_16x16x32_bf16 v[204:207], a[180:183], v[36:39], v[204:207]
  s_waitcnt lgkmcnt(10)
  v_mfma_f32_16x16x32_bf16 v[192:195], a[88:91], v[40:43], v[192:195]
  ds_read_b64_tr_b16 v[32:33], v11 offset:28704
  ds_read_b64_tr_b16 v[34:35], v11 offset:29600
  v_mfma_f32_16x16x32_bf16 v[196:199], a[120:123], v[40:43], v[196:199]
  v_mfma_f32_16x16x32_bf16 v[200:203], a[152:155], v[40:43], v[200:203]
  v_mfma_f32_16x16x32_bf16 v[204:207], a[184:187], v[40:43], v[204:207]
  s_waitcnt lgkmcnt(10)
  v_mfma_f32_16x16x32_bf16 v[192:195], a[92:95], v[44:47], v[192:195]
  ds_read_b64_tr_b16 v[36:37], v11 offset:35872
  ds_read_b64_tr_b16 v[38:39], v11 offset:36768
  v_mfma_f32_16x16x32_bf16 v[196:199], a[124:127], v[44:47], v[196:199]
  v_mfma_f32_16x16x32_bf16 v[200:203], a[156:159], v[44:47], v[200:203]
  v_mfma_f32_16x16x32_bf16 v[204:207], a[188:191], v[44:47], v[204:207]
  s_waitcnt lgkmcnt(10)
  v_mfma_f32_16x16x32_bf16 v[208:211], a[64:67], v[16:19], 0
  ds_read_b64_tr_b16 v[40:41], v11 offset:43040
  ds_read_b64_tr_b16 v[42:43], v11 offset:43936
  v_mfma_f32_16x16x32_bf16 v[212:215], a[96:99], v[16:19], 0
  v_mfma_f32_16x16x32_bf16 v[216:219], a[128:131], v[16:19], 0
  v_mfma_f32_16x16x32_bf16 v[220:223], a[160:163], v[16:19], 0
  s_waitcnt lgkmcnt(10)
  v_mfma_f32_16x16x32_bf16 v[208:211], a[68:71], v[20:23], v[208:211]
  ds_read_b64_tr_b16 v[44:45], v11 offset:50208
  ds_read_b64_tr_b16 v[46:47], v11 offset:51104
  v_mfma_f32_16x16x32_bf16 v[212:215], a[100:103], v[20:23], v[212:215]
  v_pk_mul_f32 v[224:225], v[192:193], s[28:29]
  v_mfma_f32_16x16x32_bf16 v[216:219], a[132:135], v[20:23], v[216:219]
  v_pk_mul_f32 v[226:227], v[194:195], s[28:29]
  v_mfma_f32_16x16x32_bf16 v[220:223], a[164:167], v[20:23], v[220:223]
  v_pk_mul_f32 v[228:229], v[196:197], s[28:29]
  s_waitcnt lgkmcnt(10)
  v_mfma_f32_16x16x32_bf16 v[208:211], a[72:75], v[24:27], v[208:211]
  ds_read_b64_tr_b16 v[16:17], v11 offset:64
  ds_read_b64_tr_b16 v[18:19], v11 offset:960
  v_mfma_f32_16x16x32_bf16 v[212:215], a[104:107], v[24:27], v[212:215]
  v_pk_mul_f32 v[230:231], v[198:199], s[28:29]
  v_mfma_f32_16x16x32_bf16 v[216:219], a[136:139], v[24:27], v[216:219]
  v_cvt_pk_bf16_f32 v232, v224, v225
  v_mfma_f32_16x16x32_bf16 v[220:223], a[168:171], v[24:27], v[220:223]
  v_cvt_pk_bf16_f32 v233, v226, v227
  s_waitcnt lgkmcnt(10)
  v_mfma_f32_16x16x32_bf16 v[208:211], a[76:79], v[28:31], v[208:211]
  ds_read_b64_tr_b16 v[20:21], v11 offset:7232
  ds_read_b64_tr_b16 v[22:23], v11 offset:8128
  v_mfma_f32_16x16x32_bf16 v[212:215], a[108:111], v[28:31], v[212:215]
  v_cvt_pk_bf16_f32 v234, v228, v229
  v_mfma_f32_16x16x32_bf16 v[216:219], a[140:143], v[28:31], v[216:219]
  v_cvt_pk_bf16_f32 v235, v230, v231
  v_mfma_f32_16x16x32_bf16 v[220:223], a[172:175], v[28:31], v[220:223]
  global_store_dwordx4 v12, v[232:235], s[8:9] sc0 sc1
  s_waitcnt lgkmcnt(10)
  v_mfma_f32_16x16x32_bf16 v[208:211], a[80:83], v[32:35], v[208:211]
  ds_read_b64_tr_b16 v[24:25], v11 offset:14400
  ds_read_b64_tr_b16 v[26:27], v11 offset:15296
  v_mfma_f32_16x16x32_bf16 v[212:215], a[112:115], v[32:35], v[212:215]
  v_add_u32 v12, s30, v12
  v_mfma_f32_16x16x32_bf16 v[216:219], a[144:147], v[32:35], v[216:219]
  v_pk_mul_f32 v[236:237], v[200:201], s[28:29]
  v_mfma_f32_16x16x32_bf16 v[220:223], a[176:179], v[32:35], v[220:223]
  v_pk_mul_f32 v[238:239], v[202:203], s[28:29]
  s_waitcnt lgkmcnt(10)
  v_mfma_f32_16x16x32_bf16 v[208:211], a[84:87], v[36:39], v[208:211]
  ds_read_b64_tr_b16 v[28:29], v11 offset:21568
  ds_read_b64_tr_b16 v[30:31], v11 offset:22464
  v_mfma_f32_16x16x32_bf16 v[212:215], a[116:119], v[36:39], v[212:215]
  v_pk_mul_f32 v[240:241], v[204:205], s[28:29]
  v_mfma_f32_16x16x32_bf16 v[216:219], a[148:151], v[36:39], v[216:219]
  v_pk_mul_f32 v[242:243], v[206:207], s[28:29]
  v_mfma_f32_16x16x32_bf16 v[220:223], a[180:183], v[36:39], v[220:223]
  v_cvt_pk_bf16_f32 v244, v236, v237
  s_waitcnt lgkmcnt(10)
  v_mfma_f32_16x16x32_bf16 v[208:211], a[88:91], v[40:43], v[208:211]
  ds_read_b64_tr_b16 v[32:33], v11 offset:28736
  ds_read_b64_tr_b16 v[34:35], v11 offset:29632
  v_mfma_f32_16x16x32_bf16 v[212:215], a[120:123], v[40:43], v[212:215]
  v_cvt_pk_bf16_f32 v245, v238, v239
  v_mfma_f32_16x16x32_bf16 v[216:219], a[152:155], v[40:43], v[216:219]
  v_cvt_pk_bf16_f32 v246, v240, v241
  v_mfma_f32_16x16x32_bf16 v[220:223], a[184:187], v[40:43], v[220:223]
  v_cvt_pk_bf16_f32 v247, v242, v243
  s_waitcnt lgkmcnt(10)
  v_mfma_f32_16x16x32_bf16 v[208:211], a[92:95], v[44:47], v[208:211]
  ds_read_b64_tr_b16 v[36:37], v11 offset:35904
  ds_read_b64_tr_b16 v[38:39], v11 offset:36800
  v_mfma_f32_16x16x32_bf16 v[212:215], a[124:127], v[44:47], v[212:215]
  global_store_dwordx4 v13, v[244:247], s[8:9] sc0 sc1
  v_mfma_f32_16x16x32_bf16 v[216:219], a[156:159], v[44:47], v[216:219]
  s_nop 0
  v_add_u32 v13, s30, v13
  v_mfma_f32_16x16x32_bf16 v[220:223], a[188:191], v[44:47], v[220:223]
  s_sub_u32 s30, 458752, s30
  s_waitcnt lgkmcnt(10)
  v_mfma_f32_16x16x32_bf16 v[192:195], a[64:67], v[16:19], 0
  ds_read_b64_tr_b16 v[40:41], v11 offset:43072
  ds_read_b64_tr_b16 v[42:43], v11 offset:43968
  v_mfma_f32_16x16x32_bf16 v[196:199], a[96:99], v[16:19], 0
  v_mfma_f32_16x16x32_bf16 v[200:203], a[128:131], v[16:19], 0
  v_mfma_f32_16x16x32_bf16 v[204:207], a[160:163], v[16:19], 0
  s_waitcnt lgkmcnt(10)
  v_mfma_f32_16x16x32_bf16 v[192:195], a[68:71], v[20:23], v[192:195]
  ds_read_b64_tr_b16 v[44:45], v11 offset:50240
  ds_read_b64_tr_b16 v[46:47], v11 offset:51136
  v_mfma_f32_16x16x32_bf16 v[196:199], a[100:103], v[20:23], v[196:199]
  v_pk_mul_f32 v[224:225], v[208:209], s[28:29]
  v_mfma_f32_16x16x32_bf16 v[200:203], a[132:135], v[20:23], v[200:203]
  v_pk_mul_f32 v[226:227], v[210:211], s[28:29]
  v_mfma_f32_16x16x32_bf16 v[204:207], a[164:167], v[20:23], v[204:207]
  v_pk_mul_f32 v[228:229], v[212:213], s[28:29]
  s_waitcnt lgkmcnt(10)
  v_mfma_f32_16x16x32_bf16 v[192:195], a[72:75], v[24:27], v[192:195]
  ds_read_b64_tr_b16 v[16:17], v11 offset:96
  ds_read_b64_tr_b16 v[18:19], v11 offset:992
  v_mfma_f32_16x16x32_bf16 v[196:199], a[104:107], v[24:27], v[196:199]
  v_pk_mul_f32 v[230:231], v[214:215], s[28:29]
  v_mfma_f32_16x16x32_bf16 v[200:203], a[136:139], v[24:27], v[200:203]
  v_cvt_pk_bf16_f32 v232, v224, v225
  v_mfma_f32_16x16x32_bf16 v[204:207], a[168:171], v[24:27], v[204:207]
  v_cvt_pk_bf16_f32 v233, v226, v227
  s_waitcnt lgkmcnt(10)
  v_mfma_f32_16x16x32_bf16 v[192:195], a[76:79], v[28:31], v[192:195]
  ds_read_b64_tr_b16 v[20:21], v11 offset:7264
  ds_read_b64_tr_b16 v[22:23], v11 offset:8160
  v_mfma_f32_16x16x32_bf16 v[196:199], a[108:111], v[28:31], v[196:199]
  v_cvt_pk_bf16_f32 v234, v228, v229
  v_mfma_f32_16x16x32_bf16 v[200:203], a[140:143], v[28:31], v[200:203]
  v_cvt_pk_bf16_f32 v235, v230, v231
  v_mfma_f32_16x16x32_bf16 v[204:207], a[172:175], v[28:31], v[204:207]
  global_store_dwordx4 v12, v[232:235], s[8:9] sc0 sc1
  s_waitcnt lgkmcnt(10)
  v_mfma_f32_16x16x32_bf16 v[192:195], a[80:83], v[32:35], v[192:195]
  ds_read_b64_tr_b16 v[24:25], v11 offset:14432
  ds_read_b64_tr_b16 v[26:27], v11 offset:15328
  v_mfma_f32_16x16x32_bf16 v[196:199], a[112:115], v[32:35], v[196:199]
  v_add_u32 v12, s30, v12
  v_mfma_f32_16x16x32_bf16 v[200:203], a[144:147], v[32:35], v[200:203]
  v_pk_mul_f32 v[236:237], v[216:217], s[28:29]
  v_mfma_f32_16x16x32_bf16 v[204:207], a[176:179], v[32:35], v[204:207]
  v_pk_mul_f32 v[238:239], v[218:219], s[28:29]
  s_waitcnt lgkmcnt(10)
  v_mfma_f32_16x16x32_bf16 v[192:195], a[84:87], v[36:39], v[192:195]
  ds_read_b64_tr_b16 v[28:29], v11 offset:21600
  ds_read_b64_tr_b16 v[30:31], v11 offset:22496
  v_mfma_f32_16x16x32_bf16 v[196:199], a[116:119], v[36:39], v[196:199]
  v_pk_mul_f32 v[240:241], v[220:221], s[28:29]
  v_mfma_f32_16x16x32_bf16 v[200:203], a[148:151], v[36:39], v[200:203]
  v_pk_mul_f32 v[242:243], v[222:223], s[28:29]
  v_mfma_f32_16x16x32_bf16 v[204:207], a[180:183], v[36:39], v[204:207]
  v_cvt_pk_bf16_f32 v244, v236, v237
  s_waitcnt lgkmcnt(10)
  v_mfma_f32_16x16x32_bf16 v[192:195], a[88:91], v[40:43], v[192:195]
  ds_read_b64_tr_b16 v[32:33], v11 offset:28768
  ds_read_b64_tr_b16 v[34:35], v11 offset:29664
  v_mfma_f32_16x16x32_bf16 v[196:199], a[120:123], v[40:43], v[196:199]
  v_cvt_pk_bf16_f32 v245, v238, v239
  v_mfma_f32_16x16x32_bf16 v[200:203], a[152:155], v[40:43], v[200:203]
  v_cvt_pk_bf16_f32 v246, v240, v241
  v_mfma_f32_16x16x32_bf16 v[204:207], a[184:187], v[40:43], v[204:207]
  v_cvt_pk_bf16_f32 v247, v242, v243
  s_waitcnt lgkmcnt(10)
  v_mfma_f32_16x16x32_bf16 v[192:195], a[92:95], v[44:47], v[192:195]
  ds_read_b64_tr_b16 v[36:37], v11 offset:35936
  ds_read_b64_tr_b16 v[38:39], v11 offset:36832
  v_mfma_f32_16x16x32_bf16 v[196:199], a[124:127], v[44:47], v[196:199]
  global_store_dwordx4 v13, v[244:247], s[8:9] sc0 sc1
  v_mfma_f32_16x16x32_bf16 v[200:203], a[156:159], v[44:47], v[200:203]
  s_nop 0
  v_add_u32 v13, s30, v13
  v_mfma_f32_16x16x32_bf16 v[204:207], a[188:191], v[44:47], v[204:207]
  s_sub_u32 s30, 458752, s30
  s_waitcnt lgkmcnt(10)
  v_mfma_f32_16x16x32_bf16 v[208:211], a[64:67], v[16:19], 0
  ds_read_b64_tr_b16 v[40:41], v11 offset:43104
  ds_read_b64_tr_b16 v[42:43], v11 offset:44000
  v_mfma_f32_16x16x32_bf16 v[212:215], a[96:99], v[16:19], 0
  v_mfma_f32_16x16x32_bf16 v[216:219], a[128:131], v[16:19], 0
  v_mfma_f32_16x16x32_bf16 v[220:223], a[160:163], v[16:19], 0
  s_waitcnt lgkmcnt(10)
  v_mfma_f32_16x16x32_bf16 v[208:211], a[68:71], v[20:23], v[208:211]
  ds_read_b64_tr_b16 v[44:45], v11 offset:50272
  ds_read_b64_tr_b16 v[46:47], v11 offset:51168
  v_mfma_f32_16x16x32_bf16 v[212:215], a[100:103], v[20:23], v[212:215]
  v_pk_mul_f32 v[224:225], v[192:193], s[28:29]
  v_mfma_f32_16x16x32_bf16 v[216:219], a[132:135], v[20:23], v[216:219]
  v_pk_mul_f32 v[226:227], v[194:195], s[28:29]
  v_mfma_f32_16x16x32_bf16 v[220:223], a[164:167], v[20:23], v[220:223]
  v_pk_mul_f32 v[228:229], v[196:197], s[28:29]
  s_waitcnt lgkmcnt(10)
  v_mfma_f32_16x16x32_bf16 v[208:211], a[72:75], v[24:27], v[208:211]
  ds_read_b64_tr_b16 v[16:17], v11 offset:128
  ds_read_b64_tr_b16 v[18:19], v11 offset:1024
  v_mfma_f32_16x16x32_bf16 v[212:215], a[104:107], v[24:27], v[212:215]
  v_pk_mul_f32 v[230:231], v[198:199], s[28:29]
  v_mfma_f32_16x16x32_bf16 v[216:219], a[136:139], v[24:27], v[216:219]
  v_cvt_pk_bf16_f32 v232, v224, v225
  v_mfma_f32_16x16x32_bf16 v[220:223], a[168:171], v[24:27], v[220:223]
  v_cvt_pk_bf16_f32 v233, v226, v227
  s_waitcnt lgkmcnt(10)
  v_mfma_f32_16x16x32_bf16 v[208:211], a[76:79], v[28:31], v[208:211]
  ds_read_b64_tr_b16 v[20:21], v11 offset:7296
  ds_read_b64_tr_b16 v[22:23], v11 offset:8192
  v_mfma_f32_16x16x32_bf16 v[212:215], a[108:111], v[28:31], v[212:215]
  v_cvt_pk_bf16_f32 v234, v228, v229
  v_mfma_f32_16x16x32_bf16 v[216:219], a[140:143], v[28:31], v[216:219]
  v_cvt_pk_bf16_f32 v235, v230, v231
  v_mfma_f32_16x16x32_bf16 v[220:223], a[172:175], v[28:31], v[220:223]
  global_store_dwordx4 v12, v[232:235], s[8:9] sc0 sc1
  s_waitcnt lgkmcnt(10)
  v_mfma_f32_16x16x32_bf16 v[208:211], a[80:83], v[32:35], v[208:211]
  ds_read_b64_tr_b16 v[24:25], v11 offset:14464
  ds_read_b64_tr_b16 v[26:27], v11 offset:15360
  v_mfma_f32_16x16x32_bf16 v[212:215], a[112:115], v[32:35], v[212:215]
  v_add_u32 v12, s30, v12
  v_mfma_f32_16x16x32_bf16 v[216:219], a[144:147], v[32:35], v[216:219]
  v_pk_mul_f32 v[236:237], v[200:201], s[28:29]
  v_mfma_f32_16x16x32_bf16 v[220:223], a[176:179], v[32:35], v[220:223]
  v_pk_mul_f32 v[238:239], v[202:203], s[28:29]
  s_waitcnt lgkmcnt(10)
  v_mfma_f32_16x16x32_bf16 v[208:211], a[84:87], v[36:39], v[208:211]
  ds_read_b64_tr_b16 v[28:29], v11 offset:21632
  ds_read_b64_tr_b16 v[30:31], v11 offset:22528
  v_mfma_f32_16x16x32_bf16 v[212:215], a[116:119], v[36:39], v[212:215]
  v_pk_mul_f32 v[240:241], v[204:205], s[28:29]
  v_mfma_f32_16x16x32_bf16 v[216:219], a[148:151], v[36:39], v[216:219]
  v_pk_mul_f32 v[242:243], v[206:207], s[28:29]
  v_mfma_f32_16x16x32_bf16 v[220:223], a[180:183], v[36:39], v[220:223]
  v_cvt_pk_bf16_f32 v244, v236, v237
  s_waitcnt lgkmcnt(10)
  v_mfma_f32_16x16x32_bf16 v[208:211], a[88:91], v[40:43], v[208:211]
  ds_read_b64_tr_b16 v[32:33], v11 offset:28800
  ds_read_b64_tr_b16 v[34:35], v11 offset:29696
  v_mfma_f32_16x16x32_bf16 v[212:215], a[120:123], v[40:43], v[212:215]
  v_cvt_pk_bf16_f32 v245, v238, v239
  v_mfma_f32_16x16x32_bf16 v[216:219], a[152:155], v[40:43], v[216:219]
  v_cvt_pk_bf16_f32 v246, v240, v241
  v_mfma_f32_16x16x32_bf16 v[220:223], a[184:187], v[40:43], v[220:223]
  v_cvt_pk_bf16_f32 v247, v242, v243
  s_waitcnt lgkmcnt(10)
  v_mfma_f32_16x16x32_bf16 v[208:211], a[92:95], v[44:47], v[208:211]
  ds_read_b64_tr_b16 v[36:37], v11 offset:35968
  ds_read_b64_tr_b16 v[38:39], v11 offset:36864
  v_mfma_f32_16x16x32_bf16 v[212:215], a[124:127], v[44:47], v[212:215]
  global_store_dwordx4 v13, v[244:247], s[8:9] sc0 sc1
  v_mfma_f32_16x16x32_bf16 v[216:219], a[156:159], v[44:47], v[216:219]
  s_nop 0
  v_add_u32 v13, s30, v13
  v_mfma_f32_16x16x32_bf16 v[220:223], a[188:191], v[44:47], v[220:223]
  s_sub_u32 s30, 458752, s30
  s_waitcnt lgkmcnt(10)
  v_mfma_f32_16x16x32_bf16 v[192:195], a[64:67], v[16:19], 0
  ds_read_b64_tr_b16 v[40:41], v11 offset:43136
  ds_read_b64_tr_b16 v[42:43], v11 offset:44032
  v_mfma_f32_16x16x32_bf16 v[196:199], a[96:99], v[16:19], 0
  v_mfma_f32_16x16x32_bf16 v[200:203], a[128:131], v[16:19], 0
  v_mfma_f32_16x16x32_bf16 v[204:207], a[160:163], v[16:19], 0
  s_waitcnt lgkmcnt(10)
  v_mfma_f32_16x16x32_bf16 v[192:195], a[68:71], v[20:23], v[192:195]
  ds_read_b64_tr_b16 v[44:45], v11 offset:50304
  ds_read_b64_tr_b16 v[46:47], v11 offset:51200
  v_mfma_f32_16x16x32_bf16 v[196:199], a[100:103], v[20:23], v[196:199]
  v_pk_mul_f32 v[224:225], v[208:209], s[28:29]
  v_mfma_f32_16x16x32_bf16 v[200:203], a[132:135], v[20:23], v[200:203]
  v_pk_mul_f32 v[226:227], v[210:211], s[28:29]
  v_mfma_f32_16x16x32_bf16 v[204:207], a[164:167], v[20:23], v[204:207]
  v_pk_mul_f32 v[228:229], v[212:213], s[28:29]
  s_waitcnt lgkmcnt(10)
  v_mfma_f32_16x16x32_bf16 v[192:195], a[72:75], v[24:27], v[192:195]
  ds_read_b64_tr_b16 v[16:17], v11 offset:160
  ds_read_b64_tr_b16 v[18:19], v11 offset:1056
  v_mfma_f32_16x16x32_bf16 v[196:199], a[104:107], v[24:27], v[196:199]
  v_pk_mul_f32 v[230:231], v[214:215], s[28:29]
  v_mfma_f32_16x16x32_bf16 v[200:203], a[136:139], v[24:27], v[200:203]
  v_cvt_pk_bf16_f32 v232, v224, v225
  v_mfma_f32_16x16x32_bf16 v[204:207], a[168:171], v[24:27], v[204:207]
  v_cvt_pk_bf16_f32 v233, v226, v227
  s_waitcnt lgkmcnt(10)
  v_mfma_f32_16x16x32_bf16 v[192:195], a[76:79], v[28:31], v[192:195]
  ds_read_b64_tr_b16 v[20:21], v11 offset:7328
  ds_read_b64_tr_b16 v[22:23], v11 offset:8224
  v_mfma_f32_16x16x32_bf16 v[196:199], a[108:111], v[28:31], v[196:199]
  v_cvt_pk_bf16_f32 v234, v228, v229
  v_mfma_f32_16x16x32_bf16 v[200:203], a[140:143], v[28:31], v[200:203]
  v_cvt_pk_bf16_f32 v235, v230, v231
  v_mfma_f32_16x16x32_bf16 v[204:207], a[172:175], v[28:31], v[204:207]
  global_store_dwordx4 v12, v[232:235], s[8:9] sc0 sc1
  s_waitcnt lgkmcnt(10)
  v_mfma_f32_16x16x32_bf16 v[192:195], a[80:83], v[32:35], v[192:195]
  ds_read_b64_tr_b16 v[24:25], v11 offset:14496
  ds_read_b64_tr_b16 v[26:27], v11 offset:15392
  v_mfma_f32_16x16x32_bf16 v[196:199], a[112:115], v[32:35], v[196:199]
  v_add_u32 v12, s30, v12
  v_mfma_f32_16x16x32_bf16 v[200:203], a[144:147], v[32:35], v[200:203]
  v_pk_mul_f32 v[236:237], v[216:217], s[28:29]
  v_mfma_f32_16x16x32_bf16 v[204:207], a[176:179], v[32:35], v[204:207]
  v_pk_mul_f32 v[238:239], v[218:219], s[28:29]
  s_waitcnt lgkmcnt(10)
  v_mfma_f32_16x16x32_bf16 v[192:195], a[84:87], v[36:39], v[192:195]
  ds_read_b64_tr_b16 v[28:29], v11 offset:21664
  ds_read_b64_tr_b16 v[30:31], v11 offset:22560
  v_mfma_f32_16x16x32_bf16 v[196:199], a[116:119], v[36:39], v[196:199]
  v_pk_mul_f32 v[240:241], v[220:221], s[28:29]
  v_mfma_f32_16x16x32_bf16 v[200:203], a[148:151], v[36:39], v[200:203]
  v_pk_mul_f32 v[242:243], v[222:223], s[28:29]
  v_mfma_f32_16x16x32_bf16 v[204:207], a[180:183], v[36:39], v[204:207]
  v_cvt_pk_bf16_f32 v244, v236, v237
  s_waitcnt lgkmcnt(10)
  v_mfma_f32_16x16x32_bf16 v[192:195], a[88:91], v[40:43], v[192:195]
  ds_read_b64_tr_b16 v[32:33], v11 offset:28832
  ds_read_b64_tr_b16 v[34:35], v11 offset:29728
  v_mfma_f32_16x16x32_bf16 v[196:199], a[120:123], v[40:43], v[196:199]
  v_cvt_pk_bf16_f32 v245, v238, v239
  v_mfma_f32_16x16x32_bf16 v[200:203], a[152:155], v[40:43], v[200:203]
  v_cvt_pk_bf16_f32 v246, v240, v241
  v_mfma_f32_16x16x32_bf16 v[204:207], a[184:187], v[40:43], v[204:207]
  v_cvt_pk_bf16_f32 v247, v242, v243
  s_waitcnt lgkmcnt(10)
  v_mfma_f32_16x16x32_bf16 v[192:195], a[92:95], v[44:47], v[192:195]
  ds_read_b64_tr_b16 v[36:37], v11 offset:36000
  ds_read_b64_tr_b16 v[38:39], v11 offset:36896
  v_mfma_f32_16x16x32_bf16 v[196:199], a[124:127], v[44:47], v[196:199]
  global_store_dwordx4 v13, v[244:247], s[8:9] sc0 sc1
  v_mfma_f32_16x16x32_bf16 v[200:203], a[156:159], v[44:47], v[200:203]
  s_nop 0
  v_add_u32 v13, s30, v13
  v_mfma_f32_16x16x32_bf16 v[204:207], a[188:191], v[44:47], v[204:207]
  s_sub_u32 s30, 458752, s30
  s_waitcnt lgkmcnt(10)
  v_mfma_f32_16x16x32_bf16 v[208:211], a[64:67], v[16:19], 0
  ds_read_b64_tr_b16 v[40:41], v11 offset:43168
  ds_read_b64_tr_b16 v[42:43], v11 offset:44064
  v_mfma_f32_16x16x32_bf16 v[212:215], a[96:99], v[16:19], 0
  v_mfma_f32_16x16x32_bf16 v[216:219], a[128:131], v[16:19], 0
  v_mfma_f32_16x16x32_bf16 v[220:223], a[160:163], v[16:19], 0
  s_waitcnt lgkmcnt(10)
  v_mfma_f32_16x16x32_bf16 v[208:211], a[68:71], v[20:23], v[208:211]
  ds_read_b64_tr_b16 v[44:45], v11 offset:50336
  ds_read_b64_tr_b16 v[46:47], v11 offset:51232
  v_mfma_f32_16x16x32_bf16 v[212:215], a[100:103], v[20:23], v[212:215]
  v_pk_mul_f32 v[224:225], v[192:193], s[28:29]
  v_mfma_f32_16x16x32_bf16 v[216:219], a[132:135], v[20:23], v[216:219]
  v_pk_mul_f32 v[226:227], v[194:195], s[28:29]
  v_mfma_f32_16x16x32_bf16 v[220:223], a[164:167], v[20:23], v[220:223]
  v_pk_mul_f32 v[228:229], v[196:197], s[28:29]
  s_waitcnt lgkmcnt(10)
  v_mfma_f32_16x16x32_bf16 v[208:211], a[72:75], v[24:27], v[208:211]
  ds_read_b64_tr_b16 v[16:17], v11 offset:192
  ds_read_b64_tr_b16 v[18:19], v11 offset:1088
  v_mfma_f32_16x16x32_bf16 v[212:215], a[104:107], v[24:27], v[212:215]
  v_pk_mul_f32 v[230:231], v[198:199], s[28:29]
  v_mfma_f32_16x16x32_bf16 v[216:219], a[136:139], v[24:27], v[216:219]
  v_cvt_pk_bf16_f32 v232, v224, v225
  v_mfma_f32_16x16x32_bf16 v[220:223], a[168:171], v[24:27], v[220:223]
  v_cvt_pk_bf16_f32 v233, v226, v227
  s_waitcnt lgkmcnt(10)
  v_mfma_f32_16x16x32_bf16 v[208:211], a[76:79], v[28:31], v[208:211]
  ds_read_b64_tr_b16 v[20:21], v11 offset:7360
  ds_read_b64_tr_b16 v[22:23], v11 offset:8256
  v_mfma_f32_16x16x32_bf16 v[212:215], a[108:111], v[28:31], v[212:215]
  v_cvt_pk_bf16_f32 v234, v228, v229
  v_mfma_f32_16x16x32_bf16 v[216:219], a[140:143], v[28:31], v[216:219]
  v_cvt_pk_bf16_f32 v235, v230, v231
  v_mfma_f32_16x16x32_bf16 v[220:223], a[172:175], v[28:31], v[220:223]
  global_store_dwordx4 v12, v[232:235], s[8:9] sc0 sc1
  s_waitcnt lgkmcnt(10)
  v_mfma_f32_16x16x32_bf16 v[208:211], a[80:83], v[32:35], v[208:211]
  ds_read_b64_tr_b16 v[24:25], v11 offset:14528
  ds_read_b64_tr_b16 v[26:27], v11 offset:15424
  v_mfma_f32_16x16x32_bf16 v[212:215], a[112:115], v[32:35], v[212:215]
  v_add_u32 v12, s30, v12
  v_mfma_f32_16x16x32_bf16 v[216:219], a[144:147], v[32:35], v[216:219]
  v_pk_mul_f32 v[236:237], v[200:201], s[28:29]
  v_mfma_f32_16x16x32_bf16 v[220:223], a[176:179], v[32:35], v[220:223]
  v_pk_mul_f32 v[238:239], v[202:203], s[28:29]
  s_waitcnt lgkmcnt(10)
  v_mfma_f32_16x16x32_bf16 v[208:211], a[84:87], v[36:39], v[208:211]
  ds_read_b64_tr_b16 v[28:29], v11 offset:21696
  ds_read_b64_tr_b16 v[30:31], v11 offset:22592
  v_mfma_f32_16x16x32_bf16 v[212:215], a[116:119], v[36:39], v[212:215]
  v_pk_mul_f32 v[240:241], v[204:205], s[28:29]
  v_mfma_f32_16x16x32_bf16 v[216:219], a[148:151], v[36:39], v[216:219]
  v_pk_mul_f32 v[242:243], v[206:207], s[28:29]
  v_mfma_f32_16x16x32_bf16 v[220:223], a[180:183], v[36:39], v[220:223]
  v_cvt_pk_bf16_f32 v244, v236, v237
  s_waitcnt lgkmcnt(10)
  v_mfma_f32_16x16x32_bf16 v[208:211], a[88:91], v[40:43], v[208:211]
  ds_read_b64_tr_b16 v[32:33], v11 offset:28864
  ds_read_b64_tr_b16 v[34:35], v11 offset:29760
  v_mfma_f32_16x16x32_bf16 v[212:215], a[120:123], v[40:43], v[212:215]
  v_cvt_pk_bf16_f32 v245, v238, v239
  v_mfma_f32_16x16x32_bf16 v[216:219], a[152:155], v[40:43], v[216:219]
  v_cvt_pk_bf16_f32 v246, v240, v241
  v_mfma_f32_16x16x32_bf16 v[220:223], a[184:187], v[40:43], v[220:223]
  v_cvt_pk_bf16_f32 v247, v242, v243
  s_waitcnt lgkmcnt(10)
  v_mfma_f32_16x16x32_bf16 v[208:211], a[92:95], v[44:47], v[208:211]
  ds_read_b64_tr_b16 v[36:37], v11 offset:36032
  ds_read_b64_tr_b16 v[38:39], v11 offset:36928
  v_mfma_f32_16x16x32_bf16 v[212:215], a[124:127], v[44:47], v[212:215]
  global_store_dwordx4 v13, v[244:247], s[8:9] sc0 sc1
  v_mfma_f32_16x16x32_bf16 v[216:219], a[156:159], v[44:47], v[216:219]
  s_nop 0
  v_add_u32 v13, s30, v13
  v_mfma_f32_16x16x32_bf16 v[220:223], a[188:191], v[44:47], v[220:223]
  s_sub_u32 s30, 458752, s30
  s_waitcnt lgkmcnt(10)
  v_mfma_f32_16x16x32_bf16 v[192:195], a[64:67], v[16:19], 0
  ds_read_b64_tr_b16 v[40:41], v11 offset:43200
  ds_read_b64_tr_b16 v[42:43], v11 offset:44096
  v_mfma_f32_16x16x32_bf16 v[196:199], a[96:99], v[16:19], 0
  v_mfma_f32_16x16x32_bf16 v[200:203], a[128:131], v[16:19], 0
  v_mfma_f32_16x16x32_bf16 v[204:207], a[160:163], v[16:19], 0
  s_waitcnt lgkmcnt(10)
  v_mfma_f32_16x16x32_bf16 v[192:195], a[68:71], v[20:23], v[192:195]
  ds_read_b64_tr_b16 v[44:45], v11 offset:50368
  ds_read_b64_tr_b16 v[46:47], v11 offset:51264
  v_mfma_f32_16x16x32_bf16 v[196:199], a[100:103], v[20:23], v[196:199]
  v_pk_mul_f32 v[224:225], v[208:209], s[28:29]
  v_mfma_f32_16x16x32_bf16 v[200:203], a[132:135], v[20:23], v[200:203]
  v_pk_mul_f32 v[226:227], v[210:211], s[28:29]
  v_mfma_f32_16x16x32_bf16 v[204:207], a[164:167], v[20:23], v[204:207]
  v_pk_mul_f32 v[228:229], v[212:213], s[28:29]
  s_waitcnt lgkmcnt(10)
  v_mfma_f32_16x16x32_bf16 v[192:195], a[72:75], v[24:27], v[192:195]
  v_pk_mul_f32 v[230:231], v[214:215], s[28:29]
  v_mfma_f32_16x16x32_bf16 v[196:199], a[104:107], v[24:27], v[196:199]
  v_cvt_pk_bf16_f32 v232, v224, v225
  v_mfma_f32_16x16x32_bf16 v[200:203], a[136:139], v[24:27], v[200:203]
  v_cvt_pk_bf16_f32 v233, v226, v227
  v_mfma_f32_16x16x32_bf16 v[204:207], a[168:171], v[24:27], v[204:207]
  v_cvt_pk_bf16_f32 v234, v228, v229
  s_waitcnt lgkmcnt(8)
  v_mfma_f32_16x16x32_bf16 v[192:195], a[76:79], v[28:31], v[192:195]
  v_cvt_pk_bf16_f32 v235, v230, v231
  v_mfma_f32_16x16x32_bf16 v[196:199], a[108:111], v[28:31], v[196:199]
  global_store_dwordx4 v12, v[232:235], s[8:9] sc0 sc1
  v_mfma_f32_16x16x32_bf16 v[200:203], a[140:143], v[28:31], v[200:203]
  s_nop 0
  v_add_u32 v12, s30, v12
  v_mfma_f32_16x16x32_bf16 v[204:207], a[172:175], v[28:31], v[204:207]
  v_pk_mul_f32 v[236:237], v[216:217], s[28:29]
  s_waitcnt lgkmcnt(6)
  v_mfma_f32_16x16x32_bf16 v[192:195], a[80:83], v[32:35], v[192:195]
  v_pk_mul_f32 v[238:239], v[218:219], s[28:29]
  v_mfma_f32_16x16x32_bf16 v[196:199], a[112:115], v[32:35], v[196:199]
  v_pk_mul_f32 v[240:241], v[220:221], s[28:29]
  v_mfma_f32_16x16x32_bf16 v[200:203], a[144:147], v[32:35], v[200:203]
  v_pk_mul_f32 v[242:243], v[222:223], s[28:29]
  v_mfma_f32_16x16x32_bf16 v[204:207], a[176:179], v[32:35], v[204:207]
  v_cvt_pk_bf16_f32 v244, v236, v237
  s_waitcnt lgkmcnt(4)
  v_mfma_f32_16x16x32_bf16 v[192:195], a[84:87], v[36:39], v[192:195]
  v_cvt_pk_bf16_f32 v245, v238, v239
  v_mfma_f32_16x16x32_bf16 v[196:199], a[116:119], v[36:39], v[196:199]
  v_cvt_pk_bf16_f32 v246, v240, v241
  v_mfma_f32_16x16x32_bf16 v[200:203], a[148:151], v[36:39], v[200:203]
  v_cvt_pk_bf16_f32 v247, v242, v243
  v_mfma_f32_16x16x32_bf16 v[204:207], a[180:183], v[36:39], v[204:207]
  global_store_dwordx4 v13, v[244:247], s[8:9] sc0 sc1
  s_waitcnt lgkmcnt(2)
  v_mfma_f32_16x16x32_bf16 v[192:195], a[88:91], v[40:43], v[192:195]
  v_add_u32 v13, s30, v13
  v_mfma_f32_16x16x32_bf16 v[196:199], a[120:123], v[40:43], v[196:199]
  s_sub_u32 s30, 458752, s30
  v_mfma_f32_16x16x32_bf16 v[200:203], a[152:155], v[40:43], v[200:203]
  v_mfma_f32_16x16x32_bf16 v[204:207], a[184:187], v[40:43], v[204:207]
  s_waitcnt lgkmcnt(0)
  v_mfma_f32_16x16x32_bf16 v[192:195], a[92:95], v[44:47], v[192:195]
  v_mfma_f32_16x16x32_bf16 v[196:199], a[124:127], v[44:47], v[196:199]
  v_mfma_f32_16x16x32_bf16 v[200:203], a[156:159], v[44:47], v[200:203]
  v_mfma_f32_16x16x32_bf16 v[204:207], a[188:191], v[44:47], v[204:207]
  s_nop 4
  v_pk_mul_f32 v[224:225], v[192:193], s[28:29]
  v_pk_mul_f32 v[226:227], v[194:195], s[28:29]
  v_pk_mul_f32 v[228:229], v[196:197], s[28:29]
  v_pk_mul_f32 v[230:231], v[198:199], s[28:29]
  v_cvt_pk_bf16_f32 v232, v224, v225
  v_cvt_pk_bf16_f32 v233, v226, v227
  v_cvt_pk_bf16_f32 v234, v228, v229
  v_cvt_pk_bf16_f32 v235, v230, v231
  global_store_dwordx4 v12, v[232:235], s[8:9] sc0 sc1
  s_nop 1
  v_add_u32 v12, s30, v12
  v_pk_mul_f32 v[236:237], v[200:201], s[28:29]
  v_pk_mul_f32 v[238:239], v[202:203], s[28:29]
  v_pk_mul_f32 v[240:241], v[204:205], s[28:29]
  v_pk_mul_f32 v[242:243], v[206:207], s[28:29]
  v_cvt_pk_bf16_f32 v244, v236, v237
  v_cvt_pk_bf16_f32 v245, v238, v239
  v_cvt_pk_bf16_f32 v246, v240, v241
  v_cvt_pk_bf16_f32 v247, v242, v243
  global_store_dwordx4 v13, v[244:247], s[8:9] sc0 sc1
  s_nop 1
  v_add_u32 v13, s30, v13
  s_sub_u32 s30, 458752, s30
  s_nop 1
  s_branch P1E1_11
P1E1_11:
  s_mov_b64 exec, -1
  v_mov_b32 v3, 128
  s_mov_b32 s13, 65536
  s_nop 1
P1P_25:
  global_load_dword v5, v3, s[6:7] sc0 sc1
  s_waitcnt vmcnt(0) lgkmcnt(0)
  v_cmp_eq_u32 vcc, 0, v5
  s_nop 4
  s_cbranch_vccz P1D_26
  s_sub_u32 s13, s13, 1
  s_nop 1
  s_cbranch_scc0 P1P_25
P1D_26:
  s_barrier
  s_cmp_lg_u32 s10, 0
  s_nop 1
  s_cbranch_scc1 P1SK_24
  s_lshl_b32 s12, s3, 2
  s_add_u32 s12, s12, 103366656
  v_mov_b32 v3, s12
  v_mov_b32 v4, 2
  s_mov_b64 exec, 1
  global_store_dword v3, v4, s[8:9] sc0 sc1
  s_mov_b64 exec, -1
  s_nop 1
P1SK_24:
  s_cmp_lg_u32 s10, 3
  s_nop 1
  s_cbranch_scc1 EDONE_4
  s_mov_b64 exec, 1
  s_mov_b32 s11, s92
  s_mov_b32 s13, s93
  s_mov_b32 s14, -1
  v_mov_b32 v3, 64
  s_cmp_ge_u32 s13, 32
  s_nop 1
  s_cbranch_scc1 EPUB_5
  s_branch EPOLL_6
  s_cmp_lg_u32 s10, 0
  s_nop 1
  s_cbranch_scc1 EDONE_4
  s_mov_b64 exec, 1
  s_getreg_b32 s11, hwreg(HW_REG_XCC_ID, 0, 4)
  s_lshl_b32 s12, s11, 2
  v_mov_b32 v3, s12
  v_mov_b32 v4, 1
  global_atomic_add v5, v3, v4, s[6:7] sc0 sc1
  s_waitcnt vmcnt(0)
  v_readfirstlane_b32 s13, v5
  s_add_u32 s11, s11, 1
  s_mov_b32 s14, -1
  v_mov_b32 v3, 64
  s_cmp_ge_u32 s13, 32
  s_nop 1
  s_cbranch_scc1 EPUB_5
  s_cmp_lg_u32 s13, 31
  s_nop 1
  s_cbranch_scc1 EPOLL_6
  v_mov_b32 v4, s11
  v_mov_b32 v5, 0
  global_atomic_cmpswap v6, v3, v[4:5], s[6:7] sc0 sc1
  s_waitcnt vmcnt(0)
  s_nop 1
EPOLL_6:
  s_mov_b32 s15, 512
  s_nop 1
EPL_7:
  global_load_dword v6, v3, s[6:7] sc0 sc1
  s_waitcnt vmcnt(0)
  v_readfirstlane_b32 s16, v6
  s_cmp_lg_u32 s16, 0
  s_nop 3
  s_cbranch_scc1 EGOT_8
  s_sub_u32 s15, s15, 1
  s_nop 1
  s_cbranch_scc0 EPL_7
  v_mov_b32 v4, 84
  v_mov_b32 v5, 1
  global_atomic_add v4, v5, s[6:7] sc1
  v_mov_b32 v4, 99
  v_mov_b32 v5, 0
  global_atomic_cmpswap v6, v3, v[4:5], s[6:7] sc0 sc1
  s_waitcnt vmcnt(0)
  v_readfirstlane_b32 s16, v6
  s_cmp_lg_u32 s16, 0
  s_nop 3
  s_cbranch_scc1 EGOT_8
  s_mov_b32 s16, 99
  s_nop 1
EGOT_8:
  s_cmp_eq_u32 s16, s11
  s_cselect_b32 s14, s13, -1
  s_cmp_lg_u32 s16, 99
  s_nop 1
  s_cbranch_scc1 EPUB_5
  v_mov_b32 v3, 68
  v_mov_b32 v4, 1
  global_atomic_add v5, v3, v4, s[6:7] sc0 sc1
  s_waitcnt vmcnt(0)
  v_readfirstlane_b32 s13, v5
  s_or_b32 s14, s13, 0x100
  s_cmp_ge_u32 s13, 32
  s_cselect_b32 s14, -1, s14
  s_nop 1
EPUB_5:
  v_mov_b32 v3, 86064
  v_mov_b32 v4, s14
  ds_write_b32 v3, v4
  s_waitcnt lgkmcnt(0)
  s_mov_b64 exec, -1
  s_nop 1
EDONE_4:
  s_barrier
  v_mov_b32 v3, 86064
  ds_read_b32 v4, v3
  s_waitcnt lgkmcnt(0)
  v_readfirstlane_b32 s14, v4
  s_cmp_eq_u32 s14, -1
  s_nop 3
  s_cbranch_scc1 CWORK_3
  s_lshr_b32 s17, s14, 8
  s_and_b32 s14, s14, 0xff
  s_cmp_lg_u32 s10, 0
  s_nop 1
  s_cbranch_scc1 FWD_28
  s_cmp_ge_u32 s14, 30
  s_nop 1
  s_cbranch_scc1 FWD_28
  s_mov_b32 s19, 65536
  s_cmp_ge_u32 s14, 16
  s_nop 1
  s_cbranch_scc1 FWB_29
  s_and_b32 s20, s14, 7
  s_lshr_b32 s21, s14, 3
  s_lshl_b32 s21, s21, 6
  s_add_u32 s20, s20, s21
  v_and_b32 v0, 7, v2
  v_lshl_add_u32 v0, v0, 3, s20
  s_nop 1
  s_branch FWG_30
FWB_29:
  s_sub_u32 s20, s14, 16
  s_lshl_b32 s20, s20, 1
  v_lshrrev_b32 v0, 5, v2
  v_add_u32 v0, s20, v0
  v_mul_u32_u24 v0, 9363, v0
  v_lshrrev_b32 v0, 16, v0
  v_lshlrev_b32 v0, 4, v0
  v_and_b32 v1, 15, v2
  v_add_u32 v0, v0, v1
  v_bfe_u32 v1, v2, 4, 1
  v_lshl_add_u32 v0, v1, 6, v0
  v_add_u32 v0, 128, v0
  s_nop 1
FWG_30:
  v_lshlrev_b32 v0, 2, v0
  v_add_u32 v0, 103366656, v0
  s_nop 1
FWP_27:
  global_load_dword v1, v0, s[8:9] sc0 sc1
  s_waitcnt vmcnt(0)
  v_cmp_eq_u32 vcc, 0, v1
  s_nop 4
  s_cbranch_vccz FWD_28
  s_sub_u32 s19, s19, 1
  s_nop 1
  s_cbranch_scc0 FWP_27
FWD_28:
  s_barrier
  s_cmp_ge_u32 s14, 30
  s_nop 1
  s_cbranch_scc1 PROLE_31
  s_cmp_ge_u32 s14, 16
  s_nop 1
  s_cbranch_scc1 BROLE_2
  s_mul_i32 s19, s14, 401408
  s_mul_i32 s20, s10, 100352
  s_add_u32 s19, s19, s20
  v_lshlrev_b32 v96, 4, v2
  v_add_u32 v3, s19, v96
  s_add_u32 s19, s10, 0
  s_cmp_ge_u32 s19, 7
  s_cselect_b32 s31, 7, 0
  s_sub_u32 s19, s19, s31
  s_lshl_b32 s19, s19, 11
  v_add_u32 v97, s19, v3
  s_add_u32 s20, s8, 1835008
  s_addc_u32 s21, s9, 0
  global_load_dwordx4 a[0:3], v97, s[20:21] offset:0
  global_load_dwordx4 a[4:7], v97, s[20:21] offset:1024
  s_add_u32 s20, s20, 14336
  s_addc_u32 s21, s21, 0
  global_load_dwordx4 a[56:59], v97, s[20:21] offset:0
  global_load_dwordx4 a[60:63], v97, s[20:21] offset:1024
  s_add_u32 s20, s20, 14336
  s_addc_u32 s21, s21, 0
  global_load_dwordx4 a[112:115], v97, s[20:21] offset:0
  global_load_dwordx4 a[116:119], v97, s[20:21] offset:1024
  s_add_u32 s20, s20, 14336
  s_addc_u32 s21, s21, 0
  global_load_dwordx4 a[168:171], v97, s[20:21] offset:0
  global_load_dwordx4 a[172:175], v97, s[20:21] offset:1024
  s_add_u32 s20, s20, 14336
  s_addc_u32 s21, s21, 0
  global_load_dwordx4 a[224:227], v97, s[20:21] offset:0
  global_load_dwordx4 a[228:231], v97, s[20:21] offset:1024
  s_add_u32 s20, s20, 14336
  s_addc_u32 s21, s21, 0
  global_load_dwordx4 v[144:147], v97, s[20:21] offset:0
  global_load_dwordx4 v[148:151], v97, s[20:21] offset:1024
  s_add_u32 s20, s20, 14336
  s_addc_u32 s21, s21, 0
  global_load_dwordx4 v[200:203], v97, s[20:21] offset:0
  global_load_dwordx4 v[204:207], v97, s[20:21] offset:1024
  s_waitcnt vmcnt(28)
  s_add_u32 s19, s10, 4
  s_cmp_ge_u32 s19, 7
  s_cselect_b32 s31, 7, 0
  s_sub_u32 s19, s19, s31
  s_lshl_b32 s19, s19, 11
  v_add_u32 v97, s19, v3
  s_add_u32 s20, s8, 1835008
  s_addc_u32 s21, s9, 0
  global_load_dwordx4 a[8:11], v97, s[20:21] offset:0
  global_load_dwordx4 a[12:15], v97, s[20:21] offset:1024
  s_add_u32 s20, s20, 14336
  s_addc_u32 s21, s21, 0
  global_load_dwordx4 a[64:67], v97, s[20:21] offset:0
  global_load_dwordx4 a[68:71], v97, s[20:21] offset:1024
  s_add_u32 s20, s20, 14336
  s_addc_u32 s21, s21, 0
  global_load_dwordx4 a[120:123], v97, s[20:21] offset:0
  global_load_dwordx4 a[124:127], v97, s[20:21] offset:1024
  s_add_u32 s20, s20, 14336
  s_addc_u32 s21, s21, 0
  global_load_dwordx4 a[176:179], v97, s[20:21] offset:0
  global_load_dwordx4 a[180:183], v97, s[20:21] offset:1024
  s_add_u32 s20, s20, 14336
  s_addc_u32 s21, s21, 0
  global_load_dwordx4 a[232:235], v97, s[20:21] offset:0
  global_load_dwordx4 a[236:239], v97, s[20:21] offset:1024
  s_add_u32 s20, s20, 14336
  s_addc_u32 s21, s21, 0
  global_load_dwordx4 v[152:155], v97, s[20:21] offset:0
  global_load_dwordx4 v[156:159], v97, s[20:21] offset:1024
  s_add_u32 s20, s20, 14336
  s_addc_u32 s21, s21, 0
  global_load_dwordx4 v[208:211], v97, s[20:21] offset:0
  global_load_dwordx4 v[212:215], v97, s[20:21] offset:1024
  s_waitcnt vmcnt(28)
  s_add_u32 s19, s10, 1
  s_cmp_ge_u32 s19, 7
  s_cselect_b32 s31, 7, 0
  s_sub_u32 s19, s19, s31
  s_lshl_b32 s19, s19, 11
  v_add_u32 v97, s19, v3
  s_add_u32 s20, s8, 1835008
  s_addc_u32 s21, s9, 0
  global_load_dwordx4 a[16:19], v97, s[20:21] offset:0
  global_load_dwordx4 a[20:23], v97, s[20:21] offset:1024
  s_add_u32 s20, s20, 14336
  s_addc_u32 s21, s21, 0
  global_load_dwordx4 a[72:75], v97, s[20:21] offset:0
  global_load_dwordx4 a[76:79], v97, s[20:21] offset:1024
  s_add_u32 s20, s20, 14336
  s_addc_u32 s21, s21, 0
  global_load_dwordx4 a[128:131], v97, s[20:21] offset:0
  global_load_dwordx4 a[132:135], v97, s[20:21] offset:1024
  s_add_u32 s20, s20, 14336
  s_addc_u32 s21, s21, 0
  global_load_dwordx4 a[184:187], v97, s[20:21] offset:0
  global_load_dwordx4 a[188:191], v97, s[20:21] offset:1024
  s_add_u32 s20, s20, 14336
  s_addc_u32 s21, s21, 0
  global_load_dwordx4 a[240:243], v97, s[20:21] offset:0
  global_load_dwordx4 a[244:247], v97, s[20:21] offset:1024
  s_add_u32 s20, s20, 14336
  s_addc_u32 s21, s21, 0
  global_load_dwordx4 v[160:163], v97, s[20:21] offset:0
  global_load_dwordx4 v[164:167], v97, s[20:21] offset:1024
  s_add_u32 s20, s20, 14336
  s_addc_u32 s21, s21, 0
  global_load_dwordx4 v[216:219], v97, s[20:21] offset:0
  global_load_dwordx4 v[220:223], v97, s[20:21] offset:1024
  s_waitcnt vmcnt(28)
  s_add_u32 s19, s10, 5
  s_cmp_ge_u32 s19, 7
  s_cselect_b32 s31, 7, 0
  s_sub_u32 s19, s19, s31
  s_lshl_b32 s19, s19, 11
  v_add_u32 v97, s19, v3
  s_add_u32 s20, s8, 1835008
  s_addc_u32 s21, s9, 0
  global_load_dwordx4 a[24:27], v97, s[20:21] offset:0
  global_load_dwordx4 a[28:31], v97, s[20:21] offset:1024
  s_add_u32 s20, s20, 14336
  s_addc_u32 s21, s21, 0
  global_load_dwordx4 a[80:83], v97, s[20:21] offset:0
  global_load_dwordx4 a[84:87], v97, s[20:21] offset:1024
  s_add_u32 s20, s20, 14336
  s_addc_u32 s21, s21, 0
  global_load_dwordx4 a[136:139], v97, s[20:21] offset:0
  global_load_dwordx4 a[140:143], v97, s[20:21] offset:1024
  s_add_u32 s20, s20, 14336
  s_addc_u32 s21, s21, 0
  global_load_dwordx4 a[192:195], v97, s[20:21] offset:0
  global_load_dwordx4 a[196:199], v97, s[20:21] offset:1024
  s_add_u32 s20, s20, 14336
  s_addc_u32 s21, s21, 0
  global_load_dwordx4 a[248:251], v97, s[20:21] offset:0
  global_load_dwordx4 a[252:255], v97, s[20:21] offset:1024
  s_add_u32 s20, s20, 14336
  s_addc_u32 s21, s21, 0
  global_load_dwordx4 v[168:171], v97, s[20:21] offset:0
  global_load_dwordx4 v[172:175], v97, s[20:21] offset:1024
  s_add_u32 s20, s20, 14336
  s_addc_u32 s21, s21, 0
  global_load_dwordx4 v[224:227], v97, s[20:21] offset:0
  global_load_dwordx4 v[228:231], v97, s[20:21] offset:1024
  s_waitcnt vmcnt(28)
  s_add_u32 s19, s10, 2
  s_cmp_ge_u32 s19, 7
  s_cselect_b32 s31, 7, 0
  s_sub_u32 s19, s19, s31
  s_lshl_b32 s19, s19, 11
  v_add_u32 v97, s19, v3
  s_add_u32 s20, s8, 1835008
  s_addc_u32 s21, s9, 0
  global_load_dwordx4 a[32:35], v97, s[20:21] offset:0
  global_load_dwordx4 a[36:39], v97, s[20:21] offset:1024
  s_add_u32 s20, s20, 14336
  s_addc_u32 s21, s21, 0
  global_load_dwordx4 a[88:91], v97, s[20:21] offset:0
  global_load_dwordx4 a[92:95], v97, s[20:21] offset:1024
  s_add_u32 s20, s20, 14336
  s_addc_u32 s21, s21, 0
  global_load_dwordx4 a[144:147], v97, s[20:21] offset:0
  global_load_dwordx4 a[148:151], v97, s[20:21] offset:1024
  s_add_u32 s20, s20, 14336
  s_addc_u32 s21, s21, 0
  global_load_dwordx4 a[200:203], v97, s[20:21] offset:0
  global_load_dwordx4 a[204:207], v97, s[20:21] offset:1024
  s_add_u32 s20, s20, 14336
  s_addc_u32 s21, s21, 0
  global_load_dwordx4 v[120:123], v97, s[20:21] offset:0
  global_load_dwordx4 v[124:127], v97, s[20:21] offset:1024
  s_add_u32 s20, s20, 14336
  s_addc_u32 s21, s21, 0
  global_load_dwordx4 v[176:179], v97, s[20:21] offset:0
  global_load_dwordx4 v[180:183], v97, s[20:21] offset:1024
  s_add_u32 s20, s20, 14336
  s_addc_u32 s21, s21, 0
  global_load_dwordx4 v[232:235], v97, s[20:21] offset:0
  global_load_dwordx4 v[236:239], v97, s[20:21] offset:1024
  s_waitcnt vmcnt(28)
  s_add_u32 s19, s10, 6
  s_cmp_ge_u32 s19, 7
  s_cselect_b32 s31, 7, 0
  s_sub_u32 s19, s19, s31
  s_lshl_b32 s19, s19, 11
  v_add_u32 v97, s19, v3
  s_add_u32 s20, s8, 1835008
  s_addc_u32 s21, s9, 0
  global_load_dwordx4 a[40:43], v97, s[20:21] offset:0
  global_load_dwordx4 a[44:47], v97, s[20:21] offset:1024
  s_add_u32 s20, s20, 14336
  s_addc_u32 s21, s21, 0
  global_load_dwordx4 a[96:99], v97, s[20:21] offset:0
  global_load_dwordx4 a[100:103], v97, s[20:21] offset:1024
  s_add_u32 s20, s20, 14336
  s_addc_u32 s21, s21, 0
  global_load_dwordx4 a[152:155], v97, s[20:21] offset:0
  global_load_dwordx4 a[156:159], v97, s[20:21] offset:1024
  s_add_u32 s20, s20, 14336
  s_addc_u32 s21, s21, 0
  global_load_dwordx4 a[208:211], v97, s[20:21] offset:0
  global_load_dwordx4 a[212:215], v97, s[20:21] offset:1024
  s_add_u32 s20, s20, 14336
  s_addc_u32 s21, s21, 0
  global_load_dwordx4 v[128:131], v97, s[20:21] offset:0
  global_load_dwordx4 v[132:135], v97, s[20:21] offset:1024
  s_add_u32 s20, s20, 14336
  s_addc_u32 s21, s21, 0
  global_load_dwordx4 v[184:187], v97, s[20:21] offset:0
  global_load_dwordx4 v[188:191], v97, s[20:21] offset:1024
  s_add_u32 s20, s20, 14336
  s_addc_u32 s21, s21, 0
  global_load_dwordx4 v[240:243], v97, s[20:21] offset:0
  global_load_dwordx4 v[244:247], v97, s[20:21] offset:1024
  s_waitcnt vmcnt(28)
  s_add_u32 s19, s10, 3
  s_cmp_ge_u32 s19, 7
  s_cselect_b32 s31, 7, 0
  s_sub_u32 s19, s19, s31
  s_lshl_b32 s19, s19, 11
  v_add_u32 v97, s19, v3
  s_add_u32 s20, s8, 1835008
  s_addc_u32 s21, s9, 0
  global_load_dwordx4 a[48:51], v97, s[20:21] offset:0
  global_load_dwordx4 a[52:55], v97, s[20:21] offset:1024
  s_add_u32 s20, s20, 14336
  s_addc_u32 s21, s21, 0
  global_load_dwordx4 a[104:107], v97, s[20:21] offset:0
  global_load_dwordx4 a[108:111], v97, s[20:21] offset:1024
  s_add_u32 s20, s20, 14336
  s_addc_u32 s21, s21, 0
  global_load_dwordx4 a[160:163], v97, s[20:21] offset:0
  global_load_dwordx4 a[164:167], v97, s[20:21] offset:1024
  s_add_u32 s20, s20, 14336
  s_addc_u32 s21, s21, 0
  global_load_dwordx4 a[216:219], v97, s[20:21] offset:0
  global_load_dwordx4 a[220:223], v97, s[20:21] offset:1024
  s_add_u32 s20, s20, 14336
  s_addc_u32 s21, s21, 0
  global_load_dwordx4 v[136:139], v97, s[20:21] offset:0
  global_load_dwordx4 v[140:143], v97, s[20:21] offset:1024
  s_add_u32 s20, s20, 14336
  s_addc_u32 s21, s21, 0
  global_load_dwordx4 v[192:195], v97, s[20:21] offset:0
  global_load_dwordx4 v[196:199], v97, s[20:21] offset:1024
  s_add_u32 s20, s20, 14336
  s_addc_u32 s21, s21, 0
  global_load_dwordx4 v[248:251], v97, s[20:21] offset:0
  global_load_dwordx4 v[252:255], v97, s[20:21] offset:1024
  s_waitcnt vmcnt(28)
  v_lshrrev_b32 v0, 4, v2
  v_and_b32 v1, 15, v2
  v_and_b32 v74, 7, v2
  s_lshl_b32 s19, s10, 10
  v_add_u32 v104, s19, v96
  v_mov_b32 v106, v104
  s_add_u32 s19, s10, 4
  s_cmp_eq_u32 s19, 7
  s_cselect_b32 s19, 0, s19
  s_lshl_b32 s19, s19, 10
  v_add_u32 v105, s19, v96
  s_mul_i32 s19, s10, 1792
  v_lshlrev_b32 v98, 4, v74
  v_add_u32 v98, s19, v98
  v_lshl_add_u32 v107, v0, 7, v98
  v_lshrrev_b32 v97, 1, v0
  v_lshl_add_u32 v108, v97, 7, v98
  v_and_b32 v97, 1, v0
  v_lshl_add_u32 v108, v97, 3, v108
  v_add_u32 v108, 1536, v108
  s_mul_i32 s19, s10, 7168
  v_add_u32 v109, s19, v96
  v_add_u32 v110, 4096, v109
  s_add_u32 s26, s19, 40960
  s_mul_i32 s19, s10, 3584
  s_add_u32 s19, s19, 12288
  v_lshlrev_b32 v98, 5, v1
  v_lshl_add_u32 v98, v0, 3, v98
  v_add_u32 v111, s19, v98
  v_lshlrev_b32 v98, 3, v1
  v_lshl_add_u32 v98, v0, 8, v98
  v_add_u32 v112, s19, v98
  v_lshlrev_b32 v98, 3, v2
  v_add_u32 v98, 3072, v98
  v_add_u32 v113, s19, v98
  s_mul_i32 s19, s10, 3072
  s_add_u32 s19, s19, 28672
  v_add_u32 v114, s19, v96
  v_and_b32 v74, 1, v2
  v_lshl_add_u32 v74, v0, 1, v74
  v_bfe_u32 v75, v2, 1, 3
  v_lshrrev_b32 v96, 2, v75
  v_and_b32 v97, 3, v75
  v_lshlrev_b32 v98, 4, v74
  v_lshl_add_u32 v99, v96, 10, v98
  v_lshl_add_u32 v99, v97, 8, v99
  v_add_u32 v115, 29696, v99
  v_lshl_add_u32 v99, v96, 8, v98
  v_lshl_add_u32 v99, v97, 2, v99
  v_add_u32 v116, 28672, v99
  s_lshr_b32 s19, s14, 1
  s_lshl_b32 s19, s19, 10
  s_and_b32 s20, s14, 1
  s_lshl_b32 s31, s20, 7
  s_add_u32 s19, s19, s31
  v_lshl_add_u32 v99, v97, 8, v98
  v_lshl_add_u32 v99, v96, 3, v99
  v_add_u32 v117, s19, v99
  s_lshr_b32 s19, s14, 2
  s_lshl_b32 s19, s19, 9
  s_bfe_u32 s31, s14, 0x10001
  s_lshl_b32 s31, s31, 7
  s_add_u32 s19, s19, s31
  s_lshl_b32 s20, s20, 3
  s_add_u32 s19, s19, s20
  s_add_u32 s19, s19, 8192
  v_lshl_add_u32 v99, v96, 8, v98
  v_and_b32 v97, 2, v75
  v_lshl_add_u32 v99, v97, 1, v99
  v_add_u32 v118, s19, v99
  v_and_b32 v96, 8, v2
  v_mov_b32 v119, 0x4444
  v_mov_b32 v97, 0xeeee
  v_cmp_ne_u32 vcc, 0, v96
  s_nop 1
  v_cndmask_b32 v119, v119, v97, vcc
  s_lshl_b32 s31, s10, 2
  s_add_u32 s31, s31, 11264
  v_mov_b32 v0, s31
  v_mov_b32 v1, 0
  ds_write_b32 v0, v1
  s_mov_b32 s32, 0x33333333
  s_mov_b32 s33, 0x33333333
  v_lshrrev_b32 v96, 2, v75
  v_and_b32 v97, 3, v75
  v_lshl_add_u32 v99, v97, 8, v98
  v_lshl_add_u32 v99, v96, 3, v99
  v_add_u32 v115, 29696, v99
  s_lshl_b32 s19, s14, 9
  v_bfe_u32 v97, v75, 1, 1
  v_and_b32 v100, 1, v75
  v_lshl_add_u32 v99, v97, 8, v98
  v_lshl_add_u32 v99, v96, 7, v99
  v_lshl_add_u32 v99, v100, 3, v99
  v_add_u32 v117, s19, v99
  s_lshr_b32 s19, s14, 1
  s_lshl_b32 s19, s19, 8
  s_and_b32 s20, s14, 1
  s_lshl_b32 s20, s20, 2
  s_add_u32 s19, s19, s20
  s_add_u32 s19, s19, 8192
  v_lshl_add_u32 v99, v97, 7, v98
  v_lshl_add_u32 v99, v96, 3, v99
  v_add_u32 v118, s19, v99
  s_movk_i32 s21, 28672
  v_lshrrev_b32 v98, 5, v2
  s_lshl_b32 s19, s10, 1
  v_add_u32 v98, s19, v98
  v_lshlrev_b32 v98, 4, v98
  v_and_b32 v96, 1, v2
  v_bfe_u32 v97, v2, 1, 1
  v_bfe_u32 v100, v2, 2, 1
  v_bfe_u32 v101, v2, 3, 1
  v_and_b32 v102, 16, v2
  v_cmp_ne_u32 vcc, 0, v102
  v_lshl_add_u32 v99, v96, 3, v98
  v_bfe_u32 v102, v2, 1, 3
  v_add_u32 v102, 4, v102
  v_cndmask_b32 v102, v102, v97, vcc
  v_mul_u32_u24 v102, 272, v102
  v_add3_u32 v115, v99, v102, s21
  s_mul_i32 s19, s10, 3584
  s_add_u32 s19, s19, 28672
  v_lshrrev_b32 v99, 4, v2
  v_mul_u32_u24 v99, 272, v99
  v_and_b32 v102, 15, v2
  v_lshl_add_u32 v99, v102, 4, v99
  v_add_u32 v114, s19, v99
  v_add_u32 v116, 128, v115
  v_lshl_add_u32 v99, v96, 7, v98
  v_lshl_add_u32 v99, v97, 3, v99
  s_lshl_b32 s19, s14, 9
  v_lshlrev_b32 v102, 8, v100
  v_lshl_add_u32 v102, v101, 2, v102
  v_add_u32 v102, s19, v102
  s_lshr_b32 s19, s14, 1
  s_lshl_b32 s19, s19, 8
  s_and_b32 s20, s14, 1
  s_lshl_b32 s20, s20, 2
  s_add_u32 s19, s19, s20
  s_add_u32 s19, s19, 8192
  v_mov_b32 v103, s19
  v_cndmask_b32 v102, v102, v103, vcc
  v_add_u32 v117, v99, v102
  v_lshrrev_b32 v99, 5, v2
  v_lshlrev_b32 v99, 4, v99
  v_lshl_add_u32 v99, v96, 5, v99
  v_lshl_add_u32 v99, v97, 3, v99
  s_lshl_b32 s20, s10, 6
  v_add3_u32 v117, v99, v102, s20
  s_mov_b32 s32, 0x000fffff
  s_mov_b32 s33, 0x000fffff
  s_add_u32 s22, s8, 85196800
  s_addc_u32 s23, s9, 0
  s_add_u32 s24, s8, 101474304
  s_addc_u32 s25, s9, 0
  s_add_u32 s28, s8, 85663744
  s_addc_u32 s29, s9, 0
  s_cmp_lg_u32 s10, 0
  s_nop 1
  s_cbranch_scc1 GOD_33
  s_mov_b32 s19, 65536
  v_mbcnt_lo_u32_b32 v0, -1, 0
  v_mbcnt_hi_u32_b32 v0, -1, v0
  v_lshlrev_b32 v0, 4, v0
  v_add_u32 v0, 103366656, v0
  s_nop 1
GOP_32:
  global_load_dwordx4 v[4:7], v0, s[8:9] sc0 sc1
  s_waitcnt vmcnt(0)
  v_min3_u32 v1, v4, v5, v6
  v_min_u32 v1, v1, v7
  v_cmp_gt_u32 vcc, 2, v1
  s_nop 4
  s_cbranch_vccz GOD_33
  s_sleep 3
  s_sub_u32 s19, s19, 1
  s_nop 1
  s_cbranch_scc0 GOP_32
GOD_33:
  s_barrier
  global_load_dwordx4 v[32:35], v110, s[24:25] offset:-4096
  global_load_dwordx4 v[36:39], v110, s[24:25] offset:-3072
  global_load_dwordx4 v[40:43], v110, s[24:25] offset:-2048
  global_load_dwordx4 v[44:47], v110, s[24:25] offset:-1024
  global_load_dwordx4 v[48:51], v110, s[24:25] offset:0
  global_load_dwordx4 v[52:55], v110, s[24:25] offset:1024
  global_load_dwordx4 v[56:59], v110, s[24:25] offset:2048
  s_add_u32 s24, s24, 28672
  s_addc_u32 s25, s25, 0
  s_mov_b32 s18, 1048576
  s_mov_b32 s30, 0
  s_waitcnt vmcnt(0) lgkmcnt(0)
  s_barrier
  s_nop 1
ALOOP_34:
  v_mov_b64 v[68:69], 0
  v_mov_b64 v[70:71], 0
  v_mov_b64 v[72:73], 0
  v_mov_b64 v[74:75], 0
  v_mov_b64 v[76:77], 0
  v_mov_b64 v[78:79], 0
  v_mov_b64 v[80:81], 0
  v_mov_b64 v[82:83], 0
  v_mov_b64 v[84:85], 0
  v_mov_b64 v[86:87], 0
  v_mov_b64 v[88:89], 0
  v_mov_b64 v[90:91], 0
  v_mov_b64 v[92:93], 0
  v_mov_b64 v[94:95], 0
  s_add_u32 s19, s30, 1
  v_mov_b32 v2, s31
  v_mov_b32 v3, s19
  global_load_dwordx4 v[4:7], v104, s[22:23] sc1
  global_load_dwordx4 v[8:11], v105, s[22:23] sc1
  s_waitcnt vmcnt(2)
  s_sleep 1
  global_load_dwordx4 v[60:63], v104, s[22:23] sc1
  global_load_dwordx4 v[64:67], v105, s[22:23] sc1
  s_nop 1
APM_36:
  s_waitcnt vmcnt(2)
  v_max3_u32 v0, v4, v5, v6
  v_max3_u32 v1, v7, v8, v9
  v_max3_u32 v0, v0, v10, v11
  v_max_u32 v0, v0, v1
  v_cmp_eq_u32 vcc, -1, v0
  s_nop 0
  s_cbranch_vccz APMD_37
  global_load_dwordx4 v[4:7], v104, s[22:23] sc1
  global_load_dwordx4 v[8:11], v105, s[22:23] sc1
  s_waitcnt vmcnt(2)
  v_max3_u32 v0, v60, v61, v62
  v_max3_u32 v1, v63, v64, v65
  v_max3_u32 v0, v0, v66, v67
  v_max_u32 v0, v0, v1
  v_cmp_eq_u32 vcc, -1, v0
  s_nop 0
  s_cbranch_vccz AD1_40
  global_load_dwordx4 v[60:63], v104, s[22:23] sc1
  global_load_dwordx4 v[64:67], v105, s[22:23] sc1
  s_sub_u32 s18, s18, 1
  s_nop 1
  s_cbranch_scc0 APM_36
  s_waitcnt vmcnt(0)
  s_nop 1
  s_branch CEXIT_1
AD1_40:
  ds_write_b128 v104, v[60:63]
  ds_write_b128 v104, v[64:67] offset:4096
  ds_write_b128 v104, v[60:63] offset:7168
  ds_write_b32 v2, v3
  v_mov_b32 v2, 11264
  v_smfmac_f32_16x16x64_bf16 v[68:71], v[60:63], a[0:7], v119
  v_smfmac_f32_16x16x64_bf16 v[68:71], v[64:67], a[8:15], v119
  v_smfmac_f32_16x16x64_bf16 v[72:75], v[60:63], a[56:63], v119
  v_smfmac_f32_16x16x64_bf16 v[72:75], v[64:67], a[64:71], v119
  v_smfmac_f32_16x16x64_bf16 v[76:79], v[60:63], a[112:119], v119
  v_smfmac_f32_16x16x64_bf16 v[76:79], v[64:67], a[120:127], v119
  ds_read_b128 v[96:99], v2
  ds_read_b128 v[12:15], v106 offset:1024
  ds_read_b128 v[16:19], v106 offset:5120
  ds_read_b128 v[20:23], v106 offset:2048
  ds_read_b128 v[24:27], v106 offset:6144
  ds_read_b128 v[28:31], v106 offset:3072
  v_smfmac_f32_16x16x64_bf16 v[80:83], v[60:63], a[168:175], v119
  v_smfmac_f32_16x16x64_bf16 v[80:83], v[64:67], a[176:183], v119
  v_smfmac_f32_16x16x64_bf16 v[84:87], v[60:63], a[224:231], v119
  v_smfmac_f32_16x16x64_bf16 v[84:87], v[64:67], a[232:239], v119
  v_smfmac_f32_16x16x64_bf16 v[88:91], v[60:63], v[144:151], v119
  v_smfmac_f32_16x16x64_bf16 v[88:91], v[64:67], v[152:159], v119
  v_smfmac_f32_16x16x64_bf16 v[92:95], v[60:63], v[200:207], v119
  v_smfmac_f32_16x16x64_bf16 v[92:95], v[64:67], v[208:215], v119
  s_waitcnt lgkmcnt(5)
  v_min3_u32 v0, v96, v97, v98
  v_min_u32 v0, v0, v99
  v_cmp_ne_u32 vcc, v0, v3
  s_nop 0
  s_cbranch_vccz AOK_39
  s_branch ART_38
APMD_37:
  ds_write_b128 v104, v[4:7]
  ds_write_b128 v104, v[8:11] offset:4096
  ds_write_b128 v104, v[4:7] offset:7168
  ds_write_b32 v2, v3
  v_mov_b32 v2, 11264
  v_smfmac_f32_16x16x64_bf16 v[68:71], v[4:7], a[0:7], v119
  v_smfmac_f32_16x16x64_bf16 v[68:71], v[8:11], a[8:15], v119
  v_smfmac_f32_16x16x64_bf16 v[72:75], v[4:7], a[56:63], v119
  v_smfmac_f32_16x16x64_bf16 v[72:75], v[8:11], a[64:71], v119
  v_smfmac_f32_16x16x64_bf16 v[76:79], v[4:7], a[112:119], v119
  v_smfmac_f32_16x16x64_bf16 v[76:79], v[8:11], a[120:127], v119
  ds_read_b128 v[96:99], v2
  ds_read_b128 v[12:15], v106 offset:1024
  ds_read_b128 v[16:19], v106 offset:5120
  ds_read_b128 v[20:23], v106 offset:2048
  ds_read_b128 v[24:27], v106 offset:6144
  ds_read_b128 v[28:31], v106 offset:3072
  v_smfmac_f32_16x16x64_bf16 v[80:83], v[4:7], a[168:175], v119
  v_smfmac_f32_16x16x64_bf16 v[80:83], v[8:11], a[176:183], v119
  v_smfmac_f32_16x16x64_bf16 v[84:87], v[4:7], a[224:231], v119
  v_smfmac_f32_16x16x64_bf16 v[84:87], v[8:11], a[232:239], v119
  v_smfmac_f32_16x16x64_bf16 v[88:91], v[4:7], v[144:151], v119
  v_smfmac_f32_16x16x64_bf16 v[88:91], v[8:11], v[152:159], v119
  v_smfmac_f32_16x16x64_bf16 v[92:95], v[4:7], v[200:207], v119
  v_smfmac_f32_16x16x64_bf16 v[92:95], v[8:11], v[208:215], v119
  s_waitcnt lgkmcnt(5)
  v_min3_u32 v0, v96, v97, v98
  v_min_u32 v0, v0, v99
  v_cmp_ne_u32 vcc, v0, v3
  s_nop 0
  s_cbranch_vccz AOK_39
ART_38:
  s_sub_u32 s18, s18, 1
  s_nop 1
  s_cbranch_scc1 CEXIT_1
  s_waitcnt lgkmcnt(0)
  ds_read_b128 v[96:99], v2
  ds_read_b128 v[12:15], v106 offset:1024
  ds_read_b128 v[16:19], v106 offset:5120
  ds_read_b128 v[20:23], v106 offset:2048
  ds_read_b128 v[24:27], v106 offset:6144
  ds_read_b128 v[28:31], v106 offset:3072
  s_waitcnt lgkmcnt(5)
  v_min3_u32 v0, v96, v97, v98
  v_min_u32 v0, v0, v99
  v_cmp_ne_u32 vcc, v0, v3
  s_nop 4
  s_cbranch_vccnz ART_38
AOK_39:
  s_waitcnt lgkmcnt(4)
  v_smfmac_f32_16x16x64_bf16 v[68:71], v[12:15], a[16:23], v119
  s_waitcnt lgkmcnt(3)
  v_smfmac_f32_16x16x64_bf16 v[68:71], v[16:19], a[24:31], v119
  s_waitcnt lgkmcnt(2)
  v_smfmac_f32_16x16x64_bf16 v[68:71], v[20:23], a[32:39], v119
  s_waitcnt lgkmcnt(1)
  v_smfmac_f32_16x16x64_bf16 v[68:71], v[24:27], a[40:47], v119
  s_waitcnt lgkmcnt(0)
  v_smfmac_f32_16x16x64_bf16 v[68:71], v[28:31], a[48:55], v119
  v_smfmac_f32_16x16x64_bf16 v[72:75], v[12:15], a[72:79], v119
  s_waitcnt vmcnt(0)
  ds_read_b128 v[60:63], v107 offset:0
  ds_read_b128 v[64:67], v107 offset:512
  v_smfmac_f32_16x16x64_bf16 v[72:75], v[16:19], a[80:87], v119
  s_nop 2
  v_cvt_pk_bf16_f32 v0, v68, v69
  v_cvt_pk_bf16_f32 v1, v70, v71
  v_smfmac_f32_16x16x64_bf16 v[72:75], v[20:23], a[88:95], v119
  ds_write_b64 v111, v[0:1] offset:0
  v_smfmac_f32_16x16x64_bf16 v[72:75], v[24:27], a[96:103], v119
  v_smfmac_f32_16x16x64_bf16 v[72:75], v[28:31], a[104:111], v119
  ds_read_b128 v[4:7], v107 offset:1024
  ds_read_b64 v[8:9], v108
  v_smfmac_f32_16x16x64_bf16 v[76:79], v[12:15], a[128:135], v119
  v_smfmac_f32_16x16x64_bf16 v[76:79], v[16:19], a[136:143], v119
  s_nop 3
  v_cvt_pk_bf16_f32 v2, v72, v73
  v_cvt_pk_bf16_f32 v3, v74, v75
  v_smfmac_f32_16x16x64_bf16 v[76:79], v[20:23], a[144:151], v119
  ds_write_b64 v111, v[2:3] offset:512
  ds_read_b64_tr_b16 v[96:97], v112 offset:0
  ds_read_b64_tr_b16 v[98:99], v112 offset:128
  v_smfmac_f32_16x16x64_bf16 v[76:79], v[24:27], a[152:159], v119
  v_smfmac_f32_16x16x64_bf16 v[76:79], v[28:31], a[160:167], v119
  v_smfmac_f32_16x16x64_bf16 v[80:83], v[12:15], a[184:191], v119
  v_smfmac_f32_16x16x64_bf16 v[80:83], v[16:19], a[192:199], v119
  s_nop 5
  v_cvt_pk_bf16_f32 v0, v76, v77
  v_cvt_pk_bf16_f32 v1, v78, v79
  v_smfmac_f32_16x16x64_bf16 v[80:83], v[20:23], a[200:207], v119
  ds_write_b64 v111, v[0:1] offset:1024
  v_smfmac_f32_16x16x64_bf16 v[80:83], v[24:27], a[208:215], v119
  v_smfmac_f32_16x16x64_bf16 v[80:83], v[28:31], a[216:223], v119
  v_smfmac_f32_16x16x64_bf16 v[84:87], v[12:15], a[240:247], v119
  v_smfmac_f32_16x16x64_bf16 v[84:87], v[16:19], a[248:255], v119
  s_nop 5
  v_cvt_pk_bf16_f32 v2, v80, v81
  v_cvt_pk_bf16_f32 v3, v82, v83
  v_smfmac_f32_16x16x64_bf16 v[84:87], v[20:23], v[120:127], v119
  ds_write_b64 v111, v[2:3] offset:1536
  ds_read_b64_tr_b16 v[100:101], v112 offset:1024
  ds_read_b64_tr_b16 v[102:103], v112 offset:1152
  v_smfmac_f32_16x16x64_bf16 v[84:87], v[24:27], v[128:135], v119
  v_smfmac_f32_16x16x64_bf16 v[84:87], v[28:31], v[136:143], v119
  v_smfmac_f32_16x16x64_bf16 v[88:91], v[12:15], v[160:167], v119
  v_smfmac_f32_16x16x64_bf16 v[88:91], v[16:19], v[168:175], v119
  s_nop 5
  v_cvt_pk_bf16_f32 v0, v84, v85
  v_cvt_pk_bf16_f32 v1, v86, v87
  v_smfmac_f32_16x16x64_bf16 v[88:91], v[20:23], v[176:183], v119
  ds_write_b64 v111, v[0:1] offset:2048
  v_smfmac_f32_16x16x64_bf16 v[88:91], v[24:27], v[184:191], v119
  v_smfmac_f32_16x16x64_bf16 v[88:91], v[28:31], v[192:199], v119
  v_smfmac_f32_16x16x64_bf16 v[92:95], v[12:15], v[216:223], v119
  v_smfmac_f32_16x16x64_bf16 v[92:95], v[16:19], v[224:231], v119
  s_nop 5
  v_cvt_pk_bf16_f32 v2, v88, v89
  v_cvt_pk_bf16_f32 v3, v90, v91
  v_smfmac_f32_16x16x64_bf16 v[92:95], v[20:23], v[232:239], v119
  ds_write_b64 v111, v[2:3] offset:2560
  ds_read_b64_tr_b16 v[80:81], v112 offset:2048
  ds_read_b64_tr_b16 v[82:83], v112 offset:2176
  v_smfmac_f32_16x16x64_bf16 v[92:95], v[24:27], v[240:247], v119
  v_smfmac_f32_16x16x64_bf16 v[92:95], v[28:31], v[248:255], v119
  s_waitcnt lgkmcnt(3)
  v_mfma_f32_16x16x32_bf16 v[68:71], v[60:63], v[96:99], 0
  v_mfma_f32_16x16x32_bf16 v[72:75], v[32:35], v[96:99], 0
  s_nop 4
  v_cvt_pk_bf16_f32 v0, v92, v93
  v_cvt_pk_bf16_f32 v1, v94, v95
  ds_write_b64 v111, v[0:1] offset:3072
  ds_read_b64_tr_b16 v[84:85], v113
  v_mfma_f32_16x16x32_bf16 v[76:79], v[44:47], v[96:99], 0
  v_mfma_f32_16x16x32_bf16 v[68:71], v[64:67], v[100:103], v[68:71]
  v_mfma_f32_16x16x32_bf16 v[72:75], v[36:39], v[100:103], v[72:75]
  v_mfma_f32_16x16x32_bf16 v[76:79], v[48:51], v[100:103], v[76:79]
  s_waitcnt lgkmcnt(2)
  v_mfma_f32_16x16x32_bf16 v[68:71], v[4:7], v[80:83], v[68:71]
  v_mfma_f32_16x16x32_bf16 v[72:75], v[40:43], v[80:83], v[72:75]
  v_mfma_f32_16x16x32_bf16 v[76:79], v[52:55], v[80:83], v[76:79]
  s_waitcnt lgkmcnt(0)
  v_mfma_f32_16x16x16_bf16 v[68:71], v[8:9], v[84:85], v[68:71]
  v_mfma_f32_16x16x16_bf16 v[72:75], v[56:57], v[84:85], v[72:75]
  v_mfma_f32_16x16x16_bf16 v[76:79], v[58:59], v[84:85], v[76:79]
  s_nop 5
  v_add_f32_dpp v68, v68, v68 row_ror:8 row_mask:0xf bank_mask:0xf
  v_add_f32_dpp v69, v69, v69 row_ror:8 row_mask:0xf bank_mask:0xf
  v_add_f32_dpp v70, v70, v70 row_ror:8 row_mask:0xf bank_mask:0xf
  v_add_f32_dpp v71, v71, v71 row_ror:8 row_mask:0xf bank_mask:0xf
  ds_write_b128 v114, v[68:71] offset:0
  v_add_f32_dpp v72, v72, v72 row_ror:8 row_mask:0xf bank_mask:0xf
  v_add_f32_dpp v73, v73, v73 row_ror:8 row_mask:0xf bank_mask:0xf
  v_add_f32_dpp v74, v74, v74 row_ror:8 row_mask:0xf bank_mask:0xf
  v_add_f32_dpp v75, v75, v75 row_ror:8 row_mask:0xf bank_mask:0xf
  ds_write_b128 v114, v[72:75] offset:1088
  v_add_f32_dpp v76, v76, v76 row_ror:8 row_mask:0xf bank_mask:0xf
  v_add_f32_dpp v77, v77, v77 row_ror:8 row_mask:0xf bank_mask:0xf
  v_add_f32_dpp v78, v78, v78 row_ror:8 row_mask:0xf bank_mask:0xf
  v_add_f32_dpp v79, v79, v79 row_ror:8 row_mask:0xf bank_mask:0xf
  ds_write_b128 v114, v[76:79] offset:2176
  s_waitcnt lgkmcnt(0)
  s_barrier
  ds_read2st64_b64 v[4:7], v115 offset0:0 offset1:7
  ds_read2st64_b64 v[8:11], v115 offset0:14 offset1:21
  s_waitcnt lgkmcnt(1)
  v_pk_add_f32 v[4:5], v[4:5], v[6:7]
  s_waitcnt lgkmcnt(0)
  v_pk_add_f32 v[8:9], v[8:9], v[10:11]
  v_pk_add_f32 v[4:5], v[4:5], v[8:9]
  v_max_f32 v6, v4, v5
  s_nop 1
  v_max_f32_dpp v6, v6, v6 row_ror:1 row_mask:0xf bank_mask:0xf
  s_nop 1
  v_max_f32_dpp v6, v6, v6 row_ror:2 row_mask:0xf bank_mask:0xf
  s_nop 1
  v_max_f32_dpp v6, v6, v6 row_ror:4 row_mask:0xf bank_mask:0xf
  s_nop 1
  v_max_f32_dpp v7, v6, v6 row_ror:8 row_mask:0xf bank_mask:0xf
  v_max_f32_dpp v6, v6, v6 row_ror:8 row_mask:0xf bank_mask:0xf
  s_nop 1
  v_permlane16_swap_b32 v6, v7
  v_max_f32 v6, v6, v7
  v_sub_f32 v4, v4, v6
  v_sub_f32 v5, v5, v6
  v_exp_f32 v4, v4
  v_exp_f32 v5, v5
  s_nop 0
  v_add_f32 v6, v4, v5
  s_nop 1
  v_add_f32_dpp v6, v6, v6 row_ror:1 row_mask:0xf bank_mask:0xf
  s_nop 1
  v_add_f32_dpp v6, v6, v6 row_ror:2 row_mask:0xf bank_mask:0xf
  s_nop 1
  v_add_f32_dpp v6, v6, v6 row_ror:4 row_mask:0xf bank_mask:0xf
  s_nop 1
  v_add_f32_dpp v7, v6, v6 row_ror:8 row_mask:0xf bank_mask:0xf
  v_add_f32_dpp v6, v6, v6 row_ror:8 row_mask:0xf bank_mask:0xf
  s_nop 1
  v_permlane16_swap_b32 v6, v7
  v_fmamk_f32 v6, v7, 0x3e800000, v6
  v_rcp_f32 v6, v6
  s_mov_b64 exec, s[32:33]
  v_mul_f32 v4, v4, v6
  v_mul_f32 v5, v5, v6
  v_cvt_pk_bf16_f32 v4, v4, v5
  v_min_u32 v4, -2, v4
  s_cmp_lg_u32 s17, 0
  s_cbranch_scc1 PS_42
  global_store_dword v117, v4, s[28:29]
  s_nop 1
  s_branch PE_43
PS_42:
  global_store_dword v117, v4, s[28:29] sc0 sc1
  s_nop 1
PE_43:
  s_mov_b64 exec, -1
  s_nop 1
ANOFIN_35:
  s_waitcnt vmcnt(0)
  s_barrier
  global_load_dwordx4 v[32:35], v110, s[24:25] offset:-4096
  global_load_dwordx4 v[36:39], v110, s[24:25] offset:-3072
  global_load_dwordx4 v[40:43], v110, s[24:25] offset:-2048
  global_load_dwordx4 v[44:47], v110, s[24:25] offset:-1024
  global_load_dwordx4 v[48:51], v110, s[24:25] offset:0
  global_load_dwordx4 v[52:55], v110, s[24:25] offset:1024
  global_load_dwordx4 v[56:59], v110, s[24:25] offset:2048
  s_waitcnt lgkmcnt(0)
  s_add_u32 s24, s24, 28672
  s_addc_u32 s25, s25, 0
  s_add_u32 s22, s22, 7168
  s_addc_u32 s23, s23, 0
  s_add_u32 s28, s28, 10240
  s_addc_u32 s29, s29, 0
  s_add_u32 s30, s30, 1
  s_cmp_lt_u32 s30, 63
  s_nop 1
  s_cbranch_scc1 ALOOP_34
  s_branch CEXIT_1
BROLE_2:
  s_sub_u32 s14, s14, 16
  s_mul_i32 s19, s14, 458752
  s_mul_i32 s20, s10, 114688
  s_add_u32 s19, s19, s20
  v_lshlrev_b32 v110, 4, v2
  v_add_u32 v3, s19, v110
  s_mul_i32 s19, s10, 14336
  s_add_u32 s19, s19, 16384
  v_add_u32 v111, s19, v110
  s_add_u32 s20, s8, 8357888
  s_addc_u32 s21, s9, 0
  global_load_dwordx4 v[4:7], v3, s[20:21] offset:0
  global_load_dwordx4 v[8:11], v3, s[20:21] offset:1024
  global_load_dwordx4 v[12:15], v3, s[20:21] offset:2048
  global_load_dwordx4 v[16:19], v3, s[20:21] offset:3072
  s_add_u32 s20, s20, 4096
  s_addc_u32 s21, s21, 0
  global_load_dwordx4 v[20:23], v3, s[20:21] offset:0
  global_load_dwordx4 v[24:27], v3, s[20:21] offset:1024
  global_load_dwordx4 v[28:31], v3, s[20:21] offset:2048
  global_load_dwordx4 v[32:35], v3, s[20:21] offset:3072
  s_add_u32 s20, s20, 4096
  s_addc_u32 s21, s21, 0
  global_load_dwordx4 v[36:39], v3, s[20:21] offset:0
  global_load_dwordx4 v[40:43], v3, s[20:21] offset:1024
  global_load_dwordx4 v[44:47], v3, s[20:21] offset:2048
  global_load_dwordx4 v[48:51], v3, s[20:21] offset:3072
  s_add_u32 s20, s20, 4096
  s_addc_u32 s21, s21, 0
  global_load_dwordx4 v[52:55], v3, s[20:21] offset:0
  global_load_dwordx4 v[56:59], v3, s[20:21] offset:1024
  s_waitcnt vmcnt(13)
  ds_write_b128 v111, v[4:7] offset:0
  s_waitcnt vmcnt(12)
  ds_write_b128 v111, v[8:11] offset:1024
  s_waitcnt vmcnt(11)
  ds_write_b128 v111, v[12:15] offset:2048
  s_waitcnt vmcnt(10)
  ds_write_b128 v111, v[16:19] offset:3072
  s_waitcnt vmcnt(9)
  ds_write_b128 v111, v[20:23] offset:4096
  s_waitcnt vmcnt(8)
  ds_write_b128 v111, v[24:27] offset:5120
  s_waitcnt vmcnt(7)
  ds_write_b128 v111, v[28:31] offset:6144
  s_waitcnt vmcnt(6)
  ds_write_b128 v111, v[32:35] offset:7168
  s_waitcnt vmcnt(5)
  ds_write_b128 v111, v[36:39] offset:8192
  s_waitcnt vmcnt(4)
  ds_write_b128 v111, v[40:43] offset:9216
  s_waitcnt vmcnt(3)
  ds_write_b128 v111, v[44:47] offset:10240
  s_waitcnt vmcnt(2)
  ds_write_b128 v111, v[48:51] offset:11264
  s_waitcnt vmcnt(1)
  ds_write_b128 v111, v[52:55] offset:12288
  s_waitcnt vmcnt(0)
  ds_write_b128 v111, v[56:59] offset:13312
  s_add_u32 s20, s8, 8257536
  s_addc_u32 s21, s9, 0
  global_load_dwordx4 a[0:3], v3, s[20:21] offset:0
  global_load_dwordx4 a[4:7], v3, s[20:21] offset:1024
  global_load_dwordx4 a[8:11], v3, s[20:21] offset:2048
  global_load_dwordx4 a[12:15], v3, s[20:21] offset:3072
  s_add_u32 s20, s20, 4096
  s_addc_u32 s21, s21, 0
  global_load_dwordx4 a[16:19], v3, s[20:21] offset:0
  global_load_dwordx4 a[20:23], v3, s[20:21] offset:1024
  global_load_dwordx4 a[24:27], v3, s[20:21] offset:2048
  global_load_dwordx4 a[28:31], v3, s[20:21] offset:3072
  s_add_u32 s20, s20, 4096
  s_addc_u32 s21, s21, 0
  global_load_dwordx4 a[32:35], v3, s[20:21] offset:0
  global_load_dwordx4 a[36:39], v3, s[20:21] offset:1024
  global_load_dwordx4 a[40:43], v3, s[20:21] offset:2048
  global_load_dwordx4 a[44:47], v3, s[20:21] offset:3072
  s_add_u32 s20, s20, 4096
  s_addc_u32 s21, s21, 0
  global_load_dwordx4 a[48:51], v3, s[20:21] offset:0
  global_load_dwordx4 a[52:55], v3, s[20:21] offset:1024
  s_waitcnt vmcnt(28)
  s_add_u32 s20, s8, 8286208
  s_addc_u32 s21, s9, 0
  global_load_dwordx4 a[56:59], v3, s[20:21] offset:0
  global_load_dwordx4 a[60:63], v3, s[20:21] offset:1024
  global_load_dwordx4 a[64:67], v3, s[20:21] offset:2048
  global_load_dwordx4 a[68:71], v3, s[20:21] offset:3072
  s_add_u32 s20, s20, 4096
  s_addc_u32 s21, s21, 0
  global_load_dwordx4 a[72:75], v3, s[20:21] offset:0
  global_load_dwordx4 a[76:79], v3, s[20:21] offset:1024
  global_load_dwordx4 a[80:83], v3, s[20:21] offset:2048
  global_load_dwordx4 a[84:87], v3, s[20:21] offset:3072
  s_add_u32 s20, s20, 4096
  s_addc_u32 s21, s21, 0
  global_load_dwordx4 a[88:91], v3, s[20:21] offset:0
  global_load_dwordx4 a[92:95], v3, s[20:21] offset:1024
  global_load_dwordx4 a[96:99], v3, s[20:21] offset:2048
  global_load_dwordx4 a[100:103], v3, s[20:21] offset:3072
  s_add_u32 s20, s20, 4096
  s_addc_u32 s21, s21, 0
  global_load_dwordx4 a[104:107], v3, s[20:21] offset:0
  global_load_dwordx4 a[108:111], v3, s[20:21] offset:1024
  s_waitcnt vmcnt(28)
  s_add_u32 s20, s8, 8271872
  s_addc_u32 s21, s9, 0
  global_load_dwordx4 a[112:115], v3, s[20:21] offset:0
  global_load_dwordx4 a[116:119], v3, s[20:21] offset:1024
  global_load_dwordx4 a[120:123], v3, s[20:21] offset:2048
  global_load_dwordx4 a[124:127], v3, s[20:21] offset:3072
  s_add_u32 s20, s20, 4096
  s_addc_u32 s21, s21, 0
  global_load_dwordx4 a[128:131], v3, s[20:21] offset:0
  global_load_dwordx4 a[132:135], v3, s[20:21] offset:1024
  global_load_dwordx4 a[136:139], v3, s[20:21] offset:2048
  global_load_dwordx4 a[140:143], v3, s[20:21] offset:3072
  s_add_u32 s20, s20, 4096
  s_addc_u32 s21, s21, 0
  global_load_dwordx4 a[144:147], v3, s[20:21] offset:0
  global_load_dwordx4 a[148:151], v3, s[20:21] offset:1024
  global_load_dwordx4 a[152:155], v3, s[20:21] offset:2048
  global_load_dwordx4 a[156:159], v3, s[20:21] offset:3072
  s_add_u32 s20, s20, 4096
  s_addc_u32 s21, s21, 0
  global_load_dwordx4 a[160:163], v3, s[20:21] offset:0
  global_load_dwordx4 a[164:167], v3, s[20:21] offset:1024
  s_waitcnt vmcnt(28)
  s_add_u32 s20, s8, 8300544
  s_addc_u32 s21, s9, 0
  global_load_dwordx4 a[168:171], v3, s[20:21] offset:0
  global_load_dwordx4 a[172:175], v3, s[20:21] offset:1024
  global_load_dwordx4 a[176:179], v3, s[20:21] offset:2048
  global_load_dwordx4 a[180:183], v3, s[20:21] offset:3072
  s_add_u32 s20, s20, 4096
  s_addc_u32 s21, s21, 0
  global_load_dwordx4 a[184:187], v3, s[20:21] offset:0
  global_load_dwordx4 a[188:191], v3, s[20:21] offset:1024
  global_load_dwordx4 a[192:195], v3, s[20:21] offset:2048
  global_load_dwordx4 a[196:199], v3, s[20:21] offset:3072
  s_add_u32 s20, s20, 4096
  s_addc_u32 s21, s21, 0
  global_load_dwordx4 a[200:203], v3, s[20:21] offset:0
  global_load_dwordx4 a[204:207], v3, s[20:21] offset:1024
  global_load_dwordx4 a[208:211], v3, s[20:21] offset:2048
  global_load_dwordx4 a[212:215], v3, s[20:21] offset:3072
  s_add_u32 s20, s20, 4096
  s_addc_u32 s21, s21, 0
  global_load_dwordx4 a[216:219], v3, s[20:21] offset:0
  global_load_dwordx4 a[220:223], v3, s[20:21] offset:1024
  s_waitcnt vmcnt(28)
  s_add_u32 s20, s8, 8314880
  s_addc_u32 s21, s9, 0
  global_load_dwordx4 a[224:227], v3, s[20:21] offset:0
  global_load_dwordx4 a[228:231], v3, s[20:21] offset:1024
  global_load_dwordx4 a[232:235], v3, s[20:21] offset:2048
  global_load_dwordx4 a[236:239], v3, s[20:21] offset:3072
  s_add_u32 s20, s20, 4096
  s_addc_u32 s21, s21, 0
  global_load_dwordx4 a[240:243], v3, s[20:21] offset:0
  global_load_dwordx4 a[244:247], v3, s[20:21] offset:1024
  global_load_dwordx4 a[248:251], v3, s[20:21] offset:2048
  global_load_dwordx4 a[252:255], v3, s[20:21] offset:3072
  s_add_u32 s20, s20, 4096
  s_addc_u32 s21, s21, 0
  global_load_dwordx4 v[120:123], v3, s[20:21] offset:0
  global_load_dwordx4 v[124:127], v3, s[20:21] offset:1024
  global_load_dwordx4 v[128:131], v3, s[20:21] offset:2048
  global_load_dwordx4 v[132:135], v3, s[20:21] offset:3072
  s_add_u32 s20, s20, 4096
  s_addc_u32 s21, s21, 0
  global_load_dwordx4 v[136:139], v3, s[20:21] offset:0
  global_load_dwordx4 v[140:143], v3, s[20:21] offset:1024
  s_waitcnt vmcnt(28)
  s_add_u32 s20, s8, 8343552
  s_addc_u32 s21, s9, 0
  global_load_dwordx4 v[144:147], v3, s[20:21] offset:0
  global_load_dwordx4 v[148:151], v3, s[20:21] offset:1024
  global_load_dwordx4 v[152:155], v3, s[20:21] offset:2048
  global_load_dwordx4 v[156:159], v3, s[20:21] offset:3072
  s_add_u32 s20, s20, 4096
  s_addc_u32 s21, s21, 0
  global_load_dwordx4 v[160:163], v3, s[20:21] offset:0
  global_load_dwordx4 v[164:167], v3, s[20:21] offset:1024
  global_load_dwordx4 v[168:171], v3, s[20:21] offset:2048
  global_load_dwordx4 v[172:175], v3, s[20:21] offset:3072
  s_add_u32 s20, s20, 4096
  s_addc_u32 s21, s21, 0
  global_load_dwordx4 v[176:179], v3, s[20:21] offset:0
  global_load_dwordx4 v[180:183], v3, s[20:21] offset:1024
  global_load_dwordx4 v[184:187], v3, s[20:21] offset:2048
  global_load_dwordx4 v[188:191], v3, s[20:21] offset:3072
  s_add_u32 s20, s20, 4096
  s_addc_u32 s21, s21, 0
  global_load_dwordx4 v[192:195], v3, s[20:21] offset:0
  global_load_dwordx4 v[196:199], v3, s[20:21] offset:1024
  s_waitcnt vmcnt(28)
  s_add_u32 s20, s8, 8329216
  s_addc_u32 s21, s9, 0
  global_load_dwordx4 v[200:203], v3, s[20:21] offset:0
  global_load_dwordx4 v[204:207], v3, s[20:21] offset:1024
  global_load_dwordx4 v[208:211], v3, s[20:21] offset:2048
  global_load_dwordx4 v[212:215], v3, s[20:21] offset:3072
  s_add_u32 s20, s20, 4096
  s_addc_u32 s21, s21, 0
  global_load_dwordx4 v[216:219], v3, s[20:21] offset:0
  global_load_dwordx4 v[220:223], v3, s[20:21] offset:1024
  global_load_dwordx4 v[224:227], v3, s[20:21] offset:2048
  global_load_dwordx4 v[228:231], v3, s[20:21] offset:3072
  s_add_u32 s20, s20, 4096
  s_addc_u32 s21, s21, 0
  global_load_dwordx4 v[232:235], v3, s[20:21] offset:0
  global_load_dwordx4 v[236:239], v3, s[20:21] offset:1024
  global_load_dwordx4 v[240:243], v3, s[20:21] offset:2048
  global_load_dwordx4 v[244:247], v3, s[20:21] offset:3072
  s_add_u32 s20, s20, 4096
  s_addc_u32 s21, s21, 0
  global_load_dwordx4 v[248:251], v3, s[20:21] offset:0
  global_load_dwordx4 v[252:255], v3, s[20:21] offset:1024
  s_waitcnt vmcnt(28)
  v_lshrrev_b32 v0, 4, v2
  v_and_b32 v74, 7, v2
  s_lshl_b32 s19, s10, 10
  v_add_u32 v108, s19, v110
  s_add_u32 s19, s10, 4
  s_min_u32 s19, s19, 6
  s_lshl_b32 s19, s19, 10
  v_add_u32 v109, s19, v110
  s_lshl_b32 s19, s10, 11
  v_add_u32 v112, s19, v110
  s_lshl_b32 s19, s10, 9
  s_add_u32 s19, s19, 8192
  v_and_b32 v96, 511, v110
  v_add_u32 v113, s19, v96
  s_lshl_b32 s19, s14, 15
  s_lshl_b32 s20, s10, 13
  s_add_u32 s19, s19, s20
  s_add_u32 s19, s19, 4096
  v_add_u32 v114, s19, v110
  s_lshl_b32 s19, s14, 14
  s_lshl_b32 s20, s10, 12
  s_add_u32 s19, s19, s20
  v_add_u32 v115, s19, v110
  s_lshl_b32 s19, s10, 11
  s_add_u32 s19, s19, 8192
  v_add_u32 v116, s19, v110
  v_lshrrev_b32 v96, 5, v2
  v_bfe_u32 v97, v2, 3, 2
  v_lshlrev_b32 v98, 4, v74
  v_lshl_add_u32 v99, v96, 10, v98
  v_lshl_add_u32 v99, v97, 8, v99
  v_add_u32 v117, 8192, v99
  s_lshl_b32 s19, s14, 9
  s_add_u32 s19, s19, 7168
  v_lshl_add_u32 v99, v96, 8, v98
  v_lshrrev_b32 v96, 1, v97
  v_lshl_add_u32 v99, v96, 7, v99
  v_and_b32 v96, 1, v97
  v_lshl_add_u32 v99, v96, 3, v99
  v_add_u32 v118, s19, v99
  v_and_b32 v96, 8, v2
  v_mov_b32 v119, 0x4444
  v_mov_b32 v97, 0xeeee
  v_cmp_ne_u32 vcc, 0, v96
  s_nop 1
  v_cndmask_b32 v119, v119, v97, vcc
  s_lshl_b32 s19, s10, 9
  s_add_u32 s19, s19, 8192
  v_and_b32 v96, 255, v110
  v_lshrrev_b32 v97, 5, v2
  v_lshl_add_u32 v96, v97, 8, v96
  v_add_u32 v113, s19, v96
  s_lshl_b32 s19, s10, 11
  s_add_u32 s19, s19, 8192
  v_bfe_u32 v96, v2, 4, 1
  v_mul_u32_u24 v96, 576, v96
  v_lshl_add_u32 v96, v97, 6, v96
  v_and_b32 v98, 15, v2
  v_lshl_add_u32 v96, v98, 2, v96
  v_add_u32 v116, s19, v96
  v_mul_u32_u24 v96, 144, v74
  v_lshl_add_u32 v96, v97, 6, v96
  v_bfe_u32 v98, v2, 3, 2
  v_lshl_add_u32 v96, v98, 4, v96
  v_add_u32 v117, 8192, v96
  s_lshl_b32 s19, s10, 11
  s_add_u32 s19, s19, 8192
  v_lshrrev_b32 v96, 4, v2
  v_mul_u32_u24 v96, 288, v96
  v_and_b32 v98, 15, v2
  v_lshl_add_u32 v96, v98, 2, v96
  v_add_u32 v116, s19, v96
  s_add_u32 s22, s8, 85196800
  s_addc_u32 s23, s9, 0
  s_add_u32 s24, s8, 45875200
  s_addc_u32 s25, s9, 0
  s_add_u32 s26, s8, 86319104
  s_addc_u32 s27, s9, 0
  s_add_u32 s28, s8, 85663744
  s_addc_u32 s29, s9, 0
  s_waitcnt lgkmcnt(0)
  s_mov_b32 s18, 1048576
  s_mov_b32 s30, 0
  s_mov_b32 s34, 0
  s_lshl_b32 s35, s10, 4
  s_add_u32 s35, s35, s14
  s_lshl_b32 s35, s35, 2
  s_add_u32 s35, s35, 103350272
  s_waitcnt vmcnt(0)
  s_cmp_lg_u32 s10, 0
  s_nop 1
  s_cbranch_scc1 GOD_45
  s_mov_b32 s19, 65536
  v_mbcnt_lo_u32_b32 v0, -1, 0
  v_mbcnt_hi_u32_b32 v0, -1, v0
  v_lshlrev_b32 v0, 4, v0
  v_add_u32 v0, 103366656, v0
  s_nop 1
GOP_44:
  global_load_dwordx4 v[4:7], v0, s[8:9] sc0 sc1
  s_waitcnt vmcnt(0)
  v_min3_u32 v1, v4, v5, v6
  v_min_u32 v1, v1, v7
  v_cmp_gt_u32 vcc, 2, v1
  s_nop 4
  s_cbranch_vccz GOD_45
  s_sleep 3
  s_sub_u32 s19, s19, 1
  s_nop 1
  s_cbranch_scc0 GOP_44
GOD_45:
  s_barrier
  s_nop 1
BLOOP_46:
  s_add_u32 s19, s30, 0
  s_lshr_b32 s19, s19, 1
  s_nop 1
BUW_50:
  s_cmp_lt_u32 s19, s34
  s_nop 1
  s_cbranch_scc1 BUD_51
  s_lshl_b32 s20, s14, 3
  s_lshr_b32 s21, s10, 1
  s_lshl_b32 s21, s21, 2
  s_add_u32 s20, s20, s21
  s_add_u32 s20, s20, 103338096
  v_lshlrev_b32 v0, 4, v110
  v_and_b32 v0, 0x1fff, v0
  v_add_u32 v0, s20, v0
  global_load_dword v1, v0, s[8:9] sc0 sc1
  s_waitcnt vmcnt(0)
  v_cmp_lt_u32 vcc, 3, v1
  s_ff0_i32_b32 s34, vcc_lo
  s_sub_u32 s18, s18, 1
  s_nop 2
  s_cbranch_scc0 BUW_50
  s_branch CEXIT_1
BUD_51:
PM_52:
  global_load_dwordx4 v[80:83], v108, s[22:23] sc1
  global_load_dwordx4 v[84:87], v109, s[22:23] sc1
  s_waitcnt vmcnt(0)
  v_max3_u32 v3, v80, v81, v82
  v_max3_u32 v4, v83, v84, v85
  v_max3_u32 v3, v3, v86, v87
  v_max_u32 v3, v3, v4
  v_cmp_eq_u32 vcc, -1, v3
  s_nop 4
  s_cbranch_vccz PMD_53
  s_sub_u32 s18, s18, 1
  s_nop 1
  s_cbranch_scc0 PM_52
  s_branch CEXIT_1
PMD_53:
  ds_write_b128 v108, v[80:83]
  ds_write_b128 v109, v[84:87]
  s_waitcnt lgkmcnt(0)
  s_barrier
  ds_read_b128 v[4:7], v110 offset:0
  ds_read_b128 v[8:11], v110 offset:1024
  ds_read_b128 v[12:15], v110 offset:2048
  ds_read_b128 v[16:19], v110 offset:3072
  ds_read_b128 v[20:23], v110 offset:4096
  ds_read_b128 v[24:27], v110 offset:5120
  ds_read_b128 v[28:31], v110 offset:6144
  ds_read_b128 v[88:91], v111 offset:0
  ds_read_b128 v[92:95], v111 offset:1024
  ds_read_b128 v[96:99], v111 offset:2048
  ds_read_b128 v[100:103], v111 offset:3072
  v_mov_b64 v[80:81], 0
  v_mov_b64 v[82:83], 0
  v_mov_b64 v[84:85], 0
  v_mov_b64 v[86:87], 0
  v_mov_b64 v[104:105], 0
  v_mov_b64 v[106:107], 0
  s_waitcnt lgkmcnt(10)
  v_smfmac_f32_16x16x64_bf16 v[80:83], v[4:7], a[0:7], v119
  s_waitcnt lgkmcnt(9)
  v_smfmac_f32_16x16x64_bf16 v[80:83], v[8:11], a[8:15], v119
  s_waitcnt lgkmcnt(8)
  v_smfmac_f32_16x16x64_bf16 v[80:83], v[12:15], a[16:23], v119
  global_load_dwordx4 v[32:35], v114, s[24:25] offset:-4096
  s_waitcnt lgkmcnt(7)
  v_smfmac_f32_16x16x64_bf16 v[80:83], v[16:19], a[24:31], v119
  global_load_dwordx4 v[40:43], v114, s[24:25] offset:-3072
  s_waitcnt lgkmcnt(6)
  v_smfmac_f32_16x16x64_bf16 v[80:83], v[20:23], a[32:39], v119
  global_load_dwordx4 v[36:39], v114, s[24:25] offset:-2048
  s_waitcnt lgkmcnt(5)
  v_smfmac_f32_16x16x64_bf16 v[80:83], v[24:27], a[40:47], v119
  global_load_dwordx4 v[44:47], v114, s[24:25] offset:-1024
  s_waitcnt lgkmcnt(4)
  v_smfmac_f32_16x16x64_bf16 v[80:83], v[28:31], a[48:55], v119
  global_load_dwordx4 v[48:51], v114, s[24:25] offset:0
  s_waitcnt lgkmcnt(2)
  v_smfmac_f32_16x16x64_bf16 v[104:107], v[4:7], v[88:95], v119
  ds_read_b128 v[88:91], v111 offset:4096
  ds_read_b128 v[92:95], v111 offset:5120
  v_smfmac_f32_16x16x64_bf16 v[84:87], v[4:7], a[56:63], v119
  global_load_dwordx4 v[56:59], v114, s[24:25] offset:1024
  v_smfmac_f32_16x16x64_bf16 v[84:87], v[8:11], a[64:71], v119
  global_load_dwordx4 v[52:55], v114, s[24:25] offset:2048
  v_smfmac_f32_16x16x64_bf16 v[84:87], v[12:15], a[72:79], v119
  global_load_dwordx4 v[60:63], v114, s[24:25] offset:3072
  v_cvt_pk_bf16_f32 v64, v80, v81
  v_cvt_pk_bf16_f32 v65, v82, v83
  v_smfmac_f32_16x16x64_bf16 v[84:87], v[16:19], a[80:87], v119
  v_mov_b64 v[80:81], 0
  v_mov_b64 v[82:83], 0
  v_smfmac_f32_16x16x64_bf16 v[84:87], v[20:23], a[88:95], v119
  v_smfmac_f32_16x16x64_bf16 v[84:87], v[24:27], a[96:103], v119
  v_smfmac_f32_16x16x64_bf16 v[84:87], v[28:31], a[104:111], v119
  s_waitcnt lgkmcnt(2)
  v_smfmac_f32_16x16x64_bf16 v[104:107], v[8:11], v[96:103], v119
  ds_read_b128 v[96:99], v111 offset:6144
  ds_read_b128 v[100:103], v111 offset:7168
  v_smfmac_f32_16x16x64_bf16 v[80:83], v[4:7], a[112:119], v119
  v_smfmac_f32_16x16x64_bf16 v[80:83], v[8:11], a[120:127], v119
  v_smfmac_f32_16x16x64_bf16 v[80:83], v[12:15], a[128:135], v119
  s_nop 0
  v_cvt_pk_bf16_f32 v66, v84, v85
  v_cvt_pk_bf16_f32 v67, v86, v87
  v_smfmac_f32_16x16x64_bf16 v[80:83], v[16:19], a[136:143], v119
  v_mov_b64 v[84:85], 0
  v_mov_b64 v[86:87], 0
  v_smfmac_f32_16x16x64_bf16 v[80:83], v[20:23], a[144:151], v119
  v_smfmac_f32_16x16x64_bf16 v[80:83], v[24:27], a[152:159], v119
  v_smfmac_f32_16x16x64_bf16 v[80:83], v[28:31], a[160:167], v119
  s_waitcnt lgkmcnt(2)
  v_smfmac_f32_16x16x64_bf16 v[104:107], v[12:15], v[88:95], v119
  ds_read_b128 v[88:91], v111 offset:8192
  ds_read_b128 v[92:95], v111 offset:9216
  v_smfmac_f32_16x16x64_bf16 v[84:87], v[4:7], a[168:175], v119
  v_smfmac_f32_16x16x64_bf16 v[84:87], v[8:11], a[176:183], v119
  v_smfmac_f32_16x16x64_bf16 v[84:87], v[12:15], a[184:191], v119
  s_nop 0
  v_cvt_pk_bf16_f32 v72, v80, v81
  v_cvt_pk_bf16_f32 v73, v82, v83
  v_smfmac_f32_16x16x64_bf16 v[84:87], v[16:19], a[192:199], v119
  v_mov_b64 v[80:81], 0
  v_mov_b64 v[82:83], 0
  v_smfmac_f32_16x16x64_bf16 v[84:87], v[20:23], a[200:207], v119
  v_smfmac_f32_16x16x64_bf16 v[84:87], v[24:27], a[208:215], v119
  v_smfmac_f32_16x16x64_bf16 v[84:87], v[28:31], a[216:223], v119
  s_waitcnt lgkmcnt(2)
  v_smfmac_f32_16x16x64_bf16 v[104:107], v[16:19], v[96:103], v119
  ds_read_b128 v[96:99], v111 offset:10240
  ds_read_b128 v[100:103], v111 offset:11264
  v_smfmac_f32_16x16x64_bf16 v[80:83], v[4:7], a[224:231], v119
  v_smfmac_f32_16x16x64_bf16 v[80:83], v[8:11], a[232:239], v119
  v_smfmac_f32_16x16x64_bf16 v[80:83], v[12:15], a[240:247], v119
  s_nop 0
  v_cvt_pk_bf16_f32 v74, v84, v85
  v_cvt_pk_bf16_f32 v75, v86, v87
  v_smfmac_f32_16x16x64_bf16 v[80:83], v[16:19], a[248:255], v119
  v_mov_b64 v[84:85], 0
  v_mov_b64 v[86:87], 0
  v_smfmac_f32_16x16x64_bf16 v[80:83], v[20:23], v[120:127], v119
  v_smfmac_f32_16x16x64_bf16 v[80:83], v[24:27], v[128:135], v119
  v_smfmac_f32_16x16x64_bf16 v[80:83], v[28:31], v[136:143], v119
  s_waitcnt lgkmcnt(2)
  v_smfmac_f32_16x16x64_bf16 v[104:107], v[20:23], v[88:95], v119
  ds_read_b128 v[88:91], v111 offset:12288
  ds_read_b128 v[92:95], v111 offset:13312
  v_smfmac_f32_16x16x64_bf16 v[84:87], v[4:7], v[144:151], v119
  v_smfmac_f32_16x16x64_bf16 v[84:87], v[8:11], v[152:159], v119
  v_smfmac_f32_16x16x64_bf16 v[84:87], v[12:15], v[160:167], v119
  s_nop 0
  v_cvt_pk_bf16_f32 v68, v80, v81
  v_cvt_pk_bf16_f32 v69, v82, v83
  v_smfmac_f32_16x16x64_bf16 v[84:87], v[16:19], v[168:175], v119
  v_mov_b64 v[80:81], 0
  v_mov_b64 v[82:83], 0
  v_smfmac_f32_16x16x64_bf16 v[84:87], v[20:23], v[176:183], v119
  v_smfmac_f32_16x16x64_bf16 v[84:87], v[24:27], v[184:191], v119
  v_smfmac_f32_16x16x64_bf16 v[84:87], v[28:31], v[192:199], v119
  s_waitcnt lgkmcnt(2)
  v_smfmac_f32_16x16x64_bf16 v[104:107], v[24:27], v[96:103], v119
  v_smfmac_f32_16x16x64_bf16 v[80:83], v[4:7], v[200:207], v119
  v_smfmac_f32_16x16x64_bf16 v[80:83], v[8:11], v[208:215], v119
  v_smfmac_f32_16x16x64_bf16 v[80:83], v[12:15], v[216:223], v119
  s_nop 2
  v_cvt_pk_bf16_f32 v70, v84, v85
  v_cvt_pk_bf16_f32 v71, v86, v87
  v_smfmac_f32_16x16x64_bf16 v[80:83], v[16:19], v[224:231], v119
  v_smfmac_f32_16x16x64_bf16 v[80:83], v[20:23], v[232:239], v119
  v_smfmac_f32_16x16x64_bf16 v[80:83], v[24:27], v[240:247], v119
  v_smfmac_f32_16x16x64_bf16 v[80:83], v[28:31], v[248:255], v119
  s_waitcnt lgkmcnt(0)
  v_smfmac_f32_16x16x64_bf16 v[104:107], v[28:31], v[88:95], v119
  s_nop 5
  v_cvt_pk_bf16_f32 v76, v80, v81
  v_cvt_pk_bf16_f32 v77, v82, v83
  v_cvt_pk_bf16_f32 v78, v104, v105
  v_cvt_pk_bf16_f32 v79, v106, v107
  s_cmp_eq_u32 s30, 63
  s_nop 1
  s_cbranch_scc1 BEND_55
  v_mov_b64 v[88:89], 0
  v_mov_b64 v[90:91], 0
  v_mov_b64 v[92:93], 0
  v_mov_b64 v[94:95], 0
  v_and_b32 v0, 32, v110
  v_mov_b32 v2, 0x4444
  v_mov_b32 v3, 0xeeee
  v_cmp_ne_u32 vcc, 0, v0
  s_nop 1
  v_cndmask_b32 v2, v2, v3, vcc
  global_load_dwordx4 v[96:99], v112, s[28:29] offset:0 sc1
  global_load_dwordx4 v[100:103], v112, s[28:29] offset:1024 sc1
  global_load_dwordx4 v[104:107], v113, s[28:29] sc1
  s_waitcnt vmcnt(3)
  s_sleep 1
  global_load_dwordx4 v[20:23], v112, s[28:29] offset:0 sc1
  global_load_dwordx4 v[24:27], v112, s[28:29] offset:1024 sc1
  global_load_dwordx4 v[28:31], v113, s[28:29] sc1
  s_nop 1
BPP_48:
  s_waitcnt vmcnt(3)
  v_max3_u32 v0, v96, v97, v98
  v_max3_u32 v1, v99, v100, v101
  v_max3_u32 v0, v0, v102, v103
  v_max3_u32 v1, v1, v104, v105
  v_max3_u32 v0, v0, v106, v107
  v_max_u32 v0, v0, v1
  v_cmp_eq_u32 vcc, -1, v0
  s_nop 0
  s_cbranch_vccz BPD_49
  global_load_dwordx4 v[96:99], v112, s[28:29] offset:0 sc1
  global_load_dwordx4 v[100:103], v112, s[28:29] offset:1024 sc1
  global_load_dwordx4 v[104:107], v113, s[28:29] sc1
  s_waitcnt vmcnt(3)
  v_max3_u32 v0, v20, v21, v22
  v_max3_u32 v1, v23, v24, v25
  v_max3_u32 v0, v0, v26, v27
  v_max3_u32 v1, v1, v28, v29
  v_max3_u32 v0, v0, v30, v31
  v_max_u32 v0, v0, v1
  v_cmp_eq_u32 vcc, -1, v0
  s_nop 0
  s_cbranch_vccz BD1_56
  global_load_dwordx4 v[20:23], v112, s[28:29] offset:0 sc1
  global_load_dwordx4 v[24:27], v112, s[28:29] offset:1024 sc1
  global_load_dwordx4 v[28:31], v113, s[28:29] sc1
  s_sub_u32 s18, s18, 1
  s_nop 1
  s_cbranch_scc0 BPP_48
  s_waitcnt vmcnt(0)
  s_nop 1
  s_branch CEXIT_1
BD1_56:
  v_smfmac_f32_16x16x64_bf16 v[88:91], v[20:23], v[32:39], v2
  v_smfmac_f32_16x16x64_bf16 v[92:95], v[20:23], v[40:47], v2
  v_smfmac_f32_16x16x64_bf16 v[88:91], v[24:27], v[48:55], v2
  v_smfmac_f32_16x16x64_bf16 v[92:95], v[24:27], v[56:63], v2
  v_smfmac_f32_16x16x64_bf16 v[88:91], v[28:31], v[64:71], v2
  v_smfmac_f32_16x16x64_bf16 v[92:95], v[28:31], v[72:79], v2
  s_add_u32 s24, s24, 458752
  s_addc_u32 s25, s25, 0
  s_add_u32 s26, s26, 229376
  s_addc_u32 s27, s27, 0
  s_add_u32 s28, s28, 10240
  s_addc_u32 s29, s29, 0
  s_nop 1
  s_branch BJ_57
BPD_49:
  v_smfmac_f32_16x16x64_bf16 v[88:91], v[96:99], v[32:39], v2
  v_smfmac_f32_16x16x64_bf16 v[92:95], v[96:99], v[40:47], v2
  v_smfmac_f32_16x16x64_bf16 v[88:91], v[100:103], v[48:55], v2
  v_smfmac_f32_16x16x64_bf16 v[92:95], v[100:103], v[56:63], v2
  v_smfmac_f32_16x16x64_bf16 v[88:91], v[104:107], v[64:71], v2
  v_smfmac_f32_16x16x64_bf16 v[92:95], v[104:107], v[72:79], v2
  s_add_u32 s24, s24, 458752
  s_addc_u32 s25, s25, 0
  s_add_u32 s26, s26, 229376
  s_addc_u32 s27, s27, 0
  s_add_u32 s28, s28, 10240
  s_addc_u32 s29, s29, 0
  s_nop 1
BJ_57:
  v_pk_add_f32 v[88:89], v[88:89], v[90:91]
  ds_write2_b32 v116, v88, v89 offset0:0 offset1:36
  v_pk_add_f32 v[92:93], v[92:93], v[94:95]
  ds_write2_b32 v116, v92, v93 offset0:16 offset1:52
  s_waitcnt lgkmcnt(0)
  s_barrier
  s_cmp_lg_u32 s10, 0
  s_cbranch_scc1 BNOFIN_47
  ds_read_b128 v[4:7], v117 offset:0
  ds_read_b128 v[8:11], v117 offset:2048
  ds_read_b128 v[12:15], v117 offset:4096
  ds_read_b128 v[16:19], v117 offset:6144
  s_waitcnt lgkmcnt(2)
  v_pk_add_f32 v[4:5], v[4:5], v[8:9]
  v_pk_add_f32 v[6:7], v[6:7], v[10:11]
  s_waitcnt lgkmcnt(0)
  v_pk_add_f32 v[12:13], v[12:13], v[16:17]
  v_pk_add_f32 v[14:15], v[14:15], v[18:19]
  v_pk_add_f32 v[4:5], v[4:5], v[12:13]
  v_pk_add_f32 v[6:7], v[6:7], v[14:15]
  v_cvt_pk_bf16_f32 v4, v4, v5
  v_cvt_pk_bf16_f32 v5, v6, v7
  v_min_u32 v4, -2, v4
  v_min_u32 v5, -2, v5
  s_cmp_lg_u32 s17, 0
  s_cbranch_scc1 PS_58
  global_store_dwordx2 v118, v[4:5], s[22:23]
  s_nop 1
  s_branch PE_59
PS_58:
  global_store_dwordx2 v118, v[4:5], s[22:23] sc0 sc1
  s_nop 1
PE_59:
BNOFIN_47:
  s_barrier
  s_add_u32 s22, s22, 7168
  s_addc_u32 s23, s23, 0
  s_add_u32 s30, s30, 1
  s_nop 1
  s_branch BLOOP_46
BEND_55:
  global_store_dwordx4 v115, v[64:67], s[26:27] offset:0 sc0 sc1
  global_store_dwordx4 v115, v[72:75], s[26:27] offset:1024 sc0 sc1
  global_store_dwordx4 v115, v[68:71], s[26:27] offset:2048 sc0 sc1
  global_store_dwordx4 v115, v[76:79], s[26:27] offset:3072 sc0 sc1
  s_waitcnt vmcnt(0)
  s_lshl_b32 s19, s30, 8
  s_add_u32 s19, s19, s35
  v_mov_b32 v0, s19
  v_mov_b32 v1, 1
  global_store_dword v0, v1, s[8:9] sc0 sc1
  s_nop 1
  s_branch CEXIT_1
PROLE_31:
  s_cmp_lg_u32 s10, 0
  s_nop 1
  s_cbranch_scc1 GOD_61
  s_mov_b32 s19, 65536
  v_mbcnt_lo_u32_b32 v0, -1, 0
  v_mbcnt_hi_u32_b32 v0, -1, v0
  v_lshlrev_b32 v0, 4, v0
  v_add_u32 v0, 103366656, v0
  s_nop 1
GOP_60:
  global_load_dwordx4 v[4:7], v0, s[8:9] sc0 sc1
  s_waitcnt vmcnt(0)
  v_min3_u32 v1, v4, v5, v6
  v_min_u32 v1, v1, v7
  v_cmp_gt_u32 vcc, 2, v1
  s_nop 4
  s_cbranch_vccz GOD_61
  s_sleep 3
  s_sub_u32 s19, s19, 1
  s_nop 1
  s_cbranch_scc0 GOP_60
GOD_61:
  s_barrier
  s_sub_u32 s14, s14, 30
  s_lshl_b32 s14, s14, 2
  s_add_u32 s14, s14, s10
  s_mul_i32 s19, s14, 3584
  v_min_u32 v5, 27, v2
  v_lshlrev_b32 v5, 7, v5
  v_add_u32 v5, s19, v5
  s_mul_i32 s19, s14, 1280
  v_min_u32 v6, 9, v2
  v_lshlrev_b32 v6, 7, v6
  v_add_u32 v6, s19, v6
  s_mul_i32 s19, s14, 896
  v_min_u32 v7, 6, v2
  v_lshlrev_b32 v7, 7, v7
  v_add_u32 v7, s19, v7
  v_min_u32 v8, 55, v2
  v_lshlrev_b32 v8, 4, v8
  v_add_u32 v8, s19, v8
  v_add_u32 v9, 15810560, v8
  s_mov_b32 s18, 1048576
  s_mov_b32 s30, 0
  s_add_u32 s26, s8, 101474304
  s_addc_u32 s27, s9, 0
  s_add_u32 s22, s8, 85203968
  s_addc_u32 s23, s9, 0
  s_add_u32 s28, s8, 85663744
  s_addc_u32 s29, s9, 0
  s_add_u32 s20, s8, 85175296
  s_addc_u32 s21, s9, 0
  s_nop 1
PLOOP_62:
  s_cmp_le_u32 s30, 3
  s_nop 1
  s_cbranch_scc1 PGO_64
PWAIT_63:
  global_load_dwordx4 v[16:19], v8, s[20:21] sc1
  s_waitcnt vmcnt(0)
  v_max3_u32 v0, v16, v17, v18
  v_max_u32 v0, v0, v19
  v_cmp_eq_u32 vcc, -1, v0
  s_nop 4
  s_cbranch_vccz PCP_65
  s_sleep 2
  s_sub_u32 s18, s18, 1
  s_nop 1
  s_cbranch_scc0 PWAIT_63
  s_branch CEXIT_1
PCP_65:
  global_store_dwordx4 v9, v[16:19], s[20:21] sc0 sc1
  s_nop 1
PGO_64:
  s_cmp_ge_u32 s30, 63
  s_nop 1
  s_cbranch_scc1 PNP_66
  global_load_dword v10, v7, s[22:23]
  global_load_dword v11, v6, s[28:29]
  global_load_dword v12, v5, s[26:27]
  s_nop 1
PNP_66:
  s_add_u32 s22, s22, 7168
  s_addc_u32 s23, s23, 0
  s_add_u32 s28, s28, 10240
  s_addc_u32 s29, s29, 0
  s_add_u32 s26, s26, 28672
  s_addc_u32 s27, s27, 0
  s_add_u32 s20, s20, 7168
  s_addc_u32 s21, s21, 0
  s_add_u32 s30, s30, 1
  s_cmp_lt_u32 s30, 67
  s_nop 1
  s_cbranch_scc1 PLOOP_62
  s_branch CEXIT_1
CWORK_3:
  s_load_dwordx2 s[90:91], s[0:1], 88
  s_waitcnt lgkmcnt(0)
  s_cmp_lg_u32 s10, 0
  s_nop 1
  s_cbranch_scc1 GOD_81
  s_mov_b32 s19, 65536
  v_mbcnt_lo_u32_b32 v0, -1, 0
  v_mbcnt_hi_u32_b32 v0, -1, v0
  v_lshlrev_b32 v0, 4, v0
  v_add_u32 v0, 103366656, v0
  s_nop 1
GOP_80:
  global_load_dwordx4 v[4:7], v0, s[8:9] sc0 sc1
  s_waitcnt vmcnt(0)
  v_min3_u32 v1, v4, v5, v6
  v_min_u32 v1, v1, v7
  v_cmp_gt_u32 vcc, 2, v1
  s_nop 4
  s_cbranch_vccz GOD_81
  s_sleep 3
  s_sub_u32 s19, s19, 1
  s_nop 1
  s_cbranch_scc0 GOP_80
GOD_81:
  s_barrier
  s_nop 1
WLOOP_71:
  s_cmp_lg_u32 s10, 0
  s_nop 1
  s_cbranch_scc1 WSKIP_72
  s_mov_b64 exec, 1
  v_mov_b32 v3, 72
  v_mov_b32 v4, 1
  global_atomic_add v5, v3, v4, s[6:7] sc0 sc1
  v_mov_b32 v3, 86048
  s_waitcnt vmcnt(0)
  ds_write_b32 v3, v5
  s_waitcnt lgkmcnt(0)
  s_mov_b64 exec, -1
  s_nop 1
WSKIP_72:
  s_barrier
  v_mov_b32 v3, 86048
  ds_read_b32 v4, v3
  s_waitcnt lgkmcnt(0)
  v_readfirstlane_b32 s40, v4
  s_cmp_ge_u32 s40, 112
  s_nop 3
  s_cbranch_scc1 WT0_73
  s_lshl_b32 s39, s40, 1
  s_add_u32 s39, s39, 224
  s_mov_b32 s40, 0
  s_mov_b32 s38, 1
  s_nop 1
  s_branch WGO_78
WT0_73:
  s_sub_u32 s40, s40, 112
  s_cmp_lt_u32 s40, 14
  s_nop 1
  s_cbranch_scc1 WTZ_79
  s_sub_u32 s40, s40, 14
  s_cmp_lt_u32 s40, 63
  s_nop 1
  s_cbranch_scc1 WTS_67
  s_sub_u32 s40, s40, 63
  s_cmp_ge_u32 s40, 196
  s_nop 1
  s_cbranch_scc1 WT1_74
  s_mul_i32 s12, s40, 2341
  s_lshr_b32 s12, s12, 16
  s_mul_i32 s13, s12, 28
  s_sub_u32 s39, s40, s13
  s_lshl_b32 s39, s39, 3
  s_add_u32 s39, s39, 224
  s_add_u32 s40, s12, 1
  s_mov_b32 s38, 4
  s_nop 1
  s_branch WGO_78
WT1_74:
  s_sub_u32 s40, s40, 196
  s_cmp_ge_u32 s40, 48
  s_nop 1
  s_cbranch_scc1 WT2_75
  s_mov_b32 s19, 65536
  v_min_u32 v0, 62, v2
  v_lshlrev_b32 v0, 2, v0
  v_add_u32 v0, 103367680, v0
  s_nop 1
WPW_68:
  s_sub_u32 s19, s19, 1
  s_nop 1
  s_cbranch_scc1 WPD_69
  global_load_dword v1, v0, s[8:9] sc0 sc1
  s_waitcnt vmcnt(0)
  v_cmp_eq_u32 vcc, 0, v1
  s_nop 4
  s_cbranch_vccnz WPW_68
WPD_69:
  s_mul_i32 s12, s40, 10923
  s_lshr_b32 s12, s12, 16
  s_mul_i32 s13, s12, 6
  s_sub_u32 s39, s40, s13
  s_lshl_b32 s39, s39, 3
  s_add_u32 s39, s39, 448
  s_mov_b32 s40, s12
  s_mov_b32 s38, 4
  s_nop 1
  s_branch WGO_78
WT2_75:
  s_sub_u32 s40, s40, 48
  s_cmp_ge_u32 s40, 112
  s_nop 1
  s_cbranch_scc1 WT3_76
  s_mul_i32 s12, s40, 4682
  s_lshr_b32 s12, s12, 16
  s_mul_i32 s13, s12, 14
  s_sub_u32 s39, s40, s13
  s_lshl_b32 s39, s39, 4
  s_mov_b32 s40, s12
  s_mov_b32 s38, 8
  s_nop 1
WGO_78:
  s_lshl_b32 s12, s40, 4
  s_lshl_b32 s13, s10, 2
  s_add_u32 s12, s12, s13
  s_lshr_b32 s13, s12, 1
  v_lshlrev_b32 v3, 4, v2
  s_mul_i32 s14, s12, 14336
  v_add_u32 v7, s14, v3
  s_mul_i32 s14, s39, 28672
  s_mul_i32 s15, s10, 7168
  s_add_u32 s14, s14, s15
  s_add_u32 s14, s14, 1835008
  v_add_u32 v4, s14, v3
  s_mov_b32 s44, s15
  s_mov_b32 m0, s44
  s_nop 0
  global_load_lds_dwordx4 v4, s[8:9] offset:0
  global_load_lds_dwordx4 v4, s[8:9] offset:1024
  global_load_lds_dwordx4 v4, s[8:9] offset:2048
  global_load_lds_dwordx4 v4, s[8:9] offset:3072
  s_add_u32 m0, s44, 4096
  s_nop 0
  v_add_u32 v4, 4096, v4
  global_load_lds_dwordx4 v4, s[8:9] offset:0
  global_load_lds_dwordx4 v4, s[8:9] offset:1024
  global_load_lds_dwordx4 v4, s[8:9] offset:2048
  s_nop 1
  v_add_u32 v4, 24576, v4
  s_add_u32 s44, s44, 28672
  s_cmp_ge_u32 s44, 86016
  s_cselect_b32 s45, 86016, 0
  s_sub_u32 s44, s44, s45
  s_mov_b32 m0, s44
  s_nop 0
  global_load_lds_dwordx4 v4, s[8:9] offset:0
  global_load_lds_dwordx4 v4, s[8:9] offset:1024
  global_load_lds_dwordx4 v4, s[8:9] offset:2048
  global_load_lds_dwordx4 v4, s[8:9] offset:3072
  s_add_u32 m0, s44, 4096
  s_nop 0
  v_add_u32 v4, 4096, v4
  global_load_lds_dwordx4 v4, s[8:9] offset:0
  global_load_lds_dwordx4 v4, s[8:9] offset:1024
  global_load_lds_dwordx4 v4, s[8:9] offset:2048
  s_nop 1
  v_add_u32 v4, 24576, v4
  s_add_u32 s44, s44, 28672
  s_cmp_ge_u32 s44, 86016
  s_cselect_b32 s45, 86016, 0
  s_sub_u32 s44, s44, s45
  global_load_dwordx4 a[0:3], v7, s[8:9] offset:0
  global_load_dwordx4 a[4:7], v7, s[8:9] offset:1024
  global_load_dwordx4 a[8:11], v7, s[8:9] offset:2048
  global_load_dwordx4 a[12:15], v7, s[8:9] offset:3072
  v_add_u32 v7, 4096, v7
  global_load_dwordx4 a[16:19], v7, s[8:9] offset:0
  global_load_dwordx4 a[20:23], v7, s[8:9] offset:1024
  global_load_dwordx4 a[24:27], v7, s[8:9] offset:2048
  global_load_dwordx4 a[28:31], v7, s[8:9] offset:3072
  v_add_u32 v7, 4096, v7
  global_load_dwordx4 a[32:35], v7, s[8:9] offset:0
  global_load_dwordx4 a[36:39], v7, s[8:9] offset:1024
  global_load_dwordx4 a[40:43], v7, s[8:9] offset:2048
  global_load_dwordx4 a[44:47], v7, s[8:9] offset:3072
  v_add_u32 v7, 4096, v7
  global_load_dwordx4 a[48:51], v7, s[8:9] offset:0
  global_load_dwordx4 a[52:55], v7, s[8:9] offset:1024
  global_load_dwordx4 a[56:59], v7, s[8:9] offset:2048
  global_load_dwordx4 a[60:63], v7, s[8:9] offset:3072
  v_add_u32 v7, 4096, v7
  global_load_dwordx4 a[64:67], v7, s[8:9] offset:0
  global_load_dwordx4 a[68:71], v7, s[8:9] offset:1024
  global_load_dwordx4 a[72:75], v7, s[8:9] offset:2048
  global_load_dwordx4 a[76:79], v7, s[8:9] offset:3072
  v_add_u32 v7, 4096, v7
  global_load_dwordx4 a[80:83], v7, s[8:9] offset:0
  global_load_dwordx4 a[84:87], v7, s[8:9] offset:1024
  global_load_dwordx4 a[88:91], v7, s[8:9] offset:2048
  global_load_dwordx4 a[92:95], v7, s[8:9] offset:3072
  v_add_u32 v7, 4096, v7
  global_load_dwordx4 a[96:99], v7, s[8:9] offset:0
  global_load_dwordx4 a[100:103], v7, s[8:9] offset:1024
  global_load_dwordx4 a[104:107], v7, s[8:9] offset:2048
  global_load_dwordx4 a[108:111], v7, s[8:9] offset:3072
  v_add_u32 v7, 4096, v7
  global_load_dwordx4 a[112:115], v7, s[8:9] offset:0
  global_load_dwordx4 a[116:119], v7, s[8:9] offset:1024
  global_load_dwordx4 a[120:123], v7, s[8:9] offset:2048
  global_load_dwordx4 a[124:127], v7, s[8:9] offset:3072
  v_add_u32 v7, 4096, v7
  global_load_dwordx4 a[128:131], v7, s[8:9] offset:0
  global_load_dwordx4 a[132:135], v7, s[8:9] offset:1024
  global_load_dwordx4 a[136:139], v7, s[8:9] offset:2048
  global_load_dwordx4 a[140:143], v7, s[8:9] offset:3072
  v_add_u32 v7, 4096, v7
  global_load_dwordx4 a[144:147], v7, s[8:9] offset:0
  global_load_dwordx4 a[148:151], v7, s[8:9] offset:1024
  global_load_dwordx4 a[152:155], v7, s[8:9] offset:2048
  global_load_dwordx4 a[156:159], v7, s[8:9] offset:3072
  v_add_u32 v7, 4096, v7
  s_waitcnt vmcnt(30)
  global_load_dwordx4 a[160:163], v7, s[8:9] offset:0
  global_load_dwordx4 a[164:167], v7, s[8:9] offset:1024
  global_load_dwordx4 a[168:171], v7, s[8:9] offset:2048
  global_load_dwordx4 a[172:175], v7, s[8:9] offset:3072
  v_add_u32 v7, 4096, v7
  global_load_dwordx4 a[176:179], v7, s[8:9] offset:0
  global_load_dwordx4 a[180:183], v7, s[8:9] offset:1024
  global_load_dwordx4 a[184:187], v7, s[8:9] offset:2048
  global_load_dwordx4 a[188:191], v7, s[8:9] offset:3072
  v_add_u32 v7, 4096, v7
  global_load_dwordx4 a[192:195], v7, s[8:9] offset:0
  global_load_dwordx4 a[196:199], v7, s[8:9] offset:1024
  global_load_dwordx4 a[200:203], v7, s[8:9] offset:2048
  global_load_dwordx4 a[204:207], v7, s[8:9] offset:3072
  v_add_u32 v7, 4096, v7
  global_load_dwordx4 a[208:211], v7, s[8:9] offset:0
  global_load_dwordx4 a[212:215], v7, s[8:9] offset:1024
  global_load_dwordx4 a[216:219], v7, s[8:9] offset:2048
  global_load_dwordx4 a[220:223], v7, s[8:9] offset:3072
  v_add_u32 v7, 4096, v7
  s_mov_b32 s42, 1.0
  s_mov_b32 s46, s38
  s_mov_b64 s[48:49], 0
  v_mov_b32 v5, v3
  v_add_u32 v6, 28672, v3
  s_cmp_ge_u32 s39, 480
  s_nop 1
  s_cbranch_scc1 GTV_84
  s_cmp_ge_u32 s39, 448
  s_nop 1
  s_cbranch_scc1 GTQ_82
  s_cmp_ge_u32 s39, 224
  s_nop 1
  s_cbranch_scc1 GTU_83
  s_mul_i32 s14, s12, 229376
  s_lshl_b32 s15, s39, 10
  s_add_u32 s14, s14, s15
  s_add_u32 s14, s14, 16515072
  s_mov_b32 s15, 229376
  s_mov_b32 s16, 458752
  s_mov_b32 s41, 1024
  s_mov_b32 s17, 0
  s_nop 1
  s_branch GGO_85
GTQ_82:
  s_sub_u32 s15, s39, 448
  s_lshl_b32 s15, s15, 17
  s_lshl_b32 s14, s12, 10
  s_add_u32 s14, s14, s15
  s_add_u32 s14, s14, 75235328
  s_mov_b32 s15, 1024
  s_mov_b32 s16, 2048
  s_mov_b32 s41, 131072
  s_mov_b32 s17, 0
  s_cmp_ge_u32 s39, 464
  s_cselect_b32 s42, 1.0, 0x3e8b97f6
  s_nop 1
  s_branch GGO_85
GTU_83:
  s_sub_u32 s15, s39, 224
  s_lshl_b32 s15, s15, 11
  s_mul_i32 s14, s13, 458752
  s_add_u32 s14, s14, s15
  s_add_u32 s14, s14, 45875200
  s_mov_b32 s15, 1024
  s_mov_b32 s16, 458752
  s_mov_b32 s41, 2048
  s_mov_b32 s17, 1
  s_nop 1
  s_branch GGO_85
GTV_84:
  s_sub_u32 s15, s39, 480
  s_lshl_b32 s15, s15, 17
  s_lshl_b32 s14, s13, 10
  s_add_u32 s14, s14, s15
  s_add_u32 s14, s14, 79429632
  s_mov_b32 s15, 65536
  s_mov_b32 s16, 1024
  s_mov_b32 s41, 131072
  s_mov_b32 s17, 1
  s_nop 1
GGO_85:
  s_mov_b32 s43, s42
  v_add_u32 v8, s14, v3
  v_add_u32 v9, s15, v8
  v_add_u32 v10, s16, v8
  v_add_u32 v11, s15, v10
  s_waitcnt vmcnt(0)
  s_barrier
  s_cmp_lg_u32 s17, 0
  s_nop 1
  s_cbranch_scc1 GUT_86
  ds_read_b128 v[128:131], v5 offset:0
  ds_read_b128 v[132:135], v5 offset:14336
  ds_read_b128 v[136:139], v5 offset:1024
  ds_read_b128 v[140:143], v5 offset:15360
  ds_read_b128 v[144:147], v5 offset:2048
  ds_read_b128 v[148:151], v5 offset:16384
  s_mov_b32 s47, 0
  s_nop 1
GLT_87:
  s_waitcnt lgkmcnt(4)
  v_mfma_f32_16x16x32_bf16 v[64:67], v[128:131], a[0:3], 0
  ds_read_b128 v[152:155], v5 offset:3072
  ds_read_b128 v[156:159], v5 offset:17408
  v_mfma_f32_16x16x32_bf16 v[68:71], v[132:135], a[0:3], 0
  v_mfma_f32_16x16x32_bf16 v[72:75], v[128:131], a[56:59], 0
  v_mfma_f32_16x16x32_bf16 v[76:79], v[132:135], a[56:59], 0
  v_mfma_f32_16x16x32_bf16 v[80:83], v[128:131], a[112:115], 0
  v_mfma_f32_16x16x32_bf16 v[84:87], v[132:135], a[112:115], 0
  v_mfma_f32_16x16x32_bf16 v[88:91], v[128:131], a[168:171], 0
  v_mfma_f32_16x16x32_bf16 v[92:95], v[132:135], a[168:171], 0
  s_waitcnt lgkmcnt(4)
  v_mfma_f32_16x16x32_bf16 v[64:67], v[136:139], a[4:7], v[64:67]
  ds_read_b128 v[128:131], v5 offset:4096
  ds_read_b128 v[132:135], v5 offset:18432
  v_mfma_f32_16x16x32_bf16 v[68:71], v[140:143], a[4:7], v[68:71]
  v_mfma_f32_16x16x32_bf16 v[72:75], v[136:139], a[60:63], v[72:75]
  v_pk_mul_f32 v[160:161], v[96:97], s[42:43]
  v_pk_mul_f32 v[162:163], v[98:99], s[42:43]
  v_mfma_f32_16x16x32_bf16 v[76:79], v[140:143], a[60:63], v[76:79]
  v_mfma_f32_16x16x32_bf16 v[80:83], v[136:139], a[116:119], v[80:83]
  v_pk_mul_f32 v[164:165], v[100:101], s[42:43]
  v_pk_mul_f32 v[166:167], v[102:103], s[42:43]
  v_mfma_f32_16x16x32_bf16 v[84:87], v[140:143], a[116:119], v[84:87]
  v_mfma_f32_16x16x32_bf16 v[88:91], v[136:139], a[172:175], v[88:91]
  v_cvt_pk_bf16_f32 v168, v160, v161
  v_cvt_pk_bf16_f32 v169, v162, v163
  v_mfma_f32_16x16x32_bf16 v[92:95], v[140:143], a[172:175], v[92:95]
  s_waitcnt lgkmcnt(4)
  v_mfma_f32_16x16x32_bf16 v[64:67], v[144:147], a[8:11], v[64:67]
  ds_read_b128 v[136:139], v5 offset:5120
  ds_read_b128 v[140:143], v5 offset:19456
  v_mfma_f32_16x16x32_bf16 v[68:71], v[148:151], a[8:11], v[68:71]
  v_mfma_f32_16x16x32_bf16 v[72:75], v[144:147], a[64:67], v[72:75]
  v_cvt_pk_bf16_f32 v170, v164, v165
  v_cvt_pk_bf16_f32 v171, v166, v167
  v_mfma_f32_16x16x32_bf16 v[76:79], v[148:151], a[64:67], v[76:79]
  v_mfma_f32_16x16x32_bf16 v[80:83], v[144:147], a[120:123], v[80:83]
  s_mov_b64 exec, s[48:49]
  global_store_dwordx4 v8, v[168:171], s[8:9] sc0 sc1
  s_nop 1
  v_add_u32 v8, s41, v8
  s_mov_b64 exec, -1
  v_mfma_f32_16x16x32_bf16 v[84:87], v[148:151], a[120:123], v[84:87]
  v_mfma_f32_16x16x32_bf16 v[88:91], v[144:147], a[176:179], v[88:91]
  v_pk_mul_f32 v[176:177], v[104:105], s[42:43]
  v_pk_mul_f32 v[178:179], v[106:107], s[42:43]
  v_mfma_f32_16x16x32_bf16 v[92:95], v[148:151], a[176:179], v[92:95]
  s_waitcnt lgkmcnt(4)
  v_mfma_f32_16x16x32_bf16 v[64:67], v[152:155], a[12:15], v[64:67]
  ds_read_b128 v[144:147], v5 offset:6144
  ds_read_b128 v[148:151], v5 offset:20480
  v_mfma_f32_16x16x32_bf16 v[68:71], v[156:159], a[12:15], v[68:71]
  v_mfma_f32_16x16x32_bf16 v[72:75], v[152:155], a[68:71], v[72:75]
  v_pk_mul_f32 v[180:181], v[108:109], s[42:43]
  v_pk_mul_f32 v[182:183], v[110:111], s[42:43]
  v_mfma_f32_16x16x32_bf16 v[76:79], v[156:159], a[68:71], v[76:79]
  v_mfma_f32_16x16x32_bf16 v[80:83], v[152:155], a[124:127], v[80:83]
  v_cvt_pk_bf16_f32 v184, v176, v177
  v_cvt_pk_bf16_f32 v185, v178, v179
  v_mfma_f32_16x16x32_bf16 v[84:87], v[156:159], a[124:127], v[84:87]
  v_mfma_f32_16x16x32_bf16 v[88:91], v[152:155], a[180:183], v[88:91]
  v_cvt_pk_bf16_f32 v186, v180, v181
  v_cvt_pk_bf16_f32 v187, v182, v183
  v_mfma_f32_16x16x32_bf16 v[92:95], v[156:159], a[180:183], v[92:95]
  s_waitcnt lgkmcnt(4)
  v_mfma_f32_16x16x32_bf16 v[64:67], v[128:131], a[16:19], v[64:67]
  ds_read_b128 v[152:155], v5 offset:7168
  ds_read_b128 v[156:159], v5 offset:21504
  v_mfma_f32_16x16x32_bf16 v[68:71], v[132:135], a[16:19], v[68:71]
  v_mfma_f32_16x16x32_bf16 v[72:75], v[128:131], a[72:75], v[72:75]
  s_mov_b64 exec, s[48:49]
  global_store_dwordx4 v9, v[184:187], s[8:9] sc0 sc1
  s_nop 1
  v_add_u32 v9, s41, v9
  s_mov_b64 exec, -1
  v_mfma_f32_16x16x32_bf16 v[76:79], v[132:135], a[72:75], v[76:79]
  v_mfma_f32_16x16x32_bf16 v[80:83], v[128:131], a[128:131], v[80:83]
  v_pk_mul_f32 v[160:161], v[112:113], s[42:43]
  v_pk_mul_f32 v[162:163], v[114:115], s[42:43]
  v_mfma_f32_16x16x32_bf16 v[84:87], v[132:135], a[128:131], v[84:87]
  v_mfma_f32_16x16x32_bf16 v[88:91], v[128:131], a[184:187], v[88:91]
  v_pk_mul_f32 v[164:165], v[116:117], s[42:43]
  v_pk_mul_f32 v[166:167], v[118:119], s[42:43]
  v_mfma_f32_16x16x32_bf16 v[92:95], v[132:135], a[184:187], v[92:95]
  s_waitcnt lgkmcnt(4)
  v_mfma_f32_16x16x32_bf16 v[64:67], v[136:139], a[20:23], v[64:67]
  ds_read_b128 v[128:131], v5 offset:8192
  ds_read_b128 v[132:135], v5 offset:22528
  v_mfma_f32_16x16x32_bf16 v[68:71], v[140:143], a[20:23], v[68:71]
  v_mfma_f32_16x16x32_bf16 v[72:75], v[136:139], a[76:79], v[72:75]
  v_cvt_pk_bf16_f32 v168, v160, v161
  v_cvt_pk_bf16_f32 v169, v162, v163
  v_mfma_f32_16x16x32_bf16 v[76:79], v[140:143], a[76:79], v[76:79]
  v_mfma_f32_16x16x32_bf16 v[80:83], v[136:139], a[132:135], v[80:83]
  v_cvt_pk_bf16_f32 v170, v164, v165
  v_cvt_pk_bf16_f32 v171, v166, v167
  v_mfma_f32_16x16x32_bf16 v[84:87], v[140:143], a[132:135], v[84:87]
  v_mfma_f32_16x16x32_bf16 v[88:91], v[136:139], a[188:191], v[88:91]
  s_mov_b64 exec, s[48:49]
  global_store_dwordx4 v10, v[168:171], s[8:9] sc0 sc1
  s_nop 1
  v_add_u32 v10, s41, v10
  s_mov_b64 exec, -1
  v_mfma_f32_16x16x32_bf16 v[92:95], v[140:143], a[188:191], v[92:95]
  s_waitcnt lgkmcnt(4)
  v_mfma_f32_16x16x32_bf16 v[64:67], v[144:147], a[24:27], v[64:67]
  ds_read_b128 v[136:139], v5 offset:9216
  ds_read_b128 v[140:143], v5 offset:23552
  v_mfma_f32_16x16x32_bf16 v[68:71], v[148:151], a[24:27], v[68:71]
  v_mfma_f32_16x16x32_bf16 v[72:75], v[144:147], a[80:83], v[72:75]
  v_pk_mul_f32 v[176:177], v[120:121], s[42:43]
  v_pk_mul_f32 v[178:179], v[122:123], s[42:43]
  v_mfma_f32_16x16x32_bf16 v[76:79], v[148:151], a[80:83], v[76:79]
  v_mfma_f32_16x16x32_bf16 v[80:83], v[144:147], a[136:139], v[80:83]
  v_pk_mul_f32 v[180:181], v[124:125], s[42:43]
  v_pk_mul_f32 v[182:183], v[126:127], s[42:43]
  v_mfma_f32_16x16x32_bf16 v[84:87], v[148:151], a[136:139], v[84:87]
  v_mfma_f32_16x16x32_bf16 v[88:91], v[144:147], a[192:195], v[88:91]
  v_cvt_pk_bf16_f32 v184, v176, v177
  v_cvt_pk_bf16_f32 v185, v178, v179
  v_mfma_f32_16x16x32_bf16 v[92:95], v[148:151], a[192:195], v[92:95]
  s_waitcnt lgkmcnt(4)
  v_mfma_f32_16x16x32_bf16 v[64:67], v[152:155], a[28:31], v[64:67]
  ds_read_b128 v[144:147], v5 offset:10240
  ds_read_b128 v[148:151], v5 offset:24576
  v_mfma_f32_16x16x32_bf16 v[68:71], v[156:159], a[28:31], v[68:71]
  v_mfma_f32_16x16x32_bf16 v[72:75], v[152:155], a[84:87], v[72:75]
  v_cvt_pk_bf16_f32 v186, v180, v181
  v_cvt_pk_bf16_f32 v187, v182, v183
  v_mfma_f32_16x16x32_bf16 v[76:79], v[156:159], a[84:87], v[76:79]
  v_mfma_f32_16x16x32_bf16 v[80:83], v[152:155], a[140:143], v[80:83]
  s_mov_b64 exec, s[48:49]
  global_store_dwordx4 v11, v[184:187], s[8:9] sc0 sc1
  s_nop 1
  v_add_u32 v11, s41, v11
  s_mov_b64 exec, -1
  v_mfma_f32_16x16x32_bf16 v[84:87], v[156:159], a[140:143], v[84:87]
  v_mfma_f32_16x16x32_bf16 v[88:91], v[152:155], a[196:199], v[88:91]
  v_mfma_f32_16x16x32_bf16 v[92:95], v[156:159], a[196:199], v[92:95]
  s_waitcnt lgkmcnt(4)
  v_mfma_f32_16x16x32_bf16 v[64:67], v[128:131], a[32:35], v[64:67]
  ds_read_b128 v[152:155], v5 offset:11264
  ds_read_b128 v[156:159], v5 offset:25600
  v_mfma_f32_16x16x32_bf16 v[68:71], v[132:135], a[32:35], v[68:71]
  v_mfma_f32_16x16x32_bf16 v[72:75], v[128:131], a[88:91], v[72:75]
  v_mfma_f32_16x16x32_bf16 v[76:79], v[132:135], a[88:91], v[76:79]
  v_mfma_f32_16x16x32_bf16 v[80:83], v[128:131], a[144:147], v[80:83]
  v_mfma_f32_16x16x32_bf16 v[84:87], v[132:135], a[144:147], v[84:87]
  v_mfma_f32_16x16x32_bf16 v[88:91], v[128:131], a[200:203], v[88:91]
  v_mfma_f32_16x16x32_bf16 v[92:95], v[132:135], a[200:203], v[92:95]
  s_waitcnt vmcnt(4)
  s_barrier
  s_add_u32 s12, s47, 1
  s_cmp_ge_u32 s12, s46
  s_nop 3
  s_cbranch_scc1 GSD_89
  s_mov_b32 m0, s44
  s_nop 0
  global_load_lds_dwordx4 v4, s[8:9] offset:0
  global_load_lds_dwordx4 v4, s[8:9] offset:1024
  global_load_lds_dwordx4 v4, s[8:9] offset:2048
  global_load_lds_dwordx4 v4, s[8:9] offset:3072
  s_add_u32 m0, s44, 4096
  s_nop 0
  v_add_u32 v4, 4096, v4
  global_load_lds_dwordx4 v4, s[8:9] offset:0
  global_load_lds_dwordx4 v4, s[8:9] offset:1024
  global_load_lds_dwordx4 v4, s[8:9] offset:2048
  s_nop 1
  v_add_u32 v4, 24576, v4
  s_add_u32 s44, s44, 28672
  s_cmp_ge_u32 s44, 86016
  s_cselect_b32 s45, 86016, 0
  s_sub_u32 s44, s44, s45
  s_nop 1
GSD_89:
  s_waitcnt lgkmcnt(4)
  v_mfma_f32_16x16x32_bf16 v[64:67], v[136:139], a[36:39], v[64:67]
  ds_read_b128 v[128:131], v5 offset:12288
  ds_read_b128 v[132:135], v5 offset:26624
  v_mfma_f32_16x16x32_bf16 v[68:71], v[140:143], a[36:39], v[68:71]
  v_mfma_f32_16x16x32_bf16 v[72:75], v[136:139], a[92:95], v[72:75]
  v_mfma_f32_16x16x32_bf16 v[76:79], v[140:143], a[92:95], v[76:79]
  v_mfma_f32_16x16x32_bf16 v[80:83], v[136:139], a[148:151], v[80:83]
  v_mfma_f32_16x16x32_bf16 v[84:87], v[140:143], a[148:151], v[84:87]
  v_mfma_f32_16x16x32_bf16 v[88:91], v[136:139], a[204:207], v[88:91]
  v_mfma_f32_16x16x32_bf16 v[92:95], v[140:143], a[204:207], v[92:95]
  s_waitcnt lgkmcnt(4)
  v_mfma_f32_16x16x32_bf16 v[64:67], v[144:147], a[40:43], v[64:67]
  ds_read_b128 v[136:139], v5 offset:13312
  ds_read_b128 v[140:143], v5 offset:27648
  v_mfma_f32_16x16x32_bf16 v[68:71], v[148:151], a[40:43], v[68:71]
  v_mfma_f32_16x16x32_bf16 v[72:75], v[144:147], a[96:99], v[72:75]
  v_mfma_f32_16x16x32_bf16 v[76:79], v[148:151], a[96:99], v[76:79]
  v_mfma_f32_16x16x32_bf16 v[80:83], v[144:147], a[152:155], v[80:83]
  v_mfma_f32_16x16x32_bf16 v[84:87], v[148:151], a[152:155], v[84:87]
  v_mfma_f32_16x16x32_bf16 v[88:91], v[144:147], a[208:211], v[88:91]
  v_mfma_f32_16x16x32_bf16 v[92:95], v[148:151], a[208:211], v[92:95]
  s_waitcnt lgkmcnt(4)
  v_mfma_f32_16x16x32_bf16 v[64:67], v[152:155], a[44:47], v[64:67]
  ds_read_b128 v[144:147], v6 offset:0
  ds_read_b128 v[148:151], v6 offset:14336
  v_mfma_f32_16x16x32_bf16 v[68:71], v[156:159], a[44:47], v[68:71]
  v_mfma_f32_16x16x32_bf16 v[72:75], v[152:155], a[100:103], v[72:75]
  v_mfma_f32_16x16x32_bf16 v[76:79], v[156:159], a[100:103], v[76:79]
  v_mfma_f32_16x16x32_bf16 v[80:83], v[152:155], a[156:159], v[80:83]
  v_mfma_f32_16x16x32_bf16 v[84:87], v[156:159], a[156:159], v[84:87]
  v_mfma_f32_16x16x32_bf16 v[88:91], v[152:155], a[212:215], v[88:91]
  v_mfma_f32_16x16x32_bf16 v[92:95], v[156:159], a[212:215], v[92:95]
  s_waitcnt lgkmcnt(4)
  v_mfma_f32_16x16x32_bf16 v[64:67], v[128:131], a[48:51], v[64:67]
  ds_read_b128 v[152:155], v6 offset:1024
  ds_read_b128 v[156:159], v6 offset:15360
  v_mfma_f32_16x16x32_bf16 v[68:71], v[132:135], a[48:51], v[68:71]
  v_mfma_f32_16x16x32_bf16 v[72:75], v[128:131], a[104:107], v[72:75]
  v_mfma_f32_16x16x32_bf16 v[76:79], v[132:135], a[104:107], v[76:79]
  v_mfma_f32_16x16x32_bf16 v[80:83], v[128:131], a[160:163], v[80:83]
  v_mfma_f32_16x16x32_bf16 v[84:87], v[132:135], a[160:163], v[84:87]
  v_mfma_f32_16x16x32_bf16 v[88:91], v[128:131], a[216:219], v[88:91]
  v_mfma_f32_16x16x32_bf16 v[92:95], v[132:135], a[216:219], v[92:95]
  s_waitcnt lgkmcnt(4)
  v_mfma_f32_16x16x32_bf16 v[64:67], v[136:139], a[52:55], v[64:67]
  ds_read_b128 v[128:131], v6 offset:2048
  ds_read_b128 v[132:135], v6 offset:16384
  v_mfma_f32_16x16x32_bf16 v[68:71], v[140:143], a[52:55], v[68:71]
  v_mfma_f32_16x16x32_bf16 v[72:75], v[136:139], a[108:111], v[72:75]
  v_mfma_f32_16x16x32_bf16 v[76:79], v[140:143], a[108:111], v[76:79]
  v_mfma_f32_16x16x32_bf16 v[80:83], v[136:139], a[164:167], v[80:83]
  v_mfma_f32_16x16x32_bf16 v[84:87], v[140:143], a[164:167], v[84:87]
  v_mfma_f32_16x16x32_bf16 v[88:91], v[136:139], a[220:223], v[88:91]
  v_mfma_f32_16x16x32_bf16 v[92:95], v[140:143], a[220:223], v[92:95]
  v_mov_b32 v5, v6
  v_add_u32 v6, 28672, v6
  v_subrev_u32 v12, 86016, v6
  v_min_u32 v6, v12, v6
  s_mov_b64 s[48:49], -1
  s_waitcnt lgkmcnt(4)
  v_mfma_f32_16x16x32_bf16 v[96:99], v[144:147], a[0:3], 0
  ds_read_b128 v[136:139], v5 offset:3072
  ds_read_b128 v[140:143], v5 offset:17408
  v_mfma_f32_16x16x32_bf16 v[100:103], v[148:151], a[0:3], 0
  v_mfma_f32_16x16x32_bf16 v[104:107], v[144:147], a[56:59], 0
  v_mfma_f32_16x16x32_bf16 v[108:111], v[148:151], a[56:59], 0
  v_mfma_f32_16x16x32_bf16 v[112:115], v[144:147], a[112:115], 0
  v_mfma_f32_16x16x32_bf16 v[116:119], v[148:151], a[112:115], 0
  v_mfma_f32_16x16x32_bf16 v[120:123], v[144:147], a[168:171], 0
  v_mfma_f32_16x16x32_bf16 v[124:127], v[148:151], a[168:171], 0
  s_waitcnt lgkmcnt(4)
  v_mfma_f32_16x16x32_bf16 v[96:99], v[152:155], a[4:7], v[96:99]
  ds_read_b128 v[144:147], v5 offset:4096
  ds_read_b128 v[148:151], v5 offset:18432
  v_mfma_f32_16x16x32_bf16 v[100:103], v[156:159], a[4:7], v[100:103]
  v_mfma_f32_16x16x32_bf16 v[104:107], v[152:155], a[60:63], v[104:107]
  v_pk_mul_f32 v[160:161], v[64:65], s[42:43]
  v_pk_mul_f32 v[162:163], v[66:67], s[42:43]
  v_mfma_f32_16x16x32_bf16 v[108:111], v[156:159], a[60:63], v[108:111]
  v_mfma_f32_16x16x32_bf16 v[112:115], v[152:155], a[116:119], v[112:115]
  v_pk_mul_f32 v[164:165], v[68:69], s[42:43]
  v_pk_mul_f32 v[166:167], v[70:71], s[42:43]
  v_mfma_f32_16x16x32_bf16 v[116:119], v[156:159], a[116:119], v[116:119]
  v_mfma_f32_16x16x32_bf16 v[120:123], v[152:155], a[172:175], v[120:123]
  v_cvt_pk_bf16_f32 v168, v160, v161
  v_cvt_pk_bf16_f32 v169, v162, v163
  v_mfma_f32_16x16x32_bf16 v[124:127], v[156:159], a[172:175], v[124:127]
  s_waitcnt lgkmcnt(4)
  v_mfma_f32_16x16x32_bf16 v[96:99], v[128:131], a[8:11], v[96:99]
  ds_read_b128 v[152:155], v5 offset:5120
  ds_read_b128 v[156:159], v5 offset:19456
  v_mfma_f32_16x16x32_bf16 v[100:103], v[132:135], a[8:11], v[100:103]
  v_mfma_f32_16x16x32_bf16 v[104:107], v[128:131], a[64:67], v[104:107]
  v_cvt_pk_bf16_f32 v170, v164, v165
  v_cvt_pk_bf16_f32 v171, v166, v167
  v_mfma_f32_16x16x32_bf16 v[108:111], v[132:135], a[64:67], v[108:111]
  v_mfma_f32_16x16x32_bf16 v[112:115], v[128:131], a[120:123], v[112:115]
  global_store_dwordx4 v8, v[168:171], s[8:9] sc0 sc1
  s_nop 1
  v_add_u32 v8, s41, v8
  v_mfma_f32_16x16x32_bf16 v[116:119], v[132:135], a[120:123], v[116:119]
  v_mfma_f32_16x16x32_bf16 v[120:123], v[128:131], a[176:179], v[120:123]
  v_pk_mul_f32 v[176:177], v[72:73], s[42:43]
  v_pk_mul_f32 v[178:179], v[74:75], s[42:43]
  v_mfma_f32_16x16x32_bf16 v[124:127], v[132:135], a[176:179], v[124:127]
  s_waitcnt lgkmcnt(4)
  v_mfma_f32_16x16x32_bf16 v[96:99], v[136:139], a[12:15], v[96:99]
  ds_read_b128 v[128:131], v5 offset:6144
  ds_read_b128 v[132:135], v5 offset:20480
  v_mfma_f32_16x16x32_bf16 v[100:103], v[140:143], a[12:15], v[100:103]
  v_mfma_f32_16x16x32_bf16 v[104:107], v[136:139], a[68:71], v[104:107]
  v_pk_mul_f32 v[180:181], v[76:77], s[42:43]
  v_pk_mul_f32 v[182:183], v[78:79], s[42:43]
  v_mfma_f32_16x16x32_bf16 v[108:111], v[140:143], a[68:71], v[108:111]
  v_mfma_f32_16x16x32_bf16 v[112:115], v[136:139], a[124:127], v[112:115]
  v_cvt_pk_bf16_f32 v184, v176, v177
  v_cvt_pk_bf16_f32 v185, v178, v179
  v_mfma_f32_16x16x32_bf16 v[116:119], v[140:143], a[124:127], v[116:119]
  v_mfma_f32_16x16x32_bf16 v[120:123], v[136:139], a[180:183], v[120:123]
  v_cvt_pk_bf16_f32 v186, v180, v181
  v_cvt_pk_bf16_f32 v187, v182, v183
  v_mfma_f32_16x16x32_bf16 v[124:127], v[140:143], a[180:183], v[124:127]
  s_waitcnt lgkmcnt(4)
  v_mfma_f32_16x16x32_bf16 v[96:99], v[144:147], a[16:19], v[96:99]
  ds_read_b128 v[136:139], v5 offset:7168
  ds_read_b128 v[140:143], v5 offset:21504
  v_mfma_f32_16x16x32_bf16 v[100:103], v[148:151], a[16:19], v[100:103]
  v_mfma_f32_16x16x32_bf16 v[104:107], v[144:147], a[72:75], v[104:107]
  global_store_dwordx4 v9, v[184:187], s[8:9] sc0 sc1
  s_nop 1
  v_add_u32 v9, s41, v9
  v_mfma_f32_16x16x32_bf16 v[108:111], v[148:151], a[72:75], v[108:111]
  v_mfma_f32_16x16x32_bf16 v[112:115], v[144:147], a[128:131], v[112:115]
  v_pk_mul_f32 v[160:161], v[80:81], s[42:43]
  v_pk_mul_f32 v[162:163], v[82:83], s[42:43]
  v_mfma_f32_16x16x32_bf16 v[116:119], v[148:151], a[128:131], v[116:119]
  v_mfma_f32_16x16x32_bf16 v[120:123], v[144:147], a[184:187], v[120:123]
  v_pk_mul_f32 v[164:165], v[84:85], s[42:43]
  v_pk_mul_f32 v[166:167], v[86:87], s[42:43]
  v_mfma_f32_16x16x32_bf16 v[124:127], v[148:151], a[184:187], v[124:127]
  s_waitcnt lgkmcnt(4)
  v_mfma_f32_16x16x32_bf16 v[96:99], v[152:155], a[20:23], v[96:99]
  ds_read_b128 v[144:147], v5 offset:8192
  ds_read_b128 v[148:151], v5 offset:22528
  v_mfma_f32_16x16x32_bf16 v[100:103], v[156:159], a[20:23], v[100:103]
  v_mfma_f32_16x16x32_bf16 v[104:107], v[152:155], a[76:79], v[104:107]
  v_cvt_pk_bf16_f32 v168, v160, v161
  v_cvt_pk_bf16_f32 v169, v162, v163
  v_mfma_f32_16x16x32_bf16 v[108:111], v[156:159], a[76:79], v[108:111]
  v_mfma_f32_16x16x32_bf16 v[112:115], v[152:155], a[132:135], v[112:115]
  v_cvt_pk_bf16_f32 v170, v164, v165
  v_cvt_pk_bf16_f32 v171, v166, v167
  v_mfma_f32_16x16x32_bf16 v[116:119], v[156:159], a[132:135], v[116:119]
  v_mfma_f32_16x16x32_bf16 v[120:123], v[152:155], a[188:191], v[120:123]
  global_store_dwordx4 v10, v[168:171], s[8:9] sc0 sc1
  s_nop 1
  v_add_u32 v10, s41, v10
  v_mfma_f32_16x16x32_bf16 v[124:127], v[156:159], a[188:191], v[124:127]
  s_waitcnt lgkmcnt(4)
  v_mfma_f32_16x16x32_bf16 v[96:99], v[128:131], a[24:27], v[96:99]
  ds_read_b128 v[152:155], v5 offset:9216
  ds_read_b128 v[156:159], v5 offset:23552
  v_mfma_f32_16x16x32_bf16 v[100:103], v[132:135], a[24:27], v[100:103]
  v_mfma_f32_16x16x32_bf16 v[104:107], v[128:131], a[80:83], v[104:107]
  v_pk_mul_f32 v[176:177], v[88:89], s[42:43]
  v_pk_mul_f32 v[178:179], v[90:91], s[42:43]
  v_mfma_f32_16x16x32_bf16 v[108:111], v[132:135], a[80:83], v[108:111]
  v_mfma_f32_16x16x32_bf16 v[112:115], v[128:131], a[136:139], v[112:115]
  v_pk_mul_f32 v[180:181], v[92:93], s[42:43]
  v_pk_mul_f32 v[182:183], v[94:95], s[42:43]
  v_mfma_f32_16x16x32_bf16 v[116:119], v[132:135], a[136:139], v[116:119]
  v_mfma_f32_16x16x32_bf16 v[120:123], v[128:131], a[192:195], v[120:123]
  v_cvt_pk_bf16_f32 v184, v176, v177
  v_cvt_pk_bf16_f32 v185, v178, v179
  v_mfma_f32_16x16x32_bf16 v[124:127], v[132:135], a[192:195], v[124:127]
  s_waitcnt lgkmcnt(4)
  v_mfma_f32_16x16x32_bf16 v[96:99], v[136:139], a[28:31], v[96:99]
  ds_read_b128 v[128:131], v5 offset:10240
  ds_read_b128 v[132:135], v5 offset:24576
  v_mfma_f32_16x16x32_bf16 v[100:103], v[140:143], a[28:31], v[100:103]
  v_mfma_f32_16x16x32_bf16 v[104:107], v[136:139], a[84:87], v[104:107]
  v_cvt_pk_bf16_f32 v186, v180, v181
  v_cvt_pk_bf16_f32 v187, v182, v183
  v_mfma_f32_16x16x32_bf16 v[108:111], v[140:143], a[84:87], v[108:111]
  v_mfma_f32_16x16x32_bf16 v[112:115], v[136:139], a[140:143], v[112:115]
  global_store_dwordx4 v11, v[184:187], s[8:9] sc0 sc1
  s_nop 1
  v_add_u32 v11, s41, v11
  v_mfma_f32_16x16x32_bf16 v[116:119], v[140:143], a[140:143], v[116:119]
  v_mfma_f32_16x16x32_bf16 v[120:123], v[136:139], a[196:199], v[120:123]
  v_mfma_f32_16x16x32_bf16 v[124:127], v[140:143], a[196:199], v[124:127]
  s_waitcnt lgkmcnt(4)
  v_mfma_f32_16x16x32_bf16 v[96:99], v[144:147], a[32:35], v[96:99]
  ds_read_b128 v[136:139], v5 offset:11264
  ds_read_b128 v[140:143], v5 offset:25600
  v_mfma_f32_16x16x32_bf16 v[100:103], v[148:151], a[32:35], v[100:103]
  v_mfma_f32_16x16x32_bf16 v[104:107], v[144:147], a[88:91], v[104:107]
  v_mfma_f32_16x16x32_bf16 v[108:111], v[148:151], a[88:91], v[108:111]
  v_mfma_f32_16x16x32_bf16 v[112:115], v[144:147], a[144:147], v[112:115]
  v_mfma_f32_16x16x32_bf16 v[116:119], v[148:151], a[144:147], v[116:119]
  v_mfma_f32_16x16x32_bf16 v[120:123], v[144:147], a[200:203], v[120:123]
  v_mfma_f32_16x16x32_bf16 v[124:127], v[148:151], a[200:203], v[124:127]
  s_waitcnt vmcnt(4)
  s_barrier
  s_add_u32 s12, s47, 1
  s_cmp_ge_u32 s12, s46
  s_nop 3
  s_cbranch_scc1 GSD_91
  s_mov_b32 m0, s44
  s_nop 0
  global_load_lds_dwordx4 v4, s[8:9] offset:0
  global_load_lds_dwordx4 v4, s[8:9] offset:1024
  global_load_lds_dwordx4 v4, s[8:9] offset:2048
  global_load_lds_dwordx4 v4, s[8:9] offset:3072
  s_add_u32 m0, s44, 4096
  s_nop 0
  v_add_u32 v4, 4096, v4
  global_load_lds_dwordx4 v4, s[8:9] offset:0
  global_load_lds_dwordx4 v4, s[8:9] offset:1024
  global_load_lds_dwordx4 v4, s[8:9] offset:2048
  s_nop 1
  v_add_u32 v4, 24576, v4
  s_add_u32 s44, s44, 28672
  s_cmp_ge_u32 s44, 86016
  s_cselect_b32 s45, 86016, 0
  s_sub_u32 s44, s44, s45
  s_nop 1
GSD_91:
  s_waitcnt lgkmcnt(4)
  v_mfma_f32_16x16x32_bf16 v[96:99], v[152:155], a[36:39], v[96:99]
  ds_read_b128 v[144:147], v5 offset:12288
  ds_read_b128 v[148:151], v5 offset:26624
  v_mfma_f32_16x16x32_bf16 v[100:103], v[156:159], a[36:39], v[100:103]
  v_mfma_f32_16x16x32_bf16 v[104:107], v[152:155], a[92:95], v[104:107]
  v_mfma_f32_16x16x32_bf16 v[108:111], v[156:159], a[92:95], v[108:111]
  v_mfma_f32_16x16x32_bf16 v[112:115], v[152:155], a[148:151], v[112:115]
  v_mfma_f32_16x16x32_bf16 v[116:119], v[156:159], a[148:151], v[116:119]
  v_mfma_f32_16x16x32_bf16 v[120:123], v[152:155], a[204:207], v[120:123]
  v_mfma_f32_16x16x32_bf16 v[124:127], v[156:159], a[204:207], v[124:127]
  s_waitcnt lgkmcnt(4)
  v_mfma_f32_16x16x32_bf16 v[96:99], v[128:131], a[40:43], v[96:99]
  ds_read_b128 v[152:155], v5 offset:13312
  ds_read_b128 v[156:159], v5 offset:27648
  v_mfma_f32_16x16x32_bf16 v[100:103], v[132:135], a[40:43], v[100:103]
  v_mfma_f32_16x16x32_bf16 v[104:107], v[128:131], a[96:99], v[104:107]
  v_mfma_f32_16x16x32_bf16 v[108:111], v[132:135], a[96:99], v[108:111]
  v_mfma_f32_16x16x32_bf16 v[112:115], v[128:131], a[152:155], v[112:115]
  v_mfma_f32_16x16x32_bf16 v[116:119], v[132:135], a[152:155], v[116:119]
  v_mfma_f32_16x16x32_bf16 v[120:123], v[128:131], a[208:211], v[120:123]
  v_mfma_f32_16x16x32_bf16 v[124:127], v[132:135], a[208:211], v[124:127]
  s_waitcnt lgkmcnt(4)
  v_mfma_f32_16x16x32_bf16 v[96:99], v[136:139], a[44:47], v[96:99]
  ds_read_b128 v[128:131], v6 offset:0
  ds_read_b128 v[132:135], v6 offset:14336
  v_mfma_f32_16x16x32_bf16 v[100:103], v[140:143], a[44:47], v[100:103]
  v_mfma_f32_16x16x32_bf16 v[104:107], v[136:139], a[100:103], v[104:107]
  v_mfma_f32_16x16x32_bf16 v[108:111], v[140:143], a[100:103], v[108:111]
  v_mfma_f32_16x16x32_bf16 v[112:115], v[136:139], a[156:159], v[112:115]
  v_mfma_f32_16x16x32_bf16 v[116:119], v[140:143], a[156:159], v[116:119]
  v_mfma_f32_16x16x32_bf16 v[120:123], v[136:139], a[212:215], v[120:123]
  v_mfma_f32_16x16x32_bf16 v[124:127], v[140:143], a[212:215], v[124:127]
  s_waitcnt lgkmcnt(4)
  v_mfma_f32_16x16x32_bf16 v[96:99], v[144:147], a[48:51], v[96:99]
  ds_read_b128 v[136:139], v6 offset:1024
  ds_read_b128 v[140:143], v6 offset:15360
  v_mfma_f32_16x16x32_bf16 v[100:103], v[148:151], a[48:51], v[100:103]
  v_mfma_f32_16x16x32_bf16 v[104:107], v[144:147], a[104:107], v[104:107]
  v_mfma_f32_16x16x32_bf16 v[108:111], v[148:151], a[104:107], v[108:111]
  v_mfma_f32_16x16x32_bf16 v[112:115], v[144:147], a[160:163], v[112:115]
  v_mfma_f32_16x16x32_bf16 v[116:119], v[148:151], a[160:163], v[116:119]
  v_mfma_f32_16x16x32_bf16 v[120:123], v[144:147], a[216:219], v[120:123]
  v_mfma_f32_16x16x32_bf16 v[124:127], v[148:151], a[216:219], v[124:127]
  s_waitcnt lgkmcnt(4)
  v_mfma_f32_16x16x32_bf16 v[96:99], v[152:155], a[52:55], v[96:99]
  ds_read_b128 v[144:147], v6 offset:2048
  ds_read_b128 v[148:151], v6 offset:16384
  v_mfma_f32_16x16x32_bf16 v[100:103], v[156:159], a[52:55], v[100:103]
  v_mfma_f32_16x16x32_bf16 v[104:107], v[152:155], a[108:111], v[104:107]
  v_mfma_f32_16x16x32_bf16 v[108:111], v[156:159], a[108:111], v[108:111]
  v_mfma_f32_16x16x32_bf16 v[112:115], v[152:155], a[164:167], v[112:115]
  v_mfma_f32_16x16x32_bf16 v[116:119], v[156:159], a[164:167], v[116:119]
  v_mfma_f32_16x16x32_bf16 v[120:123], v[152:155], a[220:223], v[120:123]
  v_mfma_f32_16x16x32_bf16 v[124:127], v[156:159], a[220:223], v[124:127]
  v_mov_b32 v5, v6
  v_add_u32 v6, 28672, v6
  v_subrev_u32 v12, 86016, v6
  v_min_u32 v6, v12, v6
  s_mov_b64 s[48:49], -1
  s_add_u32 s47, s47, 1
  s_cmp_lt_u32 s47, s46
  s_nop 1
  s_cbranch_scc1 GLT_87
  v_pk_mul_f32 v[160:161], v[96:97], s[42:43]
  v_pk_mul_f32 v[162:163], v[98:99], s[42:43]
  v_pk_mul_f32 v[164:165], v[100:101], s[42:43]
  v_pk_mul_f32 v[166:167], v[102:103], s[42:43]
  v_cvt_pk_bf16_f32 v168, v160, v161
  v_cvt_pk_bf16_f32 v169, v162, v163
  v_cvt_pk_bf16_f32 v170, v164, v165
  v_cvt_pk_bf16_f32 v171, v166, v167
  global_store_dwordx4 v8, v[168:171], s[8:9] sc0 sc1
  s_nop 1
  v_add_u32 v8, s41, v8
  v_pk_mul_f32 v[176:177], v[104:105], s[42:43]
  v_pk_mul_f32 v[178:179], v[106:107], s[42:43]
  v_pk_mul_f32 v[180:181], v[108:109], s[42:43]
  v_pk_mul_f32 v[182:183], v[110:111], s[42:43]
  v_cvt_pk_bf16_f32 v184, v176, v177
  v_cvt_pk_bf16_f32 v185, v178, v179
  v_cvt_pk_bf16_f32 v186, v180, v181
  v_cvt_pk_bf16_f32 v187, v182, v183
  global_store_dwordx4 v9, v[184:187], s[8:9] sc0 sc1
  s_nop 1
  v_add_u32 v9, s41, v9
  v_pk_mul_f32 v[160:161], v[112:113], s[42:43]
  v_pk_mul_f32 v[162:163], v[114:115], s[42:43]
  v_pk_mul_f32 v[164:165], v[116:117], s[42:43]
  v_pk_mul_f32 v[166:167], v[118:119], s[42:43]
  v_cvt_pk_bf16_f32 v168, v160, v161
  v_cvt_pk_bf16_f32 v169, v162, v163
  v_cvt_pk_bf16_f32 v170, v164, v165
  v_cvt_pk_bf16_f32 v171, v166, v167
  global_store_dwordx4 v10, v[168:171], s[8:9] sc0 sc1
  s_nop 1
  v_add_u32 v10, s41, v10
  v_pk_mul_f32 v[176:177], v[120:121], s[42:43]
  v_pk_mul_f32 v[178:179], v[122:123], s[42:43]
  v_pk_mul_f32 v[180:181], v[124:125], s[42:43]
  v_pk_mul_f32 v[182:183], v[126:127], s[42:43]
  v_cvt_pk_bf16_f32 v184, v176, v177
  v_cvt_pk_bf16_f32 v185, v178, v179
  v_cvt_pk_bf16_f32 v186, v180, v181
  v_cvt_pk_bf16_f32 v187, v182, v183
  global_store_dwordx4 v11, v[184:187], s[8:9] sc0 sc1
  s_nop 1
  v_add_u32 v11, s41, v11
  s_waitcnt vmcnt(0) lgkmcnt(0)
  s_lshl_b32 s12, s40, 2
  s_add_u32 s12, s12, s10
  s_lshl_b32 s12, s12, 8
  s_lshr_b32 s13, s39, 3
  s_lshl_b32 s13, s13, 2
  s_add_u32 s12, s12, s13
  s_add_u32 s12, s12, 103337984
  v_lshl_add_u32 v12, v2, 2, s12
  s_min_u32 s13, s46, 4
  v_mov_b32 v13, s13
  s_lshr_b32 s13, s46, 2
  s_max_u32 s13, s13, 1
  v_cmp_gt_u32 vcc, s13, v2
  s_mov_b64 exec, vcc
  global_atomic_add v12, v13, s[8:9] sc1
  s_mov_b64 exec, -1
  s_barrier
  s_nop 1
  s_branch WLOOP_71
GUT_86:
  ds_read_b128 v[128:131], v5 offset:0
  ds_read_b128 v[132:135], v5 offset:14336
  ds_read_b128 v[136:139], v5 offset:1024
  ds_read_b128 v[140:143], v5 offset:15360
  ds_read_b128 v[144:147], v5 offset:2048
  ds_read_b128 v[148:151], v5 offset:16384
  s_mov_b32 s47, 0
  s_nop 1
GLU_92:
  s_waitcnt lgkmcnt(4)
  v_mfma_f32_16x16x32_bf16 v[64:67], a[0:3], v[128:131], 0
  ds_read_b128 v[152:155], v5 offset:3072
  ds_read_b128 v[156:159], v5 offset:17408
  v_mfma_f32_16x16x32_bf16 v[68:71], a[0:3], v[132:135], 0
  v_mfma_f32_16x16x32_bf16 v[72:75], a[56:59], v[128:131], 0
  v_mfma_f32_16x16x32_bf16 v[76:79], a[56:59], v[132:135], 0
  v_mfma_f32_16x16x32_bf16 v[80:83], a[112:115], v[128:131], 0
  v_mfma_f32_16x16x32_bf16 v[84:87], a[112:115], v[132:135], 0
  v_mfma_f32_16x16x32_bf16 v[88:91], a[168:171], v[128:131], 0
  v_mfma_f32_16x16x32_bf16 v[92:95], a[168:171], v[132:135], 0
  s_waitcnt lgkmcnt(4)
  v_mfma_f32_16x16x32_bf16 v[64:67], a[4:7], v[136:139], v[64:67]
  ds_read_b128 v[128:131], v5 offset:4096
  ds_read_b128 v[132:135], v5 offset:18432
  v_mfma_f32_16x16x32_bf16 v[68:71], a[4:7], v[140:143], v[68:71]
  v_mfma_f32_16x16x32_bf16 v[72:75], a[60:63], v[136:139], v[72:75]
  v_pk_mul_f32 v[160:161], v[96:97], s[42:43]
  v_pk_mul_f32 v[162:163], v[98:99], s[42:43]
  v_mfma_f32_16x16x32_bf16 v[76:79], a[60:63], v[140:143], v[76:79]
  v_mfma_f32_16x16x32_bf16 v[80:83], a[116:119], v[136:139], v[80:83]
  v_pk_mul_f32 v[164:165], v[104:105], s[42:43]
  v_pk_mul_f32 v[166:167], v[106:107], s[42:43]
  v_mfma_f32_16x16x32_bf16 v[84:87], a[116:119], v[140:143], v[84:87]
  v_mfma_f32_16x16x32_bf16 v[88:91], a[172:175], v[136:139], v[88:91]
  v_cvt_pk_bf16_f32 v168, v160, v161
  v_cvt_pk_bf16_f32 v169, v162, v163
  v_mfma_f32_16x16x32_bf16 v[92:95], a[172:175], v[140:143], v[92:95]
  s_waitcnt lgkmcnt(4)
  v_mfma_f32_16x16x32_bf16 v[64:67], a[8:11], v[144:147], v[64:67]
  ds_read_b128 v[136:139], v5 offset:5120
  ds_read_b128 v[140:143], v5 offset:19456
  v_mfma_f32_16x16x32_bf16 v[68:71], a[8:11], v[148:151], v[68:71]
  v_mfma_f32_16x16x32_bf16 v[72:75], a[64:67], v[144:147], v[72:75]
  v_cvt_pk_bf16_f32 v170, v164, v165
  v_cvt_pk_bf16_f32 v171, v166, v167
  v_mfma_f32_16x16x32_bf16 v[76:79], a[64:67], v[148:151], v[76:79]
  v_mfma_f32_16x16x32_bf16 v[80:83], a[120:123], v[144:147], v[80:83]
  s_mov_b64 exec, s[48:49]
  global_store_dwordx4 v8, v[168:171], s[8:9] sc0 sc1
  s_nop 1
  v_add_u32 v8, s41, v8
  s_mov_b64 exec, -1
  v_mfma_f32_16x16x32_bf16 v[84:87], a[120:123], v[148:151], v[84:87]
  v_mfma_f32_16x16x32_bf16 v[88:91], a[176:179], v[144:147], v[88:91]
  v_pk_mul_f32 v[176:177], v[100:101], s[42:43]
  v_pk_mul_f32 v[178:179], v[102:103], s[42:43]
  v_mfma_f32_16x16x32_bf16 v[92:95], a[176:179], v[148:151], v[92:95]
  s_waitcnt lgkmcnt(4)
  v_mfma_f32_16x16x32_bf16 v[64:67], a[12:15], v[152:155], v[64:67]
  ds_read_b128 v[144:147], v5 offset:6144
  ds_read_b128 v[148:151], v5 offset:20480
  v_mfma_f32_16x16x32_bf16 v[68:71], a[12:15], v[156:159], v[68:71]
  v_mfma_f32_16x16x32_bf16 v[72:75], a[68:71], v[152:155], v[72:75]
  v_pk_mul_f32 v[180:181], v[108:109], s[42:43]
  v_pk_mul_f32 v[182:183], v[110:111], s[42:43]
  v_mfma_f32_16x16x32_bf16 v[76:79], a[68:71], v[156:159], v[76:79]
  v_mfma_f32_16x16x32_bf16 v[80:83], a[124:127], v[152:155], v[80:83]
  v_cvt_pk_bf16_f32 v184, v176, v177
  v_cvt_pk_bf16_f32 v185, v178, v179
  v_mfma_f32_16x16x32_bf16 v[84:87], a[124:127], v[156:159], v[84:87]
  v_mfma_f32_16x16x32_bf16 v[88:91], a[180:183], v[152:155], v[88:91]
  v_cvt_pk_bf16_f32 v186, v180, v181
  v_cvt_pk_bf16_f32 v187, v182, v183
  v_mfma_f32_16x16x32_bf16 v[92:95], a[180:183], v[156:159], v[92:95]
  s_waitcnt lgkmcnt(4)
  v_mfma_f32_16x16x32_bf16 v[64:67], a[16:19], v[128:131], v[64:67]
  ds_read_b128 v[152:155], v5 offset:7168
  ds_read_b128 v[156:159], v5 offset:21504
  v_mfma_f32_16x16x32_bf16 v[68:71], a[16:19], v[132:135], v[68:71]
  v_mfma_f32_16x16x32_bf16 v[72:75], a[72:75], v[128:131], v[72:75]
  s_mov_b64 exec, s[48:49]
  global_store_dwordx4 v9, v[184:187], s[8:9] sc0 sc1
  s_nop 1
  v_add_u32 v9, s41, v9
  s_mov_b64 exec, -1
  v_mfma_f32_16x16x32_bf16 v[76:79], a[72:75], v[132:135], v[76:79]
  v_mfma_f32_16x16x32_bf16 v[80:83], a[128:131], v[128:131], v[80:83]
  v_pk_mul_f32 v[160:161], v[112:113], s[42:43]
  v_pk_mul_f32 v[162:163], v[114:115], s[42:43]
  v_mfma_f32_16x16x32_bf16 v[84:87], a[128:131], v[132:135], v[84:87]
  v_mfma_f32_16x16x32_bf16 v[88:91], a[184:187], v[128:131], v[88:91]
  v_pk_mul_f32 v[164:165], v[120:121], s[42:43]
  v_pk_mul_f32 v[166:167], v[122:123], s[42:43]
  v_mfma_f32_16x16x32_bf16 v[92:95], a[184:187], v[132:135], v[92:95]
  s_waitcnt lgkmcnt(4)
  v_mfma_f32_16x16x32_bf16 v[64:67], a[20:23], v[136:139], v[64:67]
  ds_read_b128 v[128:131], v5 offset:8192
  ds_read_b128 v[132:135], v5 offset:22528
  v_mfma_f32_16x16x32_bf16 v[68:71], a[20:23], v[140:143], v[68:71]
  v_mfma_f32_16x16x32_bf16 v[72:75], a[76:79], v[136:139], v[72:75]
  v_cvt_pk_bf16_f32 v168, v160, v161
  v_cvt_pk_bf16_f32 v169, v162, v163
  v_mfma_f32_16x16x32_bf16 v[76:79], a[76:79], v[140:143], v[76:79]
  v_mfma_f32_16x16x32_bf16 v[80:83], a[132:135], v[136:139], v[80:83]
  v_cvt_pk_bf16_f32 v170, v164, v165
  v_cvt_pk_bf16_f32 v171, v166, v167
  v_mfma_f32_16x16x32_bf16 v[84:87], a[132:135], v[140:143], v[84:87]
  v_mfma_f32_16x16x32_bf16 v[88:91], a[188:191], v[136:139], v[88:91]
  s_mov_b64 exec, s[48:49]
  global_store_dwordx4 v10, v[168:171], s[8:9] sc0 sc1
  s_nop 1
  v_add_u32 v10, s41, v10
  s_mov_b64 exec, -1
  v_mfma_f32_16x16x32_bf16 v[92:95], a[188:191], v[140:143], v[92:95]
  s_waitcnt lgkmcnt(4)
  v_mfma_f32_16x16x32_bf16 v[64:67], a[24:27], v[144:147], v[64:67]
  ds_read_b128 v[136:139], v5 offset:9216
  ds_read_b128 v[140:143], v5 offset:23552
  v_mfma_f32_16x16x32_bf16 v[68:71], a[24:27], v[148:151], v[68:71]
  v_mfma_f32_16x16x32_bf16 v[72:75], a[80:83], v[144:147], v[72:75]
  v_pk_mul_f32 v[176:177], v[116:117], s[42:43]
  v_pk_mul_f32 v[178:179], v[118:119], s[42:43]
  v_mfma_f32_16x16x32_bf16 v[76:79], a[80:83], v[148:151], v[76:79]
  v_mfma_f32_16x16x32_bf16 v[80:83], a[136:139], v[144:147], v[80:83]
  v_pk_mul_f32 v[180:181], v[124:125], s[42:43]
  v_pk_mul_f32 v[182:183], v[126:127], s[42:43]
  v_mfma_f32_16x16x32_bf16 v[84:87], a[136:139], v[148:151], v[84:87]
  v_mfma_f32_16x16x32_bf16 v[88:91], a[192:195], v[144:147], v[88:91]
  v_cvt_pk_bf16_f32 v184, v176, v177
  v_cvt_pk_bf16_f32 v185, v178, v179
  v_mfma_f32_16x16x32_bf16 v[92:95], a[192:195], v[148:151], v[92:95]
  s_waitcnt lgkmcnt(4)
  v_mfma_f32_16x16x32_bf16 v[64:67], a[28:31], v[152:155], v[64:67]
  ds_read_b128 v[144:147], v5 offset:10240
  ds_read_b128 v[148:151], v5 offset:24576
  v_mfma_f32_16x16x32_bf16 v[68:71], a[28:31], v[156:159], v[68:71]
  v_mfma_f32_16x16x32_bf16 v[72:75], a[84:87], v[152:155], v[72:75]
  v_cvt_pk_bf16_f32 v186, v180, v181
  v_cvt_pk_bf16_f32 v187, v182, v183
  v_mfma_f32_16x16x32_bf16 v[76:79], a[84:87], v[156:159], v[76:79]
  v_mfma_f32_16x16x32_bf16 v[80:83], a[140:143], v[152:155], v[80:83]
  s_mov_b64 exec, s[48:49]
  global_store_dwordx4 v11, v[184:187], s[8:9] sc0 sc1
  s_nop 1
  v_add_u32 v11, s41, v11
  s_mov_b64 exec, -1
  v_mfma_f32_16x16x32_bf16 v[84:87], a[140:143], v[156:159], v[84:87]
  v_mfma_f32_16x16x32_bf16 v[88:91], a[196:199], v[152:155], v[88:91]
  v_mfma_f32_16x16x32_bf16 v[92:95], a[196:199], v[156:159], v[92:95]
  s_waitcnt lgkmcnt(4)
  v_mfma_f32_16x16x32_bf16 v[64:67], a[32:35], v[128:131], v[64:67]
  ds_read_b128 v[152:155], v5 offset:11264
  ds_read_b128 v[156:159], v5 offset:25600
  v_mfma_f32_16x16x32_bf16 v[68:71], a[32:35], v[132:135], v[68:71]
  v_mfma_f32_16x16x32_bf16 v[72:75], a[88:91], v[128:131], v[72:75]
  v_mfma_f32_16x16x32_bf16 v[76:79], a[88:91], v[132:135], v[76:79]
  v_mfma_f32_16x16x32_bf16 v[80:83], a[144:147], v[128:131], v[80:83]
  v_mfma_f32_16x16x32_bf16 v[84:87], a[144:147], v[132:135], v[84:87]
  v_mfma_f32_16x16x32_bf16 v[88:91], a[200:203], v[128:131], v[88:91]
  v_mfma_f32_16x16x32_bf16 v[92:95], a[200:203], v[132:135], v[92:95]
  s_waitcnt vmcnt(4)
  s_barrier
  s_add_u32 s12, s47, 1
  s_cmp_ge_u32 s12, s46
  s_nop 3
  s_cbranch_scc1 GSD_94
  s_mov_b32 m0, s44
  s_nop 0
  global_load_lds_dwordx4 v4, s[8:9] offset:0
  global_load_lds_dwordx4 v4, s[8:9] offset:1024
  global_load_lds_dwordx4 v4, s[8:9] offset:2048
  global_load_lds_dwordx4 v4, s[8:9] offset:3072
  s_add_u32 m0, s44, 4096
  s_nop 0
  v_add_u32 v4, 4096, v4
  global_load_lds_dwordx4 v4, s[8:9] offset:0
  global_load_lds_dwordx4 v4, s[8:9] offset:1024
  global_load_lds_dwordx4 v4, s[8:9] offset:2048
  s_nop 1
  v_add_u32 v4, 24576, v4
  s_add_u32 s44, s44, 28672
  s_cmp_ge_u32 s44, 86016
  s_cselect_b32 s45, 86016, 0
  s_sub_u32 s44, s44, s45
  s_nop 1
GSD_94:
  s_waitcnt lgkmcnt(4)
  v_mfma_f32_16x16x32_bf16 v[64:67], a[36:39], v[136:139], v[64:67]
  ds_read_b128 v[128:131], v5 offset:12288
  ds_read_b128 v[132:135], v5 offset:26624
  v_mfma_f32_16x16x32_bf16 v[68:71], a[36:39], v[140:143], v[68:71]
  v_mfma_f32_16x16x32_bf16 v[72:75], a[92:95], v[136:139], v[72:75]
  v_mfma_f32_16x16x32_bf16 v[76:79], a[92:95], v[140:143], v[76:79]
  v_mfma_f32_16x16x32_bf16 v[80:83], a[148:151], v[136:139], v[80:83]
  v_mfma_f32_16x16x32_bf16 v[84:87], a[148:151], v[140:143], v[84:87]
  v_mfma_f32_16x16x32_bf16 v[88:91], a[204:207], v[136:139], v[88:91]
  v_mfma_f32_16x16x32_bf16 v[92:95], a[204:207], v[140:143], v[92:95]
  s_waitcnt lgkmcnt(4)
  v_mfma_f32_16x16x32_bf16 v[64:67], a[40:43], v[144:147], v[64:67]
  ds_read_b128 v[136:139], v5 offset:13312
  ds_read_b128 v[140:143], v5 offset:27648
  v_mfma_f32_16x16x32_bf16 v[68:71], a[40:43], v[148:151], v[68:71]
  v_mfma_f32_16x16x32_bf16 v[72:75], a[96:99], v[144:147], v[72:75]
  v_mfma_f32_16x16x32_bf16 v[76:79], a[96:99], v[148:151], v[76:79]
  v_mfma_f32_16x16x32_bf16 v[80:83], a[152:155], v[144:147], v[80:83]
  v_mfma_f32_16x16x32_bf16 v[84:87], a[152:155], v[148:151], v[84:87]
  v_mfma_f32_16x16x32_bf16 v[88:91], a[208:211], v[144:147], v[88:91]
  v_mfma_f32_16x16x32_bf16 v[92:95], a[208:211], v[148:151], v[92:95]
  s_waitcnt lgkmcnt(4)
  v_mfma_f32_16x16x32_bf16 v[64:67], a[44:47], v[152:155], v[64:67]
  ds_read_b128 v[144:147], v6 offset:0
  ds_read_b128 v[148:151], v6 offset:14336
  v_mfma_f32_16x16x32_bf16 v[68:71], a[44:47], v[156:159], v[68:71]
  v_mfma_f32_16x16x32_bf16 v[72:75], a[100:103], v[152:155], v[72:75]
  v_mfma_f32_16x16x32_bf16 v[76:79], a[100:103], v[156:159], v[76:79]
  v_mfma_f32_16x16x32_bf16 v[80:83], a[156:159], v[152:155], v[80:83]
  v_mfma_f32_16x16x32_bf16 v[84:87], a[156:159], v[156:159], v[84:87]
  v_mfma_f32_16x16x32_bf16 v[88:91], a[212:215], v[152:155], v[88:91]
  v_mfma_f32_16x16x32_bf16 v[92:95], a[212:215], v[156:159], v[92:95]
  s_waitcnt lgkmcnt(4)
  v_mfma_f32_16x16x32_bf16 v[64:67], a[48:51], v[128:131], v[64:67]
  ds_read_b128 v[152:155], v6 offset:1024
  ds_read_b128 v[156:159], v6 offset:15360
  v_mfma_f32_16x16x32_bf16 v[68:71], a[48:51], v[132:135], v[68:71]
  v_mfma_f32_16x16x32_bf16 v[72:75], a[104:107], v[128:131], v[72:75]
  v_mfma_f32_16x16x32_bf16 v[76:79], a[104:107], v[132:135], v[76:79]
  v_mfma_f32_16x16x32_bf16 v[80:83], a[160:163], v[128:131], v[80:83]
  v_mfma_f32_16x16x32_bf16 v[84:87], a[160:163], v[132:135], v[84:87]
  v_mfma_f32_16x16x32_bf16 v[88:91], a[216:219], v[128:131], v[88:91]
  v_mfma_f32_16x16x32_bf16 v[92:95], a[216:219], v[132:135], v[92:95]
  s_waitcnt lgkmcnt(4)
  v_mfma_f32_16x16x32_bf16 v[64:67], a[52:55], v[136:139], v[64:67]
  ds_read_b128 v[128:131], v6 offset:2048
  ds_read_b128 v[132:135], v6 offset:16384
  v_mfma_f32_16x16x32_bf16 v[68:71], a[52:55], v[140:143], v[68:71]
  v_mfma_f32_16x16x32_bf16 v[72:75], a[108:111], v[136:139], v[72:75]
  v_mfma_f32_16x16x32_bf16 v[76:79], a[108:111], v[140:143], v[76:79]
  v_mfma_f32_16x16x32_bf16 v[80:83], a[164:167], v[136:139], v[80:83]
  v_mfma_f32_16x16x32_bf16 v[84:87], a[164:167], v[140:143], v[84:87]
  v_mfma_f32_16x16x32_bf16 v[88:91], a[220:223], v[136:139], v[88:91]
  v_mfma_f32_16x16x32_bf16 v[92:95], a[220:223], v[140:143], v[92:95]
  v_mov_b32 v5, v6
  v_add_u32 v6, 28672, v6
  v_subrev_u32 v12, 86016, v6
  v_min_u32 v6, v12, v6
  s_mov_b64 s[48:49], -1
  s_waitcnt lgkmcnt(4)
  v_mfma_f32_16x16x32_bf16 v[96:99], a[0:3], v[144:147], 0
  ds_read_b128 v[136:139], v5 offset:3072
  ds_read_b128 v[140:143], v5 offset:17408
  v_mfma_f32_16x16x32_bf16 v[100:103], a[0:3], v[148:151], 0
  v_mfma_f32_16x16x32_bf16 v[104:107], a[56:59], v[144:147], 0
  v_mfma_f32_16x16x32_bf16 v[108:111], a[56:59], v[148:151], 0
  v_mfma_f32_16x16x32_bf16 v[112:115], a[112:115], v[144:147], 0
  v_mfma_f32_16x16x32_bf16 v[116:119], a[112:115], v[148:151], 0
  v_mfma_f32_16x16x32_bf16 v[120:123], a[168:171], v[144:147], 0
  v_mfma_f32_16x16x32_bf16 v[124:127], a[168:171], v[148:151], 0
  s_waitcnt lgkmcnt(4)
  v_mfma_f32_16x16x32_bf16 v[96:99], a[4:7], v[152:155], v[96:99]
  ds_read_b128 v[144:147], v5 offset:4096
  ds_read_b128 v[148:151], v5 offset:18432
  v_mfma_f32_16x16x32_bf16 v[100:103], a[4:7], v[156:159], v[100:103]
  v_mfma_f32_16x16x32_bf16 v[104:107], a[60:63], v[152:155], v[104:107]
  v_pk_mul_f32 v[160:161], v[64:65], s[42:43]
  v_pk_mul_f32 v[162:163], v[66:67], s[42:43]
  v_mfma_f32_16x16x32_bf16 v[108:111], a[60:63], v[156:159], v[108:111]
  v_mfma_f32_16x16x32_bf16 v[112:115], a[116:119], v[152:155], v[112:115]
  v_pk_mul_f32 v[164:165], v[72:73], s[42:43]
  v_pk_mul_f32 v[166:167], v[74:75], s[42:43]
  v_mfma_f32_16x16x32_bf16 v[116:119], a[116:119], v[156:159], v[116:119]
  v_mfma_f32_16x16x32_bf16 v[120:123], a[172:175], v[152:155], v[120:123]
  v_cvt_pk_bf16_f32 v168, v160, v161
  v_cvt_pk_bf16_f32 v169, v162, v163
  v_mfma_f32_16x16x32_bf16 v[124:127], a[172:175], v[156:159], v[124:127]
  s_waitcnt lgkmcnt(4)
  v_mfma_f32_16x16x32_bf16 v[96:99], a[8:11], v[128:131], v[96:99]
  ds_read_b128 v[152:155], v5 offset:5120
  ds_read_b128 v[156:159], v5 offset:19456
  v_mfma_f32_16x16x32_bf16 v[100:103], a[8:11], v[132:135], v[100:103]
  v_mfma_f32_16x16x32_bf16 v[104:107], a[64:67], v[128:131], v[104:107]
  v_cvt_pk_bf16_f32 v170, v164, v165
  v_cvt_pk_bf16_f32 v171, v166, v167
  v_mfma_f32_16x16x32_bf16 v[108:111], a[64:67], v[132:135], v[108:111]
  v_mfma_f32_16x16x32_bf16 v[112:115], a[120:123], v[128:131], v[112:115]
  global_store_dwordx4 v8, v[168:171], s[8:9] sc0 sc1
  s_nop 1
  v_add_u32 v8, s41, v8
  v_mfma_f32_16x16x32_bf16 v[116:119], a[120:123], v[132:135], v[116:119]
  v_mfma_f32_16x16x32_bf16 v[120:123], a[176:179], v[128:131], v[120:123]
  v_pk_mul_f32 v[176:177], v[68:69], s[42:43]
  v_pk_mul_f32 v[178:179], v[70:71], s[42:43]
  v_mfma_f32_16x16x32_bf16 v[124:127], a[176:179], v[132:135], v[124:127]
  s_waitcnt lgkmcnt(4)
  v_mfma_f32_16x16x32_bf16 v[96:99], a[12:15], v[136:139], v[96:99]
  ds_read_b128 v[128:131], v5 offset:6144
  ds_read_b128 v[132:135], v5 offset:20480
  v_mfma_f32_16x16x32_bf16 v[100:103], a[12:15], v[140:143], v[100:103]
  v_mfma_f32_16x16x32_bf16 v[104:107], a[68:71], v[136:139], v[104:107]
  v_pk_mul_f32 v[180:181], v[76:77], s[42:43]
  v_pk_mul_f32 v[182:183], v[78:79], s[42:43]
  v_mfma_f32_16x16x32_bf16 v[108:111], a[68:71], v[140:143], v[108:111]
  v_mfma_f32_16x16x32_bf16 v[112:115], a[124:127], v[136:139], v[112:115]
  v_cvt_pk_bf16_f32 v184, v176, v177
  v_cvt_pk_bf16_f32 v185, v178, v179
  v_mfma_f32_16x16x32_bf16 v[116:119], a[124:127], v[140:143], v[116:119]
  v_mfma_f32_16x16x32_bf16 v[120:123], a[180:183], v[136:139], v[120:123]
  v_cvt_pk_bf16_f32 v186, v180, v181
  v_cvt_pk_bf16_f32 v187, v182, v183
  v_mfma_f32_16x16x32_bf16 v[124:127], a[180:183], v[140:143], v[124:127]
  s_waitcnt lgkmcnt(4)
  v_mfma_f32_16x16x32_bf16 v[96:99], a[16:19], v[144:147], v[96:99]
  ds_read_b128 v[136:139], v5 offset:7168
  ds_read_b128 v[140:143], v5 offset:21504
  v_mfma_f32_16x16x32_bf16 v[100:103], a[16:19], v[148:151], v[100:103]
  v_mfma_f32_16x16x32_bf16 v[104:107], a[72:75], v[144:147], v[104:107]
  global_store_dwordx4 v9, v[184:187], s[8:9] sc0 sc1
  s_nop 1
  v_add_u32 v9, s41, v9
  v_mfma_f32_16x16x32_bf16 v[108:111], a[72:75], v[148:151], v[108:111]
  v_mfma_f32_16x16x32_bf16 v[112:115], a[128:131], v[144:147], v[112:115]
  v_pk_mul_f32 v[160:161], v[80:81], s[42:43]
  v_pk_mul_f32 v[162:163], v[82:83], s[42:43]
  v_mfma_f32_16x16x32_bf16 v[116:119], a[128:131], v[148:151], v[116:119]
  v_mfma_f32_16x16x32_bf16 v[120:123], a[184:187], v[144:147], v[120:123]
  v_pk_mul_f32 v[164:165], v[88:89], s[42:43]
  v_pk_mul_f32 v[166:167], v[90:91], s[42:43]
  v_mfma_f32_16x16x32_bf16 v[124:127], a[184:187], v[148:151], v[124:127]
  s_waitcnt lgkmcnt(4)
  v_mfma_f32_16x16x32_bf16 v[96:99], a[20:23], v[152:155], v[96:99]
  ds_read_b128 v[144:147], v5 offset:8192
  ds_read_b128 v[148:151], v5 offset:22528
  v_mfma_f32_16x16x32_bf16 v[100:103], a[20:23], v[156:159], v[100:103]
  v_mfma_f32_16x16x32_bf16 v[104:107], a[76:79], v[152:155], v[104:107]
  v_cvt_pk_bf16_f32 v168, v160, v161
  v_cvt_pk_bf16_f32 v169, v162, v163
  v_mfma_f32_16x16x32_bf16 v[108:111], a[76:79], v[156:159], v[108:111]
  v_mfma_f32_16x16x32_bf16 v[112:115], a[132:135], v[152:155], v[112:115]
  v_cvt_pk_bf16_f32 v170, v164, v165
  v_cvt_pk_bf16_f32 v171, v166, v167
  v_mfma_f32_16x16x32_bf16 v[116:119], a[132:135], v[156:159], v[116:119]
  v_mfma_f32_16x16x32_bf16 v[120:123], a[188:191], v[152:155], v[120:123]
  global_store_dwordx4 v10, v[168:171], s[8:9] sc0 sc1
  s_nop 1
  v_add_u32 v10, s41, v10
  v_mfma_f32_16x16x32_bf16 v[124:127], a[188:191], v[156:159], v[124:127]
  s_waitcnt lgkmcnt(4)
  v_mfma_f32_16x16x32_bf16 v[96:99], a[24:27], v[128:131], v[96:99]
  ds_read_b128 v[152:155], v5 offset:9216
  ds_read_b128 v[156:159], v5 offset:23552
  v_mfma_f32_16x16x32_bf16 v[100:103], a[24:27], v[132:135], v[100:103]
  v_mfma_f32_16x16x32_bf16 v[104:107], a[80:83], v[128:131], v[104:107]
  v_pk_mul_f32 v[176:177], v[84:85], s[42:43]
  v_pk_mul_f32 v[178:179], v[86:87], s[42:43]
  v_mfma_f32_16x16x32_bf16 v[108:111], a[80:83], v[132:135], v[108:111]
  v_mfma_f32_16x16x32_bf16 v[112:115], a[136:139], v[128:131], v[112:115]
  v_pk_mul_f32 v[180:181], v[92:93], s[42:43]
  v_pk_mul_f32 v[182:183], v[94:95], s[42:43]
  v_mfma_f32_16x16x32_bf16 v[116:119], a[136:139], v[132:135], v[116:119]
  v_mfma_f32_16x16x32_bf16 v[120:123], a[192:195], v[128:131], v[120:123]
  v_cvt_pk_bf16_f32 v184, v176, v177
  v_cvt_pk_bf16_f32 v185, v178, v179
  v_mfma_f32_16x16x32_bf16 v[124:127], a[192:195], v[132:135], v[124:127]
  s_waitcnt lgkmcnt(4)
  v_mfma_f32_16x16x32_bf16 v[96:99], a[28:31], v[136:139], v[96:99]
  ds_read_b128 v[128:131], v5 offset:10240
  ds_read_b128 v[132:135], v5 offset:24576
  v_mfma_f32_16x16x32_bf16 v[100:103], a[28:31], v[140:143], v[100:103]
  v_mfma_f32_16x16x32_bf16 v[104:107], a[84:87], v[136:139], v[104:107]
  v_cvt_pk_bf16_f32 v186, v180, v181
  v_cvt_pk_bf16_f32 v187, v182, v183
  v_mfma_f32_16x16x32_bf16 v[108:111], a[84:87], v[140:143], v[108:111]
  v_mfma_f32_16x16x32_bf16 v[112:115], a[140:143], v[136:139], v[112:115]
  global_store_dwordx4 v11, v[184:187], s[8:9] sc0 sc1
  s_nop 1
  v_add_u32 v11, s41, v11
  v_mfma_f32_16x16x32_bf16 v[116:119], a[140:143], v[140:143], v[116:119]
  v_mfma_f32_16x16x32_bf16 v[120:123], a[196:199], v[136:139], v[120:123]
  v_mfma_f32_16x16x32_bf16 v[124:127], a[196:199], v[140:143], v[124:127]
  s_waitcnt lgkmcnt(4)
  v_mfma_f32_16x16x32_bf16 v[96:99], a[32:35], v[144:147], v[96:99]
  ds_read_b128 v[136:139], v5 offset:11264
  ds_read_b128 v[140:143], v5 offset:25600
  v_mfma_f32_16x16x32_bf16 v[100:103], a[32:35], v[148:151], v[100:103]
  v_mfma_f32_16x16x32_bf16 v[104:107], a[88:91], v[144:147], v[104:107]
  v_mfma_f32_16x16x32_bf16 v[108:111], a[88:91], v[148:151], v[108:111]
  v_mfma_f32_16x16x32_bf16 v[112:115], a[144:147], v[144:147], v[112:115]
  v_mfma_f32_16x16x32_bf16 v[116:119], a[144:147], v[148:151], v[116:119]
  v_mfma_f32_16x16x32_bf16 v[120:123], a[200:203], v[144:147], v[120:123]
  v_mfma_f32_16x16x32_bf16 v[124:127], a[200:203], v[148:151], v[124:127]
  s_waitcnt vmcnt(4)
  s_barrier
  s_add_u32 s12, s47, 1
  s_cmp_ge_u32 s12, s46
  s_nop 3
  s_cbranch_scc1 GSD_96
  s_mov_b32 m0, s44
  s_nop 0
  global_load_lds_dwordx4 v4, s[8:9] offset:0
  global_load_lds_dwordx4 v4, s[8:9] offset:1024
  global_load_lds_dwordx4 v4, s[8:9] offset:2048
  global_load_lds_dwordx4 v4, s[8:9] offset:3072
  s_add_u32 m0, s44, 4096
  s_nop 0
  v_add_u32 v4, 4096, v4
  global_load_lds_dwordx4 v4, s[8:9] offset:0
  global_load_lds_dwordx4 v4, s[8:9] offset:1024
  global_load_lds_dwordx4 v4, s[8:9] offset:2048
  s_nop 1
  v_add_u32 v4, 24576, v4
  s_add_u32 s44, s44, 28672
  s_cmp_ge_u32 s44, 86016
  s_cselect_b32 s45, 86016, 0
  s_sub_u32 s44, s44, s45
  s_nop 1
GSD_96:
  s_waitcnt lgkmcnt(4)
  v_mfma_f32_16x16x32_bf16 v[96:99], a[36:39], v[152:155], v[96:99]
  ds_read_b128 v[144:147], v5 offset:12288
  ds_read_b128 v[148:151], v5 offset:26624
  v_mfma_f32_16x16x32_bf16 v[100:103], a[36:39], v[156:159], v[100:103]
  v_mfma_f32_16x16x32_bf16 v[104:107], a[92:95], v[152:155], v[104:107]
  v_mfma_f32_16x16x32_bf16 v[108:111], a[92:95], v[156:159], v[108:111]
  v_mfma_f32_16x16x32_bf16 v[112:115], a[148:151], v[152:155], v[112:115]
  v_mfma_f32_16x16x32_bf16 v[116:119], a[148:151], v[156:159], v[116:119]
  v_mfma_f32_16x16x32_bf16 v[120:123], a[204:207], v[152:155], v[120:123]
  v_mfma_f32_16x16x32_bf16 v[124:127], a[204:207], v[156:159], v[124:127]
  s_waitcnt lgkmcnt(4)
  v_mfma_f32_16x16x32_bf16 v[96:99], a[40:43], v[128:131], v[96:99]
  ds_read_b128 v[152:155], v5 offset:13312
  ds_read_b128 v[156:159], v5 offset:27648
  v_mfma_f32_16x16x32_bf16 v[100:103], a[40:43], v[132:135], v[100:103]
  v_mfma_f32_16x16x32_bf16 v[104:107], a[96:99], v[128:131], v[104:107]
  v_mfma_f32_16x16x32_bf16 v[108:111], a[96:99], v[132:135], v[108:111]
  v_mfma_f32_16x16x32_bf16 v[112:115], a[152:155], v[128:131], v[112:115]
  v_mfma_f32_16x16x32_bf16 v[116:119], a[152:155], v[132:135], v[116:119]
  v_mfma_f32_16x16x32_bf16 v[120:123], a[208:211], v[128:131], v[120:123]
  v_mfma_f32_16x16x32_bf16 v[124:127], a[208:211], v[132:135], v[124:127]
  s_waitcnt lgkmcnt(4)
  v_mfma_f32_16x16x32_bf16 v[96:99], a[44:47], v[136:139], v[96:99]
  ds_read_b128 v[128:131], v6 offset:0
  ds_read_b128 v[132:135], v6 offset:14336
  v_mfma_f32_16x16x32_bf16 v[100:103], a[44:47], v[140:143], v[100:103]
  v_mfma_f32_16x16x32_bf16 v[104:107], a[100:103], v[136:139], v[104:107]
  v_mfma_f32_16x16x32_bf16 v[108:111], a[100:103], v[140:143], v[108:111]
  v_mfma_f32_16x16x32_bf16 v[112:115], a[156:159], v[136:139], v[112:115]
  v_mfma_f32_16x16x32_bf16 v[116:119], a[156:159], v[140:143], v[116:119]
  v_mfma_f32_16x16x32_bf16 v[120:123], a[212:215], v[136:139], v[120:123]
  v_mfma_f32_16x16x32_bf16 v[124:127], a[212:215], v[140:143], v[124:127]
  s_waitcnt lgkmcnt(4)
  v_mfma_f32_16x16x32_bf16 v[96:99], a[48:51], v[144:147], v[96:99]
  ds_read_b128 v[136:139], v6 offset:1024
  ds_read_b128 v[140:143], v6 offset:15360
  v_mfma_f32_16x16x32_bf16 v[100:103], a[48:51], v[148:151], v[100:103]
  v_mfma_f32_16x16x32_bf16 v[104:107], a[104:107], v[144:147], v[104:107]
  v_mfma_f32_16x16x32_bf16 v[108:111], a[104:107], v[148:151], v[108:111]
  v_mfma_f32_16x16x32_bf16 v[112:115], a[160:163], v[144:147], v[112:115]
  v_mfma_f32_16x16x32_bf16 v[116:119], a[160:163], v[148:151], v[116:119]
  v_mfma_f32_16x16x32_bf16 v[120:123], a[216:219], v[144:147], v[120:123]
  v_mfma_f32_16x16x32_bf16 v[124:127], a[216:219], v[148:151], v[124:127]
  s_waitcnt lgkmcnt(4)
  v_mfma_f32_16x16x32_bf16 v[96:99], a[52:55], v[152:155], v[96:99]
  ds_read_b128 v[144:147], v6 offset:2048
  ds_read_b128 v[148:151], v6 offset:16384
  v_mfma_f32_16x16x32_bf16 v[100:103], a[52:55], v[156:159], v[100:103]
  v_mfma_f32_16x16x32_bf16 v[104:107], a[108:111], v[152:155], v[104:107]
  v_mfma_f32_16x16x32_bf16 v[108:111], a[108:111], v[156:159], v[108:111]
  v_mfma_f32_16x16x32_bf16 v[112:115], a[164:167], v[152:155], v[112:115]
  v_mfma_f32_16x16x32_bf16 v[116:119], a[164:167], v[156:159], v[116:119]
  v_mfma_f32_16x16x32_bf16 v[120:123], a[220:223], v[152:155], v[120:123]
  v_mfma_f32_16x16x32_bf16 v[124:127], a[220:223], v[156:159], v[124:127]
  v_mov_b32 v5, v6
  v_add_u32 v6, 28672, v6
  v_subrev_u32 v12, 86016, v6
  v_min_u32 v6, v12, v6
  s_mov_b64 s[48:49], -1
  s_add_u32 s47, s47, 1
  s_cmp_lt_u32 s47, s46
  s_nop 1
  s_cbranch_scc1 GLU_92
  v_pk_mul_f32 v[160:161], v[96:97], s[42:43]
  v_pk_mul_f32 v[162:163], v[98:99], s[42:43]
  v_pk_mul_f32 v[164:165], v[104:105], s[42:43]
  v_pk_mul_f32 v[166:167], v[106:107], s[42:43]
  v_cvt_pk_bf16_f32 v168, v160, v161
  v_cvt_pk_bf16_f32 v169, v162, v163
  v_cvt_pk_bf16_f32 v170, v164, v165
  v_cvt_pk_bf16_f32 v171, v166, v167
  global_store_dwordx4 v8, v[168:171], s[8:9] sc0 sc1
  s_nop 1
  v_add_u32 v8, s41, v8
  v_pk_mul_f32 v[176:177], v[100:101], s[42:43]
  v_pk_mul_f32 v[178:179], v[102:103], s[42:43]
  v_pk_mul_f32 v[180:181], v[108:109], s[42:43]
  v_pk_mul_f32 v[182:183], v[110:111], s[42:43]
  v_cvt_pk_bf16_f32 v184, v176, v177
  v_cvt_pk_bf16_f32 v185, v178, v179
  v_cvt_pk_bf16_f32 v186, v180, v181
  v_cvt_pk_bf16_f32 v187, v182, v183
  global_store_dwordx4 v9, v[184:187], s[8:9] sc0 sc1
  s_nop 1
  v_add_u32 v9, s41, v9
  v_pk_mul_f32 v[160:161], v[112:113], s[42:43]
  v_pk_mul_f32 v[162:163], v[114:115], s[42:43]
  v_pk_mul_f32 v[164:165], v[120:121], s[42:43]
  v_pk_mul_f32 v[166:167], v[122:123], s[42:43]
  v_cvt_pk_bf16_f32 v168, v160, v161
  v_cvt_pk_bf16_f32 v169, v162, v163
  v_cvt_pk_bf16_f32 v170, v164, v165
  v_cvt_pk_bf16_f32 v171, v166, v167
  global_store_dwordx4 v10, v[168:171], s[8:9] sc0 sc1
  s_nop 1
  v_add_u32 v10, s41, v10
  v_pk_mul_f32 v[176:177], v[116:117], s[42:43]
  v_pk_mul_f32 v[178:179], v[118:119], s[42:43]
  v_pk_mul_f32 v[180:181], v[124:125], s[42:43]
  v_pk_mul_f32 v[182:183], v[126:127], s[42:43]
  v_cvt_pk_bf16_f32 v184, v176, v177
  v_cvt_pk_bf16_f32 v185, v178, v179
  v_cvt_pk_bf16_f32 v186, v180, v181
  v_cvt_pk_bf16_f32 v187, v182, v183
  global_store_dwordx4 v11, v[184:187], s[8:9] sc0 sc1
  s_nop 1
  v_add_u32 v11, s41, v11
  s_waitcnt vmcnt(0) lgkmcnt(0)
  s_lshl_b32 s12, s40, 2
  s_add_u32 s12, s12, s10
  s_lshl_b32 s12, s12, 8
  s_lshr_b32 s13, s39, 3
  s_lshl_b32 s13, s13, 2
  s_add_u32 s12, s12, s13
  s_add_u32 s12, s12, 103337984
  v_lshl_add_u32 v12, v2, 2, s12
  s_min_u32 s13, s46, 4
  v_mov_b32 v13, s13
  s_lshr_b32 s13, s46, 2
  s_max_u32 s13, s13, 1
  v_cmp_gt_u32 vcc, s13, v2
  s_mov_b64 exec, vcc
  global_atomic_add v12, v13, s[8:9] sc1
  s_mov_b64 exec, -1
  s_barrier
  s_nop 1
  s_branch WLOOP_71
WT3_76:
  s_sub_u32 s40, s40, 112
  s_cmp_ge_u32 s40, 128
  s_nop 1
  s_cbranch_scc1 WT4_77
  v_lshlrev_b32 v3, 4, v2
  v_and_b32 v4, 15, v2
  v_lshrrev_b32 v5, 4, v2
  s_lshr_b32 s12, s40, 1
  s_lshl_b32 s13, s10, 19
  s_add_u32 s14, s13, 77332480
  v_add_u32 v6, s14, v3
  s_lshl_b32 s14, s40, 10
  s_add_u32 s14, s14, s13
  s_add_u32 s14, s14, 75235328
  v_add_u32 v7, s14, v3
  s_add_u32 s14, s13, 79429632
  v_add_u32 v8, s14, v3
  s_add_i32 s14, s12, -8
  s_max_i32 s14, s14, 0
  s_lshl_b32 s60, s14, 10
  s_lshl_b32 s70, s14, 11
  s_add_i32 s14, s12, -7
  s_max_i32 s14, s14, 0
  s_lshl_b32 s61, s14, 10
  s_lshl_b32 s71, s14, 11
  s_add_i32 s14, s12, -6
  s_max_i32 s14, s14, 0
  s_lshl_b32 s62, s14, 10
  s_lshl_b32 s72, s14, 11
  s_add_i32 s14, s12, -5
  s_max_i32 s14, s14, 0
  s_lshl_b32 s63, s14, 10
  s_lshl_b32 s73, s14, 11
  s_add_i32 s14, s12, -4
  s_max_i32 s14, s14, 0
  s_lshl_b32 s64, s14, 10
  s_lshl_b32 s74, s14, 11
  s_add_i32 s14, s12, -3
  s_max_i32 s14, s14, 0
  s_lshl_b32 s65, s14, 10
  s_lshl_b32 s75, s14, 11
  s_add_i32 s14, s12, -2
  s_max_i32 s14, s14, 0
  s_lshl_b32 s66, s14, 10
  s_lshl_b32 s76, s14, 11
  s_add_i32 s14, s12, -1
  s_max_i32 s14, s14, 0
  s_lshl_b32 s67, s14, 10
  s_lshl_b32 s77, s14, 11
  s_add_i32 s14, s12, 0
  s_max_i32 s14, s14, 0
  s_lshl_b32 s68, s14, 10
  s_lshl_b32 s78, s14, 11
  s_lshr_b32 s14, s60, 11
  s_lshr_b32 s15, s12, 1
  v_lshrrev_b32 v9, 3, v2
  v_add_u32 v9, s14, v9
  v_min_u32 v9, s15, v9
  v_and_b32 v10, 7, v2
  v_min_u32 v10, 5, v10
  v_lshlrev_b32 v9, 8, v9
  v_lshl_add_u32 v9, v10, 2, v9
  v_add_u32 v9, 103338208, v9
  s_mov_b32 s14, 4096
  s_nop 1
AW_97:
  global_load_dword v10, v9, s[8:9] sc0 sc1
  s_waitcnt vmcnt(0)
  v_cmp_gt_u32 vcc, 4, v10
  s_nop 4
  s_cbranch_vccz AWD_98
  s_sleep 16
  s_sub_u32 s14, s14, 1
  s_nop 1
  s_cbranch_scc0 AW_97
AWD_98:
  v_add_u32 v9, s70, v6
  global_load_dwordx4 a[0:3], v9, s[8:9] offset:0
  global_load_dwordx4 a[4:7], v9, s[8:9] offset:1024
  v_add_u32 v9, s71, v6
  global_load_dwordx4 a[8:11], v9, s[8:9] offset:0
  global_load_dwordx4 a[12:15], v9, s[8:9] offset:1024
  v_add_u32 v9, s72, v6
  global_load_dwordx4 a[16:19], v9, s[8:9] offset:0
  global_load_dwordx4 a[20:23], v9, s[8:9] offset:1024
  v_add_u32 v9, s73, v6
  global_load_dwordx4 a[24:27], v9, s[8:9] offset:0
  global_load_dwordx4 a[28:31], v9, s[8:9] offset:1024
  v_add_u32 v9, s74, v6
  global_load_dwordx4 a[32:35], v9, s[8:9] offset:0
  global_load_dwordx4 a[36:39], v9, s[8:9] offset:1024
  v_add_u32 v9, s75, v6
  global_load_dwordx4 a[40:43], v9, s[8:9] offset:0
  global_load_dwordx4 a[44:47], v9, s[8:9] offset:1024
  v_add_u32 v9, s76, v6
  global_load_dwordx4 a[48:51], v9, s[8:9] offset:0
  global_load_dwordx4 a[52:55], v9, s[8:9] offset:1024
  v_add_u32 v9, s77, v6
  global_load_dwordx4 a[56:59], v9, s[8:9] offset:0
  global_load_dwordx4 a[60:63], v9, s[8:9] offset:1024
  v_add_u32 v9, s78, v6
  global_load_dwordx4 a[64:67], v9, s[8:9] offset:0
  global_load_dwordx4 a[68:71], v9, s[8:9] offset:1024
  global_load_dwordx4 v[204:207], v7, s[8:9]
  v_add_u32 v6, 131072, v6
  v_add_u32 v7, 131072, v7
  s_lshl_b32 s14, s40, 4
  v_add_u32 v10, s14, v4
  s_lshl_b32 s14, s12, 5
  s_sub_u32 s14, s14, 256
  v_lshlrev_b32 v11, 2, v5
  v_add_u32 v11, s14, v11
  v_sub_u32 v12, v10, v11
  v_min_u32 v13, 255, v10
  v_mov_b32 v14, 0xf149f2ca
  v_subrev_u32 v15, 0, v12
  v_cmp_le_u32 vcc, v15, v13
  s_nop 1
  v_cndmask_b32 v16, v14, 0, vcc
  v_subrev_u32 v15, 1, v12
  v_cmp_le_u32 vcc, v15, v13
  s_nop 1
  v_cndmask_b32 v17, v14, 0, vcc
  v_subrev_u32 v15, 2, v12
  v_cmp_le_u32 vcc, v15, v13
  s_nop 1
  v_cndmask_b32 v18, v14, 0, vcc
  v_subrev_u32 v15, 3, v12
  v_cmp_le_u32 vcc, v15, v13
  s_nop 1
  v_cndmask_b32 v19, v14, 0, vcc
  v_subrev_u32 v15, 16, v12
  v_cmp_le_u32 vcc, v15, v13
  s_nop 1
  v_cndmask_b32 v20, v14, 0, vcc
  v_subrev_u32 v15, 17, v12
  v_cmp_le_u32 vcc, v15, v13
  s_nop 1
  v_cndmask_b32 v21, v14, 0, vcc
  v_subrev_u32 v15, 18, v12
  v_cmp_le_u32 vcc, v15, v13
  s_nop 1
  v_cndmask_b32 v22, v14, 0, vcc
  v_subrev_u32 v15, 19, v12
  v_cmp_le_u32 vcc, v15, v13
  s_nop 1
  v_cndmask_b32 v23, v14, 0, vcc
  v_subrev_u32 v15, 32, v12
  v_cmp_le_u32 vcc, v15, v13
  s_nop 1
  v_cndmask_b32 v24, v14, 0, vcc
  v_subrev_u32 v15, 33, v12
  v_cmp_le_u32 vcc, v15, v13
  s_nop 1
  v_cndmask_b32 v25, v14, 0, vcc
  v_subrev_u32 v15, 34, v12
  v_cmp_le_u32 vcc, v15, v13
  s_nop 1
  v_cndmask_b32 v26, v14, 0, vcc
  v_subrev_u32 v15, 35, v12
  v_cmp_le_u32 vcc, v15, v13
  s_nop 1
  v_cndmask_b32 v27, v14, 0, vcc
  v_subrev_u32 v15, 48, v12
  v_cmp_le_u32 vcc, v15, v13
  s_nop 1
  v_cndmask_b32 v28, v14, 0, vcc
  v_subrev_u32 v15, 49, v12
  v_cmp_le_u32 vcc, v15, v13
  s_nop 1
  v_cndmask_b32 v29, v14, 0, vcc
  v_subrev_u32 v15, 50, v12
  v_cmp_le_u32 vcc, v15, v13
  s_nop 1
  v_cndmask_b32 v30, v14, 0, vcc
  v_subrev_u32 v15, 51, v12
  v_cmp_le_u32 vcc, v15, v13
  s_nop 1
  v_cndmask_b32 v31, v14, 0, vcc
  v_subrev_u32 v15, 64, v12
  v_cmp_le_u32 vcc, v15, v13
  s_nop 1
  v_cndmask_b32 v32, v14, 0, vcc
  v_subrev_u32 v15, 65, v12
  v_cmp_le_u32 vcc, v15, v13
  s_nop 1
  v_cndmask_b32 v33, v14, 0, vcc
  v_subrev_u32 v15, 66, v12
  v_cmp_le_u32 vcc, v15, v13
  s_nop 1
  v_cndmask_b32 v34, v14, 0, vcc
  v_subrev_u32 v15, 67, v12
  v_cmp_le_u32 vcc, v15, v13
  s_nop 1
  v_cndmask_b32 v35, v14, 0, vcc
  v_subrev_u32 v15, 80, v12
  v_cmp_le_u32 vcc, v15, v13
  s_nop 1
  v_cndmask_b32 v36, v14, 0, vcc
  v_subrev_u32 v15, 81, v12
  v_cmp_le_u32 vcc, v15, v13
  s_nop 1
  v_cndmask_b32 v37, v14, 0, vcc
  v_subrev_u32 v15, 82, v12
  v_cmp_le_u32 vcc, v15, v13
  s_nop 1
  v_cndmask_b32 v38, v14, 0, vcc
  v_subrev_u32 v15, 83, v12
  v_cmp_le_u32 vcc, v15, v13
  s_nop 1
  v_cndmask_b32 v39, v14, 0, vcc
  v_subrev_u32 v15, 96, v12
  v_cmp_le_u32 vcc, v15, v13
  s_nop 1
  v_cndmask_b32 v40, v14, 0, vcc
  v_subrev_u32 v15, 97, v12
  v_cmp_le_u32 vcc, v15, v13
  s_nop 1
  v_cndmask_b32 v41, v14, 0, vcc
  v_subrev_u32 v15, 98, v12
  v_cmp_le_u32 vcc, v15, v13
  s_nop 1
  v_cndmask_b32 v42, v14, 0, vcc
  v_subrev_u32 v15, 99, v12
  v_cmp_le_u32 vcc, v15, v13
  s_nop 1
  v_cndmask_b32 v43, v14, 0, vcc
  v_subrev_u32 v15, 112, v12
  v_cmp_le_u32 vcc, v15, v13
  s_nop 1
  v_cndmask_b32 v44, v14, 0, vcc
  v_subrev_u32 v15, 113, v12
  v_cmp_le_u32 vcc, v15, v13
  s_nop 1
  v_cndmask_b32 v45, v14, 0, vcc
  v_subrev_u32 v15, 114, v12
  v_cmp_le_u32 vcc, v15, v13
  s_nop 1
  v_cndmask_b32 v46, v14, 0, vcc
  v_subrev_u32 v15, 115, v12
  v_cmp_le_u32 vcc, v15, v13
  s_nop 1
  v_cndmask_b32 v47, v14, 0, vcc
  v_subrev_u32 v15, 128, v12
  v_cmp_le_u32 vcc, v15, v13
  s_nop 1
  v_cndmask_b32 v48, v14, 0, vcc
  v_subrev_u32 v15, 129, v12
  v_cmp_le_u32 vcc, v15, v13
  s_nop 1
  v_cndmask_b32 v49, v14, 0, vcc
  v_subrev_u32 v15, 130, v12
  v_cmp_le_u32 vcc, v15, v13
  s_nop 1
  v_cndmask_b32 v50, v14, 0, vcc
  v_subrev_u32 v15, 131, v12
  v_cmp_le_u32 vcc, v15, v13
  s_nop 1
  v_cndmask_b32 v51, v14, 0, vcc
  v_subrev_u32 v15, 144, v12
  v_cmp_le_u32 vcc, v15, v13
  s_nop 1
  v_cndmask_b32 v52, v14, 0, vcc
  v_subrev_u32 v15, 145, v12
  v_cmp_le_u32 vcc, v15, v13
  s_nop 1
  v_cndmask_b32 v53, v14, 0, vcc
  v_subrev_u32 v15, 146, v12
  v_cmp_le_u32 vcc, v15, v13
  s_nop 1
  v_cndmask_b32 v54, v14, 0, vcc
  v_subrev_u32 v15, 147, v12
  v_cmp_le_u32 vcc, v15, v13
  s_nop 1
  v_cndmask_b32 v55, v14, 0, vcc
  v_subrev_u32 v15, 160, v12
  v_cmp_le_u32 vcc, v15, v13
  s_nop 1
  v_cndmask_b32 v56, v14, 0, vcc
  v_subrev_u32 v15, 161, v12
  v_cmp_le_u32 vcc, v15, v13
  s_nop 1
  v_cndmask_b32 v57, v14, 0, vcc
  v_subrev_u32 v15, 162, v12
  v_cmp_le_u32 vcc, v15, v13
  s_nop 1
  v_cndmask_b32 v58, v14, 0, vcc
  v_subrev_u32 v15, 163, v12
  v_cmp_le_u32 vcc, v15, v13
  s_nop 1
  v_cndmask_b32 v59, v14, 0, vcc
  v_subrev_u32 v15, 176, v12
  v_cmp_le_u32 vcc, v15, v13
  s_nop 1
  v_cndmask_b32 v60, v14, 0, vcc
  v_subrev_u32 v15, 177, v12
  v_cmp_le_u32 vcc, v15, v13
  s_nop 1
  v_cndmask_b32 v61, v14, 0, vcc
  v_subrev_u32 v15, 178, v12
  v_cmp_le_u32 vcc, v15, v13
  s_nop 1
  v_cndmask_b32 v62, v14, 0, vcc
  v_subrev_u32 v15, 179, v12
  v_cmp_le_u32 vcc, v15, v13
  s_nop 1
  v_cndmask_b32 v63, v14, 0, vcc
  v_subrev_u32 v15, 192, v12
  v_cmp_le_u32 vcc, v15, v13
  s_nop 1
  v_cndmask_b32 v64, v14, 0, vcc
  v_subrev_u32 v15, 193, v12
  v_cmp_le_u32 vcc, v15, v13
  s_nop 1
  v_cndmask_b32 v65, v14, 0, vcc
  v_subrev_u32 v15, 194, v12
  v_cmp_le_u32 vcc, v15, v13
  s_nop 1
  v_cndmask_b32 v66, v14, 0, vcc
  v_subrev_u32 v15, 195, v12
  v_cmp_le_u32 vcc, v15, v13
  s_nop 1
  v_cndmask_b32 v67, v14, 0, vcc
  v_subrev_u32 v15, 208, v12
  v_cmp_le_u32 vcc, v15, v13
  s_nop 1
  v_cndmask_b32 v68, v14, 0, vcc
  v_subrev_u32 v15, 209, v12
  v_cmp_le_u32 vcc, v15, v13
  s_nop 1
  v_cndmask_b32 v69, v14, 0, vcc
  v_subrev_u32 v15, 210, v12
  v_cmp_le_u32 vcc, v15, v13
  s_nop 1
  v_cndmask_b32 v70, v14, 0, vcc
  v_subrev_u32 v15, 211, v12
  v_cmp_le_u32 vcc, v15, v13
  s_nop 1
  v_cndmask_b32 v71, v14, 0, vcc
  v_subrev_u32 v15, 224, v12
  v_cmp_le_u32 vcc, v15, v13
  s_nop 1
  v_cndmask_b32 v72, v14, 0, vcc
  v_subrev_u32 v15, 225, v12
  v_cmp_le_u32 vcc, v15, v13
  s_nop 1
  v_cndmask_b32 v73, v14, 0, vcc
  v_subrev_u32 v15, 226, v12
  v_cmp_le_u32 vcc, v15, v13
  s_nop 1
  v_cndmask_b32 v74, v14, 0, vcc
  v_subrev_u32 v15, 227, v12
  v_cmp_le_u32 vcc, v15, v13
  s_nop 1
  v_cndmask_b32 v75, v14, 0, vcc
  v_subrev_u32 v15, 240, v12
  v_cmp_le_u32 vcc, v15, v13
  s_nop 1
  v_cndmask_b32 v76, v14, 0, vcc
  v_subrev_u32 v15, 241, v12
  v_cmp_le_u32 vcc, v15, v13
  s_nop 1
  v_cndmask_b32 v77, v14, 0, vcc
  v_subrev_u32 v15, 242, v12
  v_cmp_le_u32 vcc, v15, v13
  s_nop 1
  v_cndmask_b32 v78, v14, 0, vcc
  v_subrev_u32 v15, 243, v12
  v_cmp_le_u32 vcc, v15, v13
  s_nop 1
  v_cndmask_b32 v79, v14, 0, vcc
  v_subrev_u32 v15, 256, v12
  v_cmp_le_u32 vcc, v15, v13
  s_nop 1
  v_cndmask_b32 v80, v14, 0, vcc
  v_subrev_u32 v15, 257, v12
  v_cmp_le_u32 vcc, v15, v13
  s_nop 1
  v_cndmask_b32 v81, v14, 0, vcc
  v_subrev_u32 v15, 258, v12
  v_cmp_le_u32 vcc, v15, v13
  s_nop 1
  v_cndmask_b32 v82, v14, 0, vcc
  v_subrev_u32 v15, 259, v12
  v_cmp_le_u32 vcc, v15, v13
  s_nop 1
  v_cndmask_b32 v83, v14, 0, vcc
  v_subrev_u32 v15, 272, v12
  v_cmp_le_u32 vcc, v15, v13
  s_nop 1
  v_cndmask_b32 v84, v14, 0, vcc
  v_subrev_u32 v15, 273, v12
  v_cmp_le_u32 vcc, v15, v13
  s_nop 1
  v_cndmask_b32 v85, v14, 0, vcc
  v_subrev_u32 v15, 274, v12
  v_cmp_le_u32 vcc, v15, v13
  s_nop 1
  v_cndmask_b32 v86, v14, 0, vcc
  v_subrev_u32 v15, 275, v12
  v_cmp_le_u32 vcc, v15, v13
  s_nop 1
  v_cndmask_b32 v87, v14, 0, vcc
  v_add_u32 v9, s60, v8
  global_load_dwordx4 a[144:147], v9, s[8:9]
  v_add_u32 v9, s61, v8
  global_load_dwordx4 a[152:155], v9, s[8:9]
  v_add_u32 v9, s62, v8
  global_load_dwordx4 a[160:163], v9, s[8:9]
  v_add_u32 v9, s63, v8
  global_load_dwordx4 a[168:171], v9, s[8:9]
  v_add_u32 v9, s64, v8
  global_load_dwordx4 a[176:179], v9, s[8:9]
  v_add_u32 v9, s65, v8
  global_load_dwordx4 a[184:187], v9, s[8:9]
  v_add_u32 v9, s66, v8
  global_load_dwordx4 a[192:195], v9, s[8:9]
  v_add_u32 v9, s67, v8
  global_load_dwordx4 a[200:203], v9, s[8:9]
  v_add_u32 v9, s68, v8
  global_load_dwordx4 a[208:211], v9, s[8:9]
  v_add_u32 v8, 65536, v8
  v_add_u32 v9, s60, v8
  global_load_dwordx4 a[148:151], v9, s[8:9]
  v_add_u32 v9, s61, v8
  global_load_dwordx4 a[156:159], v9, s[8:9]
  v_add_u32 v9, s62, v8
  global_load_dwordx4 a[164:167], v9, s[8:9]
  v_add_u32 v9, s63, v8
  global_load_dwordx4 a[172:175], v9, s[8:9]
  v_add_u32 v9, s64, v8
  global_load_dwordx4 a[180:183], v9, s[8:9]
  v_add_u32 v9, s65, v8
  global_load_dwordx4 a[188:191], v9, s[8:9]
  v_add_u32 v9, s66, v8
  global_load_dwordx4 a[196:199], v9, s[8:9]
  v_add_u32 v9, s67, v8
  global_load_dwordx4 a[204:207], v9, s[8:9]
  v_add_u32 v9, s68, v8
  global_load_dwordx4 a[212:215], v9, s[8:9]
  v_add_u32 v8, 65536, v8
  v_add_u32 v9, s70, v6
  global_load_dwordx4 a[72:75], v9, s[8:9] offset:0
  global_load_dwordx4 a[76:79], v9, s[8:9] offset:1024
  v_add_u32 v9, s71, v6
  global_load_dwordx4 a[80:83], v9, s[8:9] offset:0
  global_load_dwordx4 a[84:87], v9, s[8:9] offset:1024
  v_add_u32 v9, s72, v6
  global_load_dwordx4 a[88:91], v9, s[8:9] offset:0
  global_load_dwordx4 a[92:95], v9, s[8:9] offset:1024
  v_add_u32 v9, s73, v6
  global_load_dwordx4 a[96:99], v9, s[8:9] offset:0
  global_load_dwordx4 a[100:103], v9, s[8:9] offset:1024
  v_add_u32 v9, s74, v6
  global_load_dwordx4 a[104:107], v9, s[8:9] offset:0
  global_load_dwordx4 a[108:111], v9, s[8:9] offset:1024
  v_add_u32 v9, s75, v6
  global_load_dwordx4 a[112:115], v9, s[8:9] offset:0
  global_load_dwordx4 a[116:119], v9, s[8:9] offset:1024
  v_add_u32 v9, s76, v6
  global_load_dwordx4 a[120:123], v9, s[8:9] offset:0
  global_load_dwordx4 a[124:127], v9, s[8:9] offset:1024
  v_add_u32 v9, s77, v6
  global_load_dwordx4 a[128:131], v9, s[8:9] offset:0
  global_load_dwordx4 a[132:135], v9, s[8:9] offset:1024
  v_add_u32 v9, s78, v6
  global_load_dwordx4 a[136:139], v9, s[8:9] offset:0
  global_load_dwordx4 a[140:143], v9, s[8:9] offset:1024
  global_load_dwordx4 v[208:211], v7, s[8:9]
  v_add_u32 v6, 131072, v6
  v_add_u32 v7, 131072, v7
  s_waitcnt vmcnt(37)
  v_mfma_f32_16x16x32_bf16 v[88:91], a[0:3], v[204:207], v[16:19]
  v_mfma_f32_16x16x32_bf16 v[92:95], a[4:7], v[204:207], v[20:23]
  v_mfma_f32_16x16x32_bf16 v[96:99], a[8:11], v[204:207], v[24:27]
  v_mfma_f32_16x16x32_bf16 v[100:103], a[12:15], v[204:207], v[28:31]
  v_mfma_f32_16x16x32_bf16 v[104:107], a[16:19], v[204:207], v[32:35]
  v_mfma_f32_16x16x32_bf16 v[108:111], a[20:23], v[204:207], v[36:39]
  v_mfma_f32_16x16x32_bf16 v[112:115], a[24:27], v[204:207], v[40:43]
  v_mfma_f32_16x16x32_bf16 v[116:119], a[28:31], v[204:207], v[44:47]
  v_mfma_f32_16x16x32_bf16 v[120:123], a[32:35], v[204:207], v[48:51]
  v_mfma_f32_16x16x32_bf16 v[124:127], a[36:39], v[204:207], v[52:55]
  v_mfma_f32_16x16x32_bf16 v[128:131], a[40:43], v[204:207], v[56:59]
  v_mfma_f32_16x16x32_bf16 v[132:135], a[44:47], v[204:207], v[60:63]
  v_mfma_f32_16x16x32_bf16 v[136:139], a[48:51], v[204:207], v[64:67]
  v_mfma_f32_16x16x32_bf16 v[140:143], a[52:55], v[204:207], v[68:71]
  v_mfma_f32_16x16x32_bf16 v[144:147], a[56:59], v[204:207], v[72:75]
  v_mfma_f32_16x16x32_bf16 v[148:151], a[60:63], v[204:207], v[76:79]
  v_mfma_f32_16x16x32_bf16 v[152:155], a[64:67], v[204:207], v[80:83]
  v_mfma_f32_16x16x32_bf16 v[156:159], a[68:71], v[204:207], v[84:87]
  v_max3_f32 v212, v88, v89, v90
  v_max3_f32 v213, v91, v92, v93
  v_max3_f32 v212, v212, v94, v95
  v_max3_f32 v213, v213, v96, v97
  v_max3_f32 v212, v212, v98, v99
  v_max3_f32 v213, v213, v100, v101
  v_max3_f32 v212, v212, v102, v103
  v_max3_f32 v213, v213, v104, v105
  v_max3_f32 v212, v212, v106, v107
  v_max3_f32 v213, v213, v108, v109
  v_max3_f32 v212, v212, v110, v111
  v_max3_f32 v213, v213, v112, v113
  v_max3_f32 v212, v212, v114, v115
  v_max3_f32 v213, v213, v116, v117
  v_max3_f32 v212, v212, v118, v119
  v_max3_f32 v213, v213, v120, v121
  v_max3_f32 v212, v212, v122, v123
  v_max3_f32 v213, v213, v124, v125
  v_max3_f32 v212, v212, v126, v127
  v_max3_f32 v213, v213, v128, v129
  v_max3_f32 v212, v212, v130, v131
  v_max3_f32 v213, v213, v132, v133
  v_max3_f32 v212, v212, v134, v135
  v_max3_f32 v213, v213, v136, v137
  v_max3_f32 v212, v212, v138, v139
  v_max3_f32 v213, v213, v140, v141
  v_max3_f32 v212, v212, v142, v143
  v_max3_f32 v213, v213, v144, v145
  v_max3_f32 v212, v212, v146, v147
  v_max3_f32 v213, v213, v148, v149
  v_max3_f32 v212, v212, v150, v151
  v_max3_f32 v213, v213, v152, v153
  v_max3_f32 v212, v212, v154, v155
  v_max3_f32 v213, v213, v156, v157
  v_max3_f32 v212, v212, v158, v159
  v_max_f32 v212, v212, v213
  v_mov_b32 v213, v212
  s_nop 1
  v_permlane16_swap_b32 v212, v213
  v_max_f32 v212, v212, v213
  v_mov_b32 v213, v212
  s_nop 1
  v_permlane32_swap_b32 v212, v213
  v_max_f32 v212, v212, v213
  v_mov_b32 v213, v212
  v_pk_add_f32 v[88:89], v[88:89], v[212:213] neg_lo:[0,1] neg_hi:[0,1]
  v_pk_add_f32 v[90:91], v[90:91], v[212:213] neg_lo:[0,1] neg_hi:[0,1]
  v_pk_add_f32 v[92:93], v[92:93], v[212:213] neg_lo:[0,1] neg_hi:[0,1]
  v_pk_add_f32 v[94:95], v[94:95], v[212:213] neg_lo:[0,1] neg_hi:[0,1]
  v_pk_add_f32 v[96:97], v[96:97], v[212:213] neg_lo:[0,1] neg_hi:[0,1]
  v_pk_add_f32 v[98:99], v[98:99], v[212:213] neg_lo:[0,1] neg_hi:[0,1]
  v_pk_add_f32 v[100:101], v[100:101], v[212:213] neg_lo:[0,1] neg_hi:[0,1]
  v_pk_add_f32 v[102:103], v[102:103], v[212:213] neg_lo:[0,1] neg_hi:[0,1]
  v_pk_add_f32 v[104:105], v[104:105], v[212:213] neg_lo:[0,1] neg_hi:[0,1]
  v_pk_add_f32 v[106:107], v[106:107], v[212:213] neg_lo:[0,1] neg_hi:[0,1]
  v_pk_add_f32 v[108:109], v[108:109], v[212:213] neg_lo:[0,1] neg_hi:[0,1]
  v_pk_add_f32 v[110:111], v[110:111], v[212:213] neg_lo:[0,1] neg_hi:[0,1]
  v_pk_add_f32 v[112:113], v[112:113], v[212:213] neg_lo:[0,1] neg_hi:[0,1]
  v_pk_add_f32 v[114:115], v[114:115], v[212:213] neg_lo:[0,1] neg_hi:[0,1]
  v_pk_add_f32 v[116:117], v[116:117], v[212:213] neg_lo:[0,1] neg_hi:[0,1]
  v_pk_add_f32 v[118:119], v[118:119], v[212:213] neg_lo:[0,1] neg_hi:[0,1]
  v_pk_add_f32 v[120:121], v[120:121], v[212:213] neg_lo:[0,1] neg_hi:[0,1]
  v_pk_add_f32 v[122:123], v[122:123], v[212:213] neg_lo:[0,1] neg_hi:[0,1]
  v_pk_add_f32 v[124:125], v[124:125], v[212:213] neg_lo:[0,1] neg_hi:[0,1]
  v_pk_add_f32 v[126:127], v[126:127], v[212:213] neg_lo:[0,1] neg_hi:[0,1]
  v_pk_add_f32 v[128:129], v[128:129], v[212:213] neg_lo:[0,1] neg_hi:[0,1]
  v_pk_add_f32 v[130:131], v[130:131], v[212:213] neg_lo:[0,1] neg_hi:[0,1]
  v_pk_add_f32 v[132:133], v[132:133], v[212:213] neg_lo:[0,1] neg_hi:[0,1]
  v_pk_add_f32 v[134:135], v[134:135], v[212:213] neg_lo:[0,1] neg_hi:[0,1]
  v_pk_add_f32 v[136:137], v[136:137], v[212:213] neg_lo:[0,1] neg_hi:[0,1]
  v_pk_add_f32 v[138:139], v[138:139], v[212:213] neg_lo:[0,1] neg_hi:[0,1]
  v_pk_add_f32 v[140:141], v[140:141], v[212:213] neg_lo:[0,1] neg_hi:[0,1]
  v_pk_add_f32 v[142:143], v[142:143], v[212:213] neg_lo:[0,1] neg_hi:[0,1]
  v_pk_add_f32 v[144:145], v[144:145], v[212:213] neg_lo:[0,1] neg_hi:[0,1]
  v_pk_add_f32 v[146:147], v[146:147], v[212:213] neg_lo:[0,1] neg_hi:[0,1]
  v_pk_add_f32 v[148:149], v[148:149], v[212:213] neg_lo:[0,1] neg_hi:[0,1]
  v_pk_add_f32 v[150:151], v[150:151], v[212:213] neg_lo:[0,1] neg_hi:[0,1]
  v_pk_add_f32 v[152:153], v[152:153], v[212:213] neg_lo:[0,1] neg_hi:[0,1]
  v_pk_add_f32 v[154:155], v[154:155], v[212:213] neg_lo:[0,1] neg_hi:[0,1]
  v_pk_add_f32 v[156:157], v[156:157], v[212:213] neg_lo:[0,1] neg_hi:[0,1]
  v_pk_add_f32 v[158:159], v[158:159], v[212:213] neg_lo:[0,1] neg_hi:[0,1]
  v_exp_f32 v88, v88
  v_exp_f32 v89, v89
  v_exp_f32 v90, v90
  v_exp_f32 v91, v91
  v_exp_f32 v92, v92
  v_exp_f32 v93, v93
  v_exp_f32 v94, v94
  v_exp_f32 v95, v95
  v_exp_f32 v96, v96
  v_exp_f32 v97, v97
  v_exp_f32 v98, v98
  v_exp_f32 v99, v99
  v_exp_f32 v100, v100
  v_exp_f32 v101, v101
  v_exp_f32 v102, v102
  v_exp_f32 v103, v103
  v_exp_f32 v104, v104
  v_exp_f32 v105, v105
  v_exp_f32 v106, v106
  v_exp_f32 v107, v107
  v_exp_f32 v108, v108
  v_exp_f32 v109, v109
  v_exp_f32 v110, v110
  v_exp_f32 v111, v111
  v_exp_f32 v112, v112
  v_exp_f32 v113, v113
  v_exp_f32 v114, v114
  v_exp_f32 v115, v115
  v_exp_f32 v116, v116
  v_exp_f32 v117, v117
  v_exp_f32 v118, v118
  v_exp_f32 v119, v119
  v_exp_f32 v120, v120
  v_exp_f32 v121, v121
  v_exp_f32 v122, v122
  v_exp_f32 v123, v123
  v_exp_f32 v124, v124
  v_exp_f32 v125, v125
  v_exp_f32 v126, v126
  v_exp_f32 v127, v127
  v_exp_f32 v128, v128
  v_exp_f32 v129, v129
  v_exp_f32 v130, v130
  v_exp_f32 v131, v131
  v_exp_f32 v132, v132
  v_exp_f32 v133, v133
  v_exp_f32 v134, v134
  v_exp_f32 v135, v135
  v_exp_f32 v136, v136
  v_exp_f32 v137, v137
  v_exp_f32 v138, v138
  v_exp_f32 v139, v139
  v_exp_f32 v140, v140
  v_exp_f32 v141, v141
  v_exp_f32 v142, v142
  v_exp_f32 v143, v143
  v_exp_f32 v144, v144
  v_exp_f32 v145, v145
  v_exp_f32 v146, v146
  v_exp_f32 v147, v147
  v_exp_f32 v148, v148
  v_exp_f32 v149, v149
  v_exp_f32 v150, v150
  v_exp_f32 v151, v151
  v_exp_f32 v152, v152
  v_exp_f32 v153, v153
  v_exp_f32 v154, v154
  v_exp_f32 v155, v155
  v_exp_f32 v156, v156
  v_exp_f32 v157, v157
  v_exp_f32 v158, v158
  v_exp_f32 v159, v159
  v_pk_add_f32 v[214:215], v[88:89], v[90:91]
  v_pk_add_f32 v[216:217], v[92:93], v[94:95]
  v_pk_add_f32 v[214:215], v[214:215], v[96:97]
  v_pk_add_f32 v[216:217], v[216:217], v[98:99]
  v_pk_add_f32 v[214:215], v[214:215], v[100:101]
  v_pk_add_f32 v[216:217], v[216:217], v[102:103]
  v_pk_add_f32 v[214:215], v[214:215], v[104:105]
  v_pk_add_f32 v[216:217], v[216:217], v[106:107]
  v_pk_add_f32 v[214:215], v[214:215], v[108:109]
  v_pk_add_f32 v[216:217], v[216:217], v[110:111]
  v_pk_add_f32 v[214:215], v[214:215], v[112:113]
  v_pk_add_f32 v[216:217], v[216:217], v[114:115]
  v_pk_add_f32 v[214:215], v[214:215], v[116:117]
  v_pk_add_f32 v[216:217], v[216:217], v[118:119]
  v_pk_add_f32 v[214:215], v[214:215], v[120:121]
  v_pk_add_f32 v[216:217], v[216:217], v[122:123]
  v_pk_add_f32 v[214:215], v[214:215], v[124:125]
  v_pk_add_f32 v[216:217], v[216:217], v[126:127]
  v_pk_add_f32 v[214:215], v[214:215], v[128:129]
  v_pk_add_f32 v[216:217], v[216:217], v[130:131]
  v_pk_add_f32 v[214:215], v[214:215], v[132:133]
  v_pk_add_f32 v[216:217], v[216:217], v[134:135]
  v_pk_add_f32 v[214:215], v[214:215], v[136:137]
  v_pk_add_f32 v[216:217], v[216:217], v[138:139]
  v_pk_add_f32 v[214:215], v[214:215], v[140:141]
  v_pk_add_f32 v[216:217], v[216:217], v[142:143]
  v_pk_add_f32 v[214:215], v[214:215], v[144:145]
  v_pk_add_f32 v[216:217], v[216:217], v[146:147]
  v_pk_add_f32 v[214:215], v[214:215], v[148:149]
  v_pk_add_f32 v[216:217], v[216:217], v[150:151]
  v_pk_add_f32 v[214:215], v[214:215], v[152:153]
  v_pk_add_f32 v[216:217], v[216:217], v[154:155]
  v_pk_add_f32 v[214:215], v[214:215], v[156:157]
  v_pk_add_f32 v[216:217], v[216:217], v[158:159]
  v_cvt_pk_bf16_f32 v160, v88, v89
  v_cvt_pk_bf16_f32 v161, v90, v91
  v_cvt_pk_bf16_f32 v162, v92, v93
  v_cvt_pk_bf16_f32 v163, v94, v95
  v_cvt_pk_bf16_f32 v164, v96, v97
  v_cvt_pk_bf16_f32 v165, v98, v99
  v_cvt_pk_bf16_f32 v166, v100, v101
  v_cvt_pk_bf16_f32 v167, v102, v103
  v_cvt_pk_bf16_f32 v168, v104, v105
  v_cvt_pk_bf16_f32 v169, v106, v107
  v_cvt_pk_bf16_f32 v170, v108, v109
  v_cvt_pk_bf16_f32 v171, v110, v111
  v_cvt_pk_bf16_f32 v172, v112, v113
  v_cvt_pk_bf16_f32 v173, v114, v115
  v_cvt_pk_bf16_f32 v174, v116, v117
  v_cvt_pk_bf16_f32 v175, v118, v119
  v_cvt_pk_bf16_f32 v176, v120, v121
  v_cvt_pk_bf16_f32 v177, v122, v123
  v_cvt_pk_bf16_f32 v178, v124, v125
  v_cvt_pk_bf16_f32 v179, v126, v127
  v_cvt_pk_bf16_f32 v180, v128, v129
  v_cvt_pk_bf16_f32 v181, v130, v131
  v_cvt_pk_bf16_f32 v182, v132, v133
  v_cvt_pk_bf16_f32 v183, v134, v135
  v_cvt_pk_bf16_f32 v184, v136, v137
  v_cvt_pk_bf16_f32 v185, v138, v139
  v_cvt_pk_bf16_f32 v186, v140, v141
  v_cvt_pk_bf16_f32 v187, v142, v143
  v_cvt_pk_bf16_f32 v188, v144, v145
  v_cvt_pk_bf16_f32 v189, v146, v147
  v_cvt_pk_bf16_f32 v190, v148, v149
  v_cvt_pk_bf16_f32 v191, v150, v151
  v_cvt_pk_bf16_f32 v192, v152, v153
  v_cvt_pk_bf16_f32 v193, v154, v155
  v_cvt_pk_bf16_f32 v194, v156, v157
  v_cvt_pk_bf16_f32 v195, v158, v159
  v_pk_add_f32 v[214:215], v[214:215], v[216:217]
  v_add_f32 v214, v214, v215
  s_waitcnt vmcnt(19)
  v_mfma_f32_16x16x32_bf16 v[196:199], a[144:147], v[160:163], 0
  v_mfma_f32_16x16x32_bf16 v[200:203], a[148:151], v[160:163], 0
  v_mfma_f32_16x16x32_bf16 v[196:199], a[152:155], v[164:167], v[196:199]
  v_mfma_f32_16x16x32_bf16 v[200:203], a[156:159], v[164:167], v[200:203]
  v_mfma_f32_16x16x32_bf16 v[196:199], a[160:163], v[168:171], v[196:199]
  v_mfma_f32_16x16x32_bf16 v[200:203], a[164:167], v[168:171], v[200:203]
  v_mfma_f32_16x16x32_bf16 v[196:199], a[168:171], v[172:175], v[196:199]
  v_mfma_f32_16x16x32_bf16 v[200:203], a[172:175], v[172:175], v[200:203]
  v_mfma_f32_16x16x32_bf16 v[196:199], a[176:179], v[176:179], v[196:199]
  v_mfma_f32_16x16x32_bf16 v[200:203], a[180:183], v[176:179], v[200:203]
  v_mfma_f32_16x16x32_bf16 v[196:199], a[184:187], v[180:183], v[196:199]
  v_mfma_f32_16x16x32_bf16 v[200:203], a[188:191], v[180:183], v[200:203]
  v_mfma_f32_16x16x32_bf16 v[196:199], a[192:195], v[184:187], v[196:199]
  v_mfma_f32_16x16x32_bf16 v[200:203], a[196:199], v[184:187], v[200:203]
  v_mfma_f32_16x16x32_bf16 v[196:199], a[200:203], v[188:191], v[196:199]
  v_mfma_f32_16x16x32_bf16 v[200:203], a[204:207], v[188:191], v[200:203]
  v_mfma_f32_16x16x32_bf16 v[196:199], a[208:211], v[192:195], v[196:199]
  v_mfma_f32_16x16x32_bf16 v[200:203], a[212:215], v[192:195], v[200:203]
  v_mov_b32 v215, v214
  s_nop 1
  v_permlane16_swap_b32 v214, v215
  v_add_f32 v214, v214, v215
  v_mov_b32 v215, v214
  s_nop 1
  v_permlane32_swap_b32 v214, v215
  v_add_f32 v214, v214, v215
  v_rcp_f32 v214, v214
  s_nop 0
  v_mov_b32 v215, v214
  v_pk_mul_f32 v[196:197], v[196:197], v[214:215]
  v_pk_mul_f32 v[198:199], v[198:199], v[214:215]
  v_pk_mul_f32 v[200:201], v[200:201], v[214:215]
  v_pk_mul_f32 v[202:203], v[202:203], v[214:215]
  v_cvt_pk_bf16_f32 v216, v196, v197
  v_cvt_pk_bf16_f32 v217, v198, v199
  v_cvt_pk_bf16_f32 v218, v200, v201
  v_cvt_pk_bf16_f32 v219, v202, v203
  s_lshl_b32 s14, s10, 12
  v_add_u32 v10, s14, v3
  ds_write_b128 v10, v[216:219] offset:0
  v_add_u32 v9, s60, v8
  global_load_dwordx4 a[144:147], v9, s[8:9]
  v_add_u32 v9, s61, v8
  global_load_dwordx4 a[152:155], v9, s[8:9]
  v_add_u32 v9, s62, v8
  global_load_dwordx4 a[160:163], v9, s[8:9]
  v_add_u32 v9, s63, v8
  global_load_dwordx4 a[168:171], v9, s[8:9]
  v_add_u32 v9, s64, v8
  global_load_dwordx4 a[176:179], v9, s[8:9]
  v_add_u32 v9, s65, v8
  global_load_dwordx4 a[184:187], v9, s[8:9]
  v_add_u32 v9, s66, v8
  global_load_dwordx4 a[192:195], v9, s[8:9]
  v_add_u32 v9, s67, v8
  global_load_dwordx4 a[200:203], v9, s[8:9]
  v_add_u32 v9, s68, v8
  global_load_dwordx4 a[208:211], v9, s[8:9]
  v_add_u32 v8, 65536, v8
  v_add_u32 v9, s60, v8
  global_load_dwordx4 a[148:151], v9, s[8:9]
  v_add_u32 v9, s61, v8
  global_load_dwordx4 a[156:159], v9, s[8:9]
  v_add_u32 v9, s62, v8
  global_load_dwordx4 a[164:167], v9, s[8:9]
  v_add_u32 v9, s63, v8
  global_load_dwordx4 a[172:175], v9, s[8:9]
  v_add_u32 v9, s64, v8
  global_load_dwordx4 a[180:183], v9, s[8:9]
  v_add_u32 v9, s65, v8
  global_load_dwordx4 a[188:191], v9, s[8:9]
  v_add_u32 v9, s66, v8
  global_load_dwordx4 a[196:199], v9, s[8:9]
  v_add_u32 v9, s67, v8
  global_load_dwordx4 a[204:207], v9, s[8:9]
  v_add_u32 v9, s68, v8
  global_load_dwordx4 a[212:215], v9, s[8:9]
  v_add_u32 v8, 65536, v8
  v_add_u32 v9, s70, v6
  global_load_dwordx4 a[0:3], v9, s[8:9] offset:0
  global_load_dwordx4 a[4:7], v9, s[8:9] offset:1024
  v_add_u32 v9, s71, v6
  global_load_dwordx4 a[8:11], v9, s[8:9] offset:0
  global_load_dwordx4 a[12:15], v9, s[8:9] offset:1024
  v_add_u32 v9, s72, v6
  global_load_dwordx4 a[16:19], v9, s[8:9] offset:0
  global_load_dwordx4 a[20:23], v9, s[8:9] offset:1024
  v_add_u32 v9, s73, v6
  global_load_dwordx4 a[24:27], v9, s[8:9] offset:0
  global_load_dwordx4 a[28:31], v9, s[8:9] offset:1024
  v_add_u32 v9, s74, v6
  global_load_dwordx4 a[32:35], v9, s[8:9] offset:0
  global_load_dwordx4 a[36:39], v9, s[8:9] offset:1024
  v_add_u32 v9, s75, v6
  global_load_dwordx4 a[40:43], v9, s[8:9] offset:0
  global_load_dwordx4 a[44:47], v9, s[8:9] offset:1024
  v_add_u32 v9, s76, v6
  global_load_dwordx4 a[48:51], v9, s[8:9] offset:0
  global_load_dwordx4 a[52:55], v9, s[8:9] offset:1024
  v_add_u32 v9, s77, v6
  global_load_dwordx4 a[56:59], v9, s[8:9] offset:0
  global_load_dwordx4 a[60:63], v9, s[8:9] offset:1024
  v_add_u32 v9, s78, v6
  global_load_dwordx4 a[64:67], v9, s[8:9] offset:0
  global_load_dwordx4 a[68:71], v9, s[8:9] offset:1024
  global_load_dwordx4 v[204:207], v7, s[8:9]
  v_add_u32 v6, 131072, v6
  v_add_u32 v7, 131072, v7
  s_waitcnt vmcnt(37)
  v_mfma_f32_16x16x32_bf16 v[88:91], a[72:75], v[208:211], v[16:19]
  v_mfma_f32_16x16x32_bf16 v[92:95], a[76:79], v[208:211], v[20:23]
  v_mfma_f32_16x16x32_bf16 v[96:99], a[80:83], v[208:211], v[24:27]
  v_mfma_f32_16x16x32_bf16 v[100:103], a[84:87], v[208:211], v[28:31]
  v_mfma_f32_16x16x32_bf16 v[104:107], a[88:91], v[208:211], v[32:35]
  v_mfma_f32_16x16x32_bf16 v[108:111], a[92:95], v[208:211], v[36:39]
  v_mfma_f32_16x16x32_bf16 v[112:115], a[96:99], v[208:211], v[40:43]
  v_mfma_f32_16x16x32_bf16 v[116:119], a[100:103], v[208:211], v[44:47]
  v_mfma_f32_16x16x32_bf16 v[120:123], a[104:107], v[208:211], v[48:51]
  v_mfma_f32_16x16x32_bf16 v[124:127], a[108:111], v[208:211], v[52:55]
  v_mfma_f32_16x16x32_bf16 v[128:131], a[112:115], v[208:211], v[56:59]
  v_mfma_f32_16x16x32_bf16 v[132:135], a[116:119], v[208:211], v[60:63]
  v_mfma_f32_16x16x32_bf16 v[136:139], a[120:123], v[208:211], v[64:67]
  v_mfma_f32_16x16x32_bf16 v[140:143], a[124:127], v[208:211], v[68:71]
  v_mfma_f32_16x16x32_bf16 v[144:147], a[128:131], v[208:211], v[72:75]
  v_mfma_f32_16x16x32_bf16 v[148:151], a[132:135], v[208:211], v[76:79]
  v_mfma_f32_16x16x32_bf16 v[152:155], a[136:139], v[208:211], v[80:83]
  v_mfma_f32_16x16x32_bf16 v[156:159], a[140:143], v[208:211], v[84:87]
  v_max3_f32 v212, v88, v89, v90
  v_max3_f32 v213, v91, v92, v93
  v_max3_f32 v212, v212, v94, v95
  v_max3_f32 v213, v213, v96, v97
  v_max3_f32 v212, v212, v98, v99
  v_max3_f32 v213, v213, v100, v101
  v_max3_f32 v212, v212, v102, v103
  v_max3_f32 v213, v213, v104, v105
  v_max3_f32 v212, v212, v106, v107
  v_max3_f32 v213, v213, v108, v109
  v_max3_f32 v212, v212, v110, v111
  v_max3_f32 v213, v213, v112, v113
  v_max3_f32 v212, v212, v114, v115
  v_max3_f32 v213, v213, v116, v117
  v_max3_f32 v212, v212, v118, v119
  v_max3_f32 v213, v213, v120, v121
  v_max3_f32 v212, v212, v122, v123
  v_max3_f32 v213, v213, v124, v125
  v_max3_f32 v212, v212, v126, v127
  v_max3_f32 v213, v213, v128, v129
  v_max3_f32 v212, v212, v130, v131
  v_max3_f32 v213, v213, v132, v133
  v_max3_f32 v212, v212, v134, v135
  v_max3_f32 v213, v213, v136, v137
  v_max3_f32 v212, v212, v138, v139
  v_max3_f32 v213, v213, v140, v141
  v_max3_f32 v212, v212, v142, v143
  v_max3_f32 v213, v213, v144, v145
  v_max3_f32 v212, v212, v146, v147
  v_max3_f32 v213, v213, v148, v149
  v_max3_f32 v212, v212, v150, v151
  v_max3_f32 v213, v213, v152, v153
  v_max3_f32 v212, v212, v154, v155
  v_max3_f32 v213, v213, v156, v157
  v_max3_f32 v212, v212, v158, v159
  v_max_f32 v212, v212, v213
  v_mov_b32 v213, v212
  s_nop 1
  v_permlane16_swap_b32 v212, v213
  v_max_f32 v212, v212, v213
  v_mov_b32 v213, v212
  s_nop 1
  v_permlane32_swap_b32 v212, v213
  v_max_f32 v212, v212, v213
  v_mov_b32 v213, v212
  v_pk_add_f32 v[88:89], v[88:89], v[212:213] neg_lo:[0,1] neg_hi:[0,1]
  v_pk_add_f32 v[90:91], v[90:91], v[212:213] neg_lo:[0,1] neg_hi:[0,1]
  v_pk_add_f32 v[92:93], v[92:93], v[212:213] neg_lo:[0,1] neg_hi:[0,1]
  v_pk_add_f32 v[94:95], v[94:95], v[212:213] neg_lo:[0,1] neg_hi:[0,1]
  v_pk_add_f32 v[96:97], v[96:97], v[212:213] neg_lo:[0,1] neg_hi:[0,1]
  v_pk_add_f32 v[98:99], v[98:99], v[212:213] neg_lo:[0,1] neg_hi:[0,1]
  v_pk_add_f32 v[100:101], v[100:101], v[212:213] neg_lo:[0,1] neg_hi:[0,1]
  v_pk_add_f32 v[102:103], v[102:103], v[212:213] neg_lo:[0,1] neg_hi:[0,1]
  v_pk_add_f32 v[104:105], v[104:105], v[212:213] neg_lo:[0,1] neg_hi:[0,1]
  v_pk_add_f32 v[106:107], v[106:107], v[212:213] neg_lo:[0,1] neg_hi:[0,1]
  v_pk_add_f32 v[108:109], v[108:109], v[212:213] neg_lo:[0,1] neg_hi:[0,1]
  v_pk_add_f32 v[110:111], v[110:111], v[212:213] neg_lo:[0,1] neg_hi:[0,1]
  v_pk_add_f32 v[112:113], v[112:113], v[212:213] neg_lo:[0,1] neg_hi:[0,1]
  v_pk_add_f32 v[114:115], v[114:115], v[212:213] neg_lo:[0,1] neg_hi:[0,1]
  v_pk_add_f32 v[116:117], v[116:117], v[212:213] neg_lo:[0,1] neg_hi:[0,1]
  v_pk_add_f32 v[118:119], v[118:119], v[212:213] neg_lo:[0,1] neg_hi:[0,1]
  v_pk_add_f32 v[120:121], v[120:121], v[212:213] neg_lo:[0,1] neg_hi:[0,1]
  v_pk_add_f32 v[122:123], v[122:123], v[212:213] neg_lo:[0,1] neg_hi:[0,1]
  v_pk_add_f32 v[124:125], v[124:125], v[212:213] neg_lo:[0,1] neg_hi:[0,1]
  v_pk_add_f32 v[126:127], v[126:127], v[212:213] neg_lo:[0,1] neg_hi:[0,1]
  v_pk_add_f32 v[128:129], v[128:129], v[212:213] neg_lo:[0,1] neg_hi:[0,1]
  v_pk_add_f32 v[130:131], v[130:131], v[212:213] neg_lo:[0,1] neg_hi:[0,1]
  v_pk_add_f32 v[132:133], v[132:133], v[212:213] neg_lo:[0,1] neg_hi:[0,1]
  v_pk_add_f32 v[134:135], v[134:135], v[212:213] neg_lo:[0,1] neg_hi:[0,1]
  v_pk_add_f32 v[136:137], v[136:137], v[212:213] neg_lo:[0,1] neg_hi:[0,1]
  v_pk_add_f32 v[138:139], v[138:139], v[212:213] neg_lo:[0,1] neg_hi:[0,1]
  v_pk_add_f32 v[140:141], v[140:141], v[212:213] neg_lo:[0,1] neg_hi:[0,1]
  v_pk_add_f32 v[142:143], v[142:143], v[212:213] neg_lo:[0,1] neg_hi:[0,1]
  v_pk_add_f32 v[144:145], v[144:145], v[212:213] neg_lo:[0,1] neg_hi:[0,1]
  v_pk_add_f32 v[146:147], v[146:147], v[212:213] neg_lo:[0,1] neg_hi:[0,1]
  v_pk_add_f32 v[148:149], v[148:149], v[212:213] neg_lo:[0,1] neg_hi:[0,1]
  v_pk_add_f32 v[150:151], v[150:151], v[212:213] neg_lo:[0,1] neg_hi:[0,1]
  v_pk_add_f32 v[152:153], v[152:153], v[212:213] neg_lo:[0,1] neg_hi:[0,1]
  v_pk_add_f32 v[154:155], v[154:155], v[212:213] neg_lo:[0,1] neg_hi:[0,1]
  v_pk_add_f32 v[156:157], v[156:157], v[212:213] neg_lo:[0,1] neg_hi:[0,1]
  v_pk_add_f32 v[158:159], v[158:159], v[212:213] neg_lo:[0,1] neg_hi:[0,1]
  v_exp_f32 v88, v88
  v_exp_f32 v89, v89
  v_exp_f32 v90, v90
  v_exp_f32 v91, v91
  v_exp_f32 v92, v92
  v_exp_f32 v93, v93
  v_exp_f32 v94, v94
  v_exp_f32 v95, v95
  v_exp_f32 v96, v96
  v_exp_f32 v97, v97
  v_exp_f32 v98, v98
  v_exp_f32 v99, v99
  v_exp_f32 v100, v100
  v_exp_f32 v101, v101
  v_exp_f32 v102, v102
  v_exp_f32 v103, v103
  v_exp_f32 v104, v104
  v_exp_f32 v105, v105
  v_exp_f32 v106, v106
  v_exp_f32 v107, v107
  v_exp_f32 v108, v108
  v_exp_f32 v109, v109
  v_exp_f32 v110, v110
  v_exp_f32 v111, v111
  v_exp_f32 v112, v112
  v_exp_f32 v113, v113
  v_exp_f32 v114, v114
  v_exp_f32 v115, v115
  v_exp_f32 v116, v116
  v_exp_f32 v117, v117
  v_exp_f32 v118, v118
  v_exp_f32 v119, v119
  v_exp_f32 v120, v120
  v_exp_f32 v121, v121
  v_exp_f32 v122, v122
  v_exp_f32 v123, v123
  v_exp_f32 v124, v124
  v_exp_f32 v125, v125
  v_exp_f32 v126, v126
  v_exp_f32 v127, v127
  v_exp_f32 v128, v128
  v_exp_f32 v129, v129
  v_exp_f32 v130, v130
  v_exp_f32 v131, v131
  v_exp_f32 v132, v132
  v_exp_f32 v133, v133
  v_exp_f32 v134, v134
  v_exp_f32 v135, v135
  v_exp_f32 v136, v136
  v_exp_f32 v137, v137
  v_exp_f32 v138, v138
  v_exp_f32 v139, v139
  v_exp_f32 v140, v140
  v_exp_f32 v141, v141
  v_exp_f32 v142, v142
  v_exp_f32 v143, v143
  v_exp_f32 v144, v144
  v_exp_f32 v145, v145
  v_exp_f32 v146, v146
  v_exp_f32 v147, v147
  v_exp_f32 v148, v148
  v_exp_f32 v149, v149
  v_exp_f32 v150, v150
  v_exp_f32 v151, v151
  v_exp_f32 v152, v152
  v_exp_f32 v153, v153
  v_exp_f32 v154, v154
  v_exp_f32 v155, v155
  v_exp_f32 v156, v156
  v_exp_f32 v157, v157
  v_exp_f32 v158, v158
  v_exp_f32 v159, v159
  v_pk_add_f32 v[214:215], v[88:89], v[90:91]
  v_pk_add_f32 v[216:217], v[92:93], v[94:95]
  v_pk_add_f32 v[214:215], v[214:215], v[96:97]
  v_pk_add_f32 v[216:217], v[216:217], v[98:99]
  v_pk_add_f32 v[214:215], v[214:215], v[100:101]
  v_pk_add_f32 v[216:217], v[216:217], v[102:103]
  v_pk_add_f32 v[214:215], v[214:215], v[104:105]
  v_pk_add_f32 v[216:217], v[216:217], v[106:107]
  v_pk_add_f32 v[214:215], v[214:215], v[108:109]
  v_pk_add_f32 v[216:217], v[216:217], v[110:111]
  v_pk_add_f32 v[214:215], v[214:215], v[112:113]
  v_pk_add_f32 v[216:217], v[216:217], v[114:115]
  v_pk_add_f32 v[214:215], v[214:215], v[116:117]
  v_pk_add_f32 v[216:217], v[216:217], v[118:119]
  v_pk_add_f32 v[214:215], v[214:215], v[120:121]
  v_pk_add_f32 v[216:217], v[216:217], v[122:123]
  v_pk_add_f32 v[214:215], v[214:215], v[124:125]
  v_pk_add_f32 v[216:217], v[216:217], v[126:127]
  v_pk_add_f32 v[214:215], v[214:215], v[128:129]
  v_pk_add_f32 v[216:217], v[216:217], v[130:131]
  v_pk_add_f32 v[214:215], v[214:215], v[132:133]
  v_pk_add_f32 v[216:217], v[216:217], v[134:135]
  v_pk_add_f32 v[214:215], v[214:215], v[136:137]
  v_pk_add_f32 v[216:217], v[216:217], v[138:139]
  v_pk_add_f32 v[214:215], v[214:215], v[140:141]
  v_pk_add_f32 v[216:217], v[216:217], v[142:143]
  v_pk_add_f32 v[214:215], v[214:215], v[144:145]
  v_pk_add_f32 v[216:217], v[216:217], v[146:147]
  v_pk_add_f32 v[214:215], v[214:215], v[148:149]
  v_pk_add_f32 v[216:217], v[216:217], v[150:151]
  v_pk_add_f32 v[214:215], v[214:215], v[152:153]
  v_pk_add_f32 v[216:217], v[216:217], v[154:155]
  v_pk_add_f32 v[214:215], v[214:215], v[156:157]
  v_pk_add_f32 v[216:217], v[216:217], v[158:159]
  v_cvt_pk_bf16_f32 v160, v88, v89
  v_cvt_pk_bf16_f32 v161, v90, v91
  v_cvt_pk_bf16_f32 v162, v92, v93
  v_cvt_pk_bf16_f32 v163, v94, v95
  v_cvt_pk_bf16_f32 v164, v96, v97
  v_cvt_pk_bf16_f32 v165, v98, v99
  v_cvt_pk_bf16_f32 v166, v100, v101
  v_cvt_pk_bf16_f32 v167, v102, v103
  v_cvt_pk_bf16_f32 v168, v104, v105
  v_cvt_pk_bf16_f32 v169, v106, v107
  v_cvt_pk_bf16_f32 v170, v108, v109
  v_cvt_pk_bf16_f32 v171, v110, v111
  v_cvt_pk_bf16_f32 v172, v112, v113
  v_cvt_pk_bf16_f32 v173, v114, v115
  v_cvt_pk_bf16_f32 v174, v116, v117
  v_cvt_pk_bf16_f32 v175, v118, v119
  v_cvt_pk_bf16_f32 v176, v120, v121
  v_cvt_pk_bf16_f32 v177, v122, v123
  v_cvt_pk_bf16_f32 v178, v124, v125
  v_cvt_pk_bf16_f32 v179, v126, v127
  v_cvt_pk_bf16_f32 v180, v128, v129
  v_cvt_pk_bf16_f32 v181, v130, v131
  v_cvt_pk_bf16_f32 v182, v132, v133
  v_cvt_pk_bf16_f32 v183, v134, v135
  v_cvt_pk_bf16_f32 v184, v136, v137
  v_cvt_pk_bf16_f32 v185, v138, v139
  v_cvt_pk_bf16_f32 v186, v140, v141
  v_cvt_pk_bf16_f32 v187, v142, v143
  v_cvt_pk_bf16_f32 v188, v144, v145
  v_cvt_pk_bf16_f32 v189, v146, v147
  v_cvt_pk_bf16_f32 v190, v148, v149
  v_cvt_pk_bf16_f32 v191, v150, v151
  v_cvt_pk_bf16_f32 v192, v152, v153
  v_cvt_pk_bf16_f32 v193, v154, v155
  v_cvt_pk_bf16_f32 v194, v156, v157
  v_cvt_pk_bf16_f32 v195, v158, v159
  v_pk_add_f32 v[214:215], v[214:215], v[216:217]
  v_add_f32 v214, v214, v215
  s_waitcnt vmcnt(19)
  v_mfma_f32_16x16x32_bf16 v[196:199], a[144:147], v[160:163], 0
  v_mfma_f32_16x16x32_bf16 v[200:203], a[148:151], v[160:163], 0
  v_mfma_f32_16x16x32_bf16 v[196:199], a[152:155], v[164:167], v[196:199]
  v_mfma_f32_16x16x32_bf16 v[200:203], a[156:159], v[164:167], v[200:203]
  v_mfma_f32_16x16x32_bf16 v[196:199], a[160:163], v[168:171], v[196:199]
  v_mfma_f32_16x16x32_bf16 v[200:203], a[164:167], v[168:171], v[200:203]
  v_mfma_f32_16x16x32_bf16 v[196:199], a[168:171], v[172:175], v[196:199]
  v_mfma_f32_16x16x32_bf16 v[200:203], a[172:175], v[172:175], v[200:203]
  v_mfma_f32_16x16x32_bf16 v[196:199], a[176:179], v[176:179], v[196:199]
  v_mfma_f32_16x16x32_bf16 v[200:203], a[180:183], v[176:179], v[200:203]
  v_mfma_f32_16x16x32_bf16 v[196:199], a[184:187], v[180:183], v[196:199]
  v_mfma_f32_16x16x32_bf16 v[200:203], a[188:191], v[180:183], v[200:203]
  v_mfma_f32_16x16x32_bf16 v[196:199], a[192:195], v[184:187], v[196:199]
  v_mfma_f32_16x16x32_bf16 v[200:203], a[196:199], v[184:187], v[200:203]
  v_mfma_f32_16x16x32_bf16 v[196:199], a[200:203], v[188:191], v[196:199]
  v_mfma_f32_16x16x32_bf16 v[200:203], a[204:207], v[188:191], v[200:203]
  v_mfma_f32_16x16x32_bf16 v[196:199], a[208:211], v[192:195], v[196:199]
  v_mfma_f32_16x16x32_bf16 v[200:203], a[212:215], v[192:195], v[200:203]
  v_mov_b32 v215, v214
  s_nop 1
  v_permlane16_swap_b32 v214, v215
  v_add_f32 v214, v214, v215
  v_mov_b32 v215, v214
  s_nop 1
  v_permlane32_swap_b32 v214, v215
  v_add_f32 v214, v214, v215
  v_rcp_f32 v214, v214
  s_nop 0
  v_mov_b32 v215, v214
  v_pk_mul_f32 v[196:197], v[196:197], v[214:215]
  v_pk_mul_f32 v[198:199], v[198:199], v[214:215]
  v_pk_mul_f32 v[200:201], v[200:201], v[214:215]
  v_pk_mul_f32 v[202:203], v[202:203], v[214:215]
  v_cvt_pk_bf16_f32 v216, v196, v197
  v_cvt_pk_bf16_f32 v217, v198, v199
  v_cvt_pk_bf16_f32 v218, v200, v201
  v_cvt_pk_bf16_f32 v219, v202, v203
  ds_write_b128 v10, v[216:219] offset:1024
  v_add_u32 v9, s60, v8
  global_load_dwordx4 a[144:147], v9, s[8:9]
  v_add_u32 v9, s61, v8
  global_load_dwordx4 a[152:155], v9, s[8:9]
  v_add_u32 v9, s62, v8
  global_load_dwordx4 a[160:163], v9, s[8:9]
  v_add_u32 v9, s63, v8
  global_load_dwordx4 a[168:171], v9, s[8:9]
  v_add_u32 v9, s64, v8
  global_load_dwordx4 a[176:179], v9, s[8:9]
  v_add_u32 v9, s65, v8
  global_load_dwordx4 a[184:187], v9, s[8:9]
  v_add_u32 v9, s66, v8
  global_load_dwordx4 a[192:195], v9, s[8:9]
  v_add_u32 v9, s67, v8
  global_load_dwordx4 a[200:203], v9, s[8:9]
  v_add_u32 v9, s68, v8
  global_load_dwordx4 a[208:211], v9, s[8:9]
  v_add_u32 v8, 65536, v8
  v_add_u32 v9, s60, v8
  global_load_dwordx4 a[148:151], v9, s[8:9]
  v_add_u32 v9, s61, v8
  global_load_dwordx4 a[156:159], v9, s[8:9]
  v_add_u32 v9, s62, v8
  global_load_dwordx4 a[164:167], v9, s[8:9]
  v_add_u32 v9, s63, v8
  global_load_dwordx4 a[172:175], v9, s[8:9]
  v_add_u32 v9, s64, v8
  global_load_dwordx4 a[180:183], v9, s[8:9]
  v_add_u32 v9, s65, v8
  global_load_dwordx4 a[188:191], v9, s[8:9]
  v_add_u32 v9, s66, v8
  global_load_dwordx4 a[196:199], v9, s[8:9]
  v_add_u32 v9, s67, v8
  global_load_dwordx4 a[204:207], v9, s[8:9]
  v_add_u32 v9, s68, v8
  global_load_dwordx4 a[212:215], v9, s[8:9]
  v_add_u32 v8, 65536, v8
  v_add_u32 v9, s70, v6
  global_load_dwordx4 a[72:75], v9, s[8:9] offset:0
  global_load_dwordx4 a[76:79], v9, s[8:9] offset:1024
  v_add_u32 v9, s71, v6
  global_load_dwordx4 a[80:83], v9, s[8:9] offset:0
  global_load_dwordx4 a[84:87], v9, s[8:9] offset:1024
  v_add_u32 v9, s72, v6
  global_load_dwordx4 a[88:91], v9, s[8:9] offset:0
  global_load_dwordx4 a[92:95], v9, s[8:9] offset:1024
  v_add_u32 v9, s73, v6
  global_load_dwordx4 a[96:99], v9, s[8:9] offset:0
  global_load_dwordx4 a[100:103], v9, s[8:9] offset:1024
  v_add_u32 v9, s74, v6
  global_load_dwordx4 a[104:107], v9, s[8:9] offset:0
  global_load_dwordx4 a[108:111], v9, s[8:9] offset:1024
  v_add_u32 v9, s75, v6
  global_load_dwordx4 a[112:115], v9, s[8:9] offset:0
  global_load_dwordx4 a[116:119], v9, s[8:9] offset:1024
  v_add_u32 v9, s76, v6
  global_load_dwordx4 a[120:123], v9, s[8:9] offset:0
  global_load_dwordx4 a[124:127], v9, s[8:9] offset:1024
  v_add_u32 v9, s77, v6
  global_load_dwordx4 a[128:131], v9, s[8:9] offset:0
  global_load_dwordx4 a[132:135], v9, s[8:9] offset:1024
  v_add_u32 v9, s78, v6
  global_load_dwordx4 a[136:139], v9, s[8:9] offset:0
  global_load_dwordx4 a[140:143], v9, s[8:9] offset:1024
  global_load_dwordx4 v[208:211], v7, s[8:9]
  v_add_u32 v6, 131072, v6
  v_add_u32 v7, 131072, v7
  s_waitcnt vmcnt(37)
  v_mfma_f32_16x16x32_bf16 v[88:91], a[0:3], v[204:207], v[16:19]
  v_mfma_f32_16x16x32_bf16 v[92:95], a[4:7], v[204:207], v[20:23]
  v_mfma_f32_16x16x32_bf16 v[96:99], a[8:11], v[204:207], v[24:27]
  v_mfma_f32_16x16x32_bf16 v[100:103], a[12:15], v[204:207], v[28:31]
  v_mfma_f32_16x16x32_bf16 v[104:107], a[16:19], v[204:207], v[32:35]
  v_mfma_f32_16x16x32_bf16 v[108:111], a[20:23], v[204:207], v[36:39]
  v_mfma_f32_16x16x32_bf16 v[112:115], a[24:27], v[204:207], v[40:43]
  v_mfma_f32_16x16x32_bf16 v[116:119], a[28:31], v[204:207], v[44:47]
  v_mfma_f32_16x16x32_bf16 v[120:123], a[32:35], v[204:207], v[48:51]
  v_mfma_f32_16x16x32_bf16 v[124:127], a[36:39], v[204:207], v[52:55]
  v_mfma_f32_16x16x32_bf16 v[128:131], a[40:43], v[204:207], v[56:59]
  v_mfma_f32_16x16x32_bf16 v[132:135], a[44:47], v[204:207], v[60:63]
  v_mfma_f32_16x16x32_bf16 v[136:139], a[48:51], v[204:207], v[64:67]
  v_mfma_f32_16x16x32_bf16 v[140:143], a[52:55], v[204:207], v[68:71]
  v_mfma_f32_16x16x32_bf16 v[144:147], a[56:59], v[204:207], v[72:75]
  v_mfma_f32_16x16x32_bf16 v[148:151], a[60:63], v[204:207], v[76:79]
  v_mfma_f32_16x16x32_bf16 v[152:155], a[64:67], v[204:207], v[80:83]
  v_mfma_f32_16x16x32_bf16 v[156:159], a[68:71], v[204:207], v[84:87]
  v_max3_f32 v212, v88, v89, v90
  v_max3_f32 v213, v91, v92, v93
  v_max3_f32 v212, v212, v94, v95
  v_max3_f32 v213, v213, v96, v97
  v_max3_f32 v212, v212, v98, v99
  v_max3_f32 v213, v213, v100, v101
  v_max3_f32 v212, v212, v102, v103
  v_max3_f32 v213, v213, v104, v105
  v_max3_f32 v212, v212, v106, v107
  v_max3_f32 v213, v213, v108, v109
  v_max3_f32 v212, v212, v110, v111
  v_max3_f32 v213, v213, v112, v113
  v_max3_f32 v212, v212, v114, v115
  v_max3_f32 v213, v213, v116, v117
  v_max3_f32 v212, v212, v118, v119
  v_max3_f32 v213, v213, v120, v121
  v_max3_f32 v212, v212, v122, v123
  v_max3_f32 v213, v213, v124, v125
  v_max3_f32 v212, v212, v126, v127
  v_max3_f32 v213, v213, v128, v129
  v_max3_f32 v212, v212, v130, v131
  v_max3_f32 v213, v213, v132, v133
  v_max3_f32 v212, v212, v134, v135
  v_max3_f32 v213, v213, v136, v137
  v_max3_f32 v212, v212, v138, v139
  v_max3_f32 v213, v213, v140, v141
  v_max3_f32 v212, v212, v142, v143
  v_max3_f32 v213, v213, v144, v145
  v_max3_f32 v212, v212, v146, v147
  v_max3_f32 v213, v213, v148, v149
  v_max3_f32 v212, v212, v150, v151
  v_max3_f32 v213, v213, v152, v153
  v_max3_f32 v212, v212, v154, v155
  v_max3_f32 v213, v213, v156, v157
  v_max3_f32 v212, v212, v158, v159
  v_max_f32 v212, v212, v213
  v_mov_b32 v213, v212
  s_nop 1
  v_permlane16_swap_b32 v212, v213
  v_max_f32 v212, v212, v213
  v_mov_b32 v213, v212
  s_nop 1
  v_permlane32_swap_b32 v212, v213
  v_max_f32 v212, v212, v213
  v_mov_b32 v213, v212
  v_pk_add_f32 v[88:89], v[88:89], v[212:213] neg_lo:[0,1] neg_hi:[0,1]
  v_pk_add_f32 v[90:91], v[90:91], v[212:213] neg_lo:[0,1] neg_hi:[0,1]
  v_pk_add_f32 v[92:93], v[92:93], v[212:213] neg_lo:[0,1] neg_hi:[0,1]
  v_pk_add_f32 v[94:95], v[94:95], v[212:213] neg_lo:[0,1] neg_hi:[0,1]
  v_pk_add_f32 v[96:97], v[96:97], v[212:213] neg_lo:[0,1] neg_hi:[0,1]
  v_pk_add_f32 v[98:99], v[98:99], v[212:213] neg_lo:[0,1] neg_hi:[0,1]
  v_pk_add_f32 v[100:101], v[100:101], v[212:213] neg_lo:[0,1] neg_hi:[0,1]
  v_pk_add_f32 v[102:103], v[102:103], v[212:213] neg_lo:[0,1] neg_hi:[0,1]
  v_pk_add_f32 v[104:105], v[104:105], v[212:213] neg_lo:[0,1] neg_hi:[0,1]
  v_pk_add_f32 v[106:107], v[106:107], v[212:213] neg_lo:[0,1] neg_hi:[0,1]
  v_pk_add_f32 v[108:109], v[108:109], v[212:213] neg_lo:[0,1] neg_hi:[0,1]
  v_pk_add_f32 v[110:111], v[110:111], v[212:213] neg_lo:[0,1] neg_hi:[0,1]
  v_pk_add_f32 v[112:113], v[112:113], v[212:213] neg_lo:[0,1] neg_hi:[0,1]
  v_pk_add_f32 v[114:115], v[114:115], v[212:213] neg_lo:[0,1] neg_hi:[0,1]
  v_pk_add_f32 v[116:117], v[116:117], v[212:213] neg_lo:[0,1] neg_hi:[0,1]
  v_pk_add_f32 v[118:119], v[118:119], v[212:213] neg_lo:[0,1] neg_hi:[0,1]
  v_pk_add_f32 v[120:121], v[120:121], v[212:213] neg_lo:[0,1] neg_hi:[0,1]
  v_pk_add_f32 v[122:123], v[122:123], v[212:213] neg_lo:[0,1] neg_hi:[0,1]
  v_pk_add_f32 v[124:125], v[124:125], v[212:213] neg_lo:[0,1] neg_hi:[0,1]
  v_pk_add_f32 v[126:127], v[126:127], v[212:213] neg_lo:[0,1] neg_hi:[0,1]
  v_pk_add_f32 v[128:129], v[128:129], v[212:213] neg_lo:[0,1] neg_hi:[0,1]
  v_pk_add_f32 v[130:131], v[130:131], v[212:213] neg_lo:[0,1] neg_hi:[0,1]
  v_pk_add_f32 v[132:133], v[132:133], v[212:213] neg_lo:[0,1] neg_hi:[0,1]
  v_pk_add_f32 v[134:135], v[134:135], v[212:213] neg_lo:[0,1] neg_hi:[0,1]
  v_pk_add_f32 v[136:137], v[136:137], v[212:213] neg_lo:[0,1] neg_hi:[0,1]
  v_pk_add_f32 v[138:139], v[138:139], v[212:213] neg_lo:[0,1] neg_hi:[0,1]
  v_pk_add_f32 v[140:141], v[140:141], v[212:213] neg_lo:[0,1] neg_hi:[0,1]
  v_pk_add_f32 v[142:143], v[142:143], v[212:213] neg_lo:[0,1] neg_hi:[0,1]
  v_pk_add_f32 v[144:145], v[144:145], v[212:213] neg_lo:[0,1] neg_hi:[0,1]
  v_pk_add_f32 v[146:147], v[146:147], v[212:213] neg_lo:[0,1] neg_hi:[0,1]
  v_pk_add_f32 v[148:149], v[148:149], v[212:213] neg_lo:[0,1] neg_hi:[0,1]
  v_pk_add_f32 v[150:151], v[150:151], v[212:213] neg_lo:[0,1] neg_hi:[0,1]
  v_pk_add_f32 v[152:153], v[152:153], v[212:213] neg_lo:[0,1] neg_hi:[0,1]
  v_pk_add_f32 v[154:155], v[154:155], v[212:213] neg_lo:[0,1] neg_hi:[0,1]
  v_pk_add_f32 v[156:157], v[156:157], v[212:213] neg_lo:[0,1] neg_hi:[0,1]
  v_pk_add_f32 v[158:159], v[158:159], v[212:213] neg_lo:[0,1] neg_hi:[0,1]
  v_exp_f32 v88, v88
  v_exp_f32 v89, v89
  v_exp_f32 v90, v90
  v_exp_f32 v91, v91
  v_exp_f32 v92, v92
  v_exp_f32 v93, v93
  v_exp_f32 v94, v94
  v_exp_f32 v95, v95
  v_exp_f32 v96, v96
  v_exp_f32 v97, v97
  v_exp_f32 v98, v98
  v_exp_f32 v99, v99
  v_exp_f32 v100, v100
  v_exp_f32 v101, v101
  v_exp_f32 v102, v102
  v_exp_f32 v103, v103
  v_exp_f32 v104, v104
  v_exp_f32 v105, v105
  v_exp_f32 v106, v106
  v_exp_f32 v107, v107
  v_exp_f32 v108, v108
  v_exp_f32 v109, v109
  v_exp_f32 v110, v110
  v_exp_f32 v111, v111
  v_exp_f32 v112, v112
  v_exp_f32 v113, v113
  v_exp_f32 v114, v114
  v_exp_f32 v115, v115
  v_exp_f32 v116, v116
  v_exp_f32 v117, v117
  v_exp_f32 v118, v118
  v_exp_f32 v119, v119
  v_exp_f32 v120, v120
  v_exp_f32 v121, v121
  v_exp_f32 v122, v122
  v_exp_f32 v123, v123
  v_exp_f32 v124, v124
  v_exp_f32 v125, v125
  v_exp_f32 v126, v126
  v_exp_f32 v127, v127
  v_exp_f32 v128, v128
  v_exp_f32 v129, v129
  v_exp_f32 v130, v130
  v_exp_f32 v131, v131
  v_exp_f32 v132, v132
  v_exp_f32 v133, v133
  v_exp_f32 v134, v134
  v_exp_f32 v135, v135
  v_exp_f32 v136, v136
  v_exp_f32 v137, v137
  v_exp_f32 v138, v138
  v_exp_f32 v139, v139
  v_exp_f32 v140, v140
  v_exp_f32 v141, v141
  v_exp_f32 v142, v142
  v_exp_f32 v143, v143
  v_exp_f32 v144, v144
  v_exp_f32 v145, v145
  v_exp_f32 v146, v146
  v_exp_f32 v147, v147
  v_exp_f32 v148, v148
  v_exp_f32 v149, v149
  v_exp_f32 v150, v150
  v_exp_f32 v151, v151
  v_exp_f32 v152, v152
  v_exp_f32 v153, v153
  v_exp_f32 v154, v154
  v_exp_f32 v155, v155
  v_exp_f32 v156, v156
  v_exp_f32 v157, v157
  v_exp_f32 v158, v158
  v_exp_f32 v159, v159
  v_pk_add_f32 v[214:215], v[88:89], v[90:91]
  v_pk_add_f32 v[216:217], v[92:93], v[94:95]
  v_pk_add_f32 v[214:215], v[214:215], v[96:97]
  v_pk_add_f32 v[216:217], v[216:217], v[98:99]
  v_pk_add_f32 v[214:215], v[214:215], v[100:101]
  v_pk_add_f32 v[216:217], v[216:217], v[102:103]
  v_pk_add_f32 v[214:215], v[214:215], v[104:105]
  v_pk_add_f32 v[216:217], v[216:217], v[106:107]
  v_pk_add_f32 v[214:215], v[214:215], v[108:109]
  v_pk_add_f32 v[216:217], v[216:217], v[110:111]
  v_pk_add_f32 v[214:215], v[214:215], v[112:113]
  v_pk_add_f32 v[216:217], v[216:217], v[114:115]
  v_pk_add_f32 v[214:215], v[214:215], v[116:117]
  v_pk_add_f32 v[216:217], v[216:217], v[118:119]
  v_pk_add_f32 v[214:215], v[214:215], v[120:121]
  v_pk_add_f32 v[216:217], v[216:217], v[122:123]
  v_pk_add_f32 v[214:215], v[214:215], v[124:125]
  v_pk_add_f32 v[216:217], v[216:217], v[126:127]
  v_pk_add_f32 v[214:215], v[214:215], v[128:129]
  v_pk_add_f32 v[216:217], v[216:217], v[130:131]
  v_pk_add_f32 v[214:215], v[214:215], v[132:133]
  v_pk_add_f32 v[216:217], v[216:217], v[134:135]
  v_pk_add_f32 v[214:215], v[214:215], v[136:137]
  v_pk_add_f32 v[216:217], v[216:217], v[138:139]
  v_pk_add_f32 v[214:215], v[214:215], v[140:141]
  v_pk_add_f32 v[216:217], v[216:217], v[142:143]
  v_pk_add_f32 v[214:215], v[214:215], v[144:145]
  v_pk_add_f32 v[216:217], v[216:217], v[146:147]
  v_pk_add_f32 v[214:215], v[214:215], v[148:149]
  v_pk_add_f32 v[216:217], v[216:217], v[150:151]
  v_pk_add_f32 v[214:215], v[214:215], v[152:153]
  v_pk_add_f32 v[216:217], v[216:217], v[154:155]
  v_pk_add_f32 v[214:215], v[214:215], v[156:157]
  v_pk_add_f32 v[216:217], v[216:217], v[158:159]
  v_cvt_pk_bf16_f32 v160, v88, v89
  v_cvt_pk_bf16_f32 v161, v90, v91
  v_cvt_pk_bf16_f32 v162, v92, v93
  v_cvt_pk_bf16_f32 v163, v94, v95
  v_cvt_pk_bf16_f32 v164, v96, v97
  v_cvt_pk_bf16_f32 v165, v98, v99
  v_cvt_pk_bf16_f32 v166, v100, v101
  v_cvt_pk_bf16_f32 v167, v102, v103
  v_cvt_pk_bf16_f32 v168, v104, v105
  v_cvt_pk_bf16_f32 v169, v106, v107
  v_cvt_pk_bf16_f32 v170, v108, v109
  v_cvt_pk_bf16_f32 v171, v110, v111
  v_cvt_pk_bf16_f32 v172, v112, v113
  v_cvt_pk_bf16_f32 v173, v114, v115
  v_cvt_pk_bf16_f32 v174, v116, v117
  v_cvt_pk_bf16_f32 v175, v118, v119
  v_cvt_pk_bf16_f32 v176, v120, v121
  v_cvt_pk_bf16_f32 v177, v122, v123
  v_cvt_pk_bf16_f32 v178, v124, v125
  v_cvt_pk_bf16_f32 v179, v126, v127
  v_cvt_pk_bf16_f32 v180, v128, v129
  v_cvt_pk_bf16_f32 v181, v130, v131
  v_cvt_pk_bf16_f32 v182, v132, v133
  v_cvt_pk_bf16_f32 v183, v134, v135
  v_cvt_pk_bf16_f32 v184, v136, v137
  v_cvt_pk_bf16_f32 v185, v138, v139
  v_cvt_pk_bf16_f32 v186, v140, v141
  v_cvt_pk_bf16_f32 v187, v142, v143
  v_cvt_pk_bf16_f32 v188, v144, v145
  v_cvt_pk_bf16_f32 v189, v146, v147
  v_cvt_pk_bf16_f32 v190, v148, v149
  v_cvt_pk_bf16_f32 v191, v150, v151
  v_cvt_pk_bf16_f32 v192, v152, v153
  v_cvt_pk_bf16_f32 v193, v154, v155
  v_cvt_pk_bf16_f32 v194, v156, v157
  v_cvt_pk_bf16_f32 v195, v158, v159
  v_pk_add_f32 v[214:215], v[214:215], v[216:217]
  v_add_f32 v214, v214, v215
  s_waitcnt vmcnt(19)
  v_mfma_f32_16x16x32_bf16 v[196:199], a[144:147], v[160:163], 0
  v_mfma_f32_16x16x32_bf16 v[200:203], a[148:151], v[160:163], 0
  v_mfma_f32_16x16x32_bf16 v[196:199], a[152:155], v[164:167], v[196:199]
  v_mfma_f32_16x16x32_bf16 v[200:203], a[156:159], v[164:167], v[200:203]
  v_mfma_f32_16x16x32_bf16 v[196:199], a[160:163], v[168:171], v[196:199]
  v_mfma_f32_16x16x32_bf16 v[200:203], a[164:167], v[168:171], v[200:203]
  v_mfma_f32_16x16x32_bf16 v[196:199], a[168:171], v[172:175], v[196:199]
  v_mfma_f32_16x16x32_bf16 v[200:203], a[172:175], v[172:175], v[200:203]
  v_mfma_f32_16x16x32_bf16 v[196:199], a[176:179], v[176:179], v[196:199]
  v_mfma_f32_16x16x32_bf16 v[200:203], a[180:183], v[176:179], v[200:203]
  v_mfma_f32_16x16x32_bf16 v[196:199], a[184:187], v[180:183], v[196:199]
  v_mfma_f32_16x16x32_bf16 v[200:203], a[188:191], v[180:183], v[200:203]
  v_mfma_f32_16x16x32_bf16 v[196:199], a[192:195], v[184:187], v[196:199]
  v_mfma_f32_16x16x32_bf16 v[200:203], a[196:199], v[184:187], v[200:203]
  v_mfma_f32_16x16x32_bf16 v[196:199], a[200:203], v[188:191], v[196:199]
  v_mfma_f32_16x16x32_bf16 v[200:203], a[204:207], v[188:191], v[200:203]
  v_mfma_f32_16x16x32_bf16 v[196:199], a[208:211], v[192:195], v[196:199]
  v_mfma_f32_16x16x32_bf16 v[200:203], a[212:215], v[192:195], v[200:203]
  v_mov_b32 v215, v214
  s_nop 1
  v_permlane16_swap_b32 v214, v215
  v_add_f32 v214, v214, v215
  v_mov_b32 v215, v214
  s_nop 1
  v_permlane32_swap_b32 v214, v215
  v_add_f32 v214, v214, v215
  v_rcp_f32 v214, v214
  s_nop 0
  v_mov_b32 v215, v214
  v_pk_mul_f32 v[196:197], v[196:197], v[214:215]
  v_pk_mul_f32 v[198:199], v[198:199], v[214:215]
  v_pk_mul_f32 v[200:201], v[200:201], v[214:215]
  v_pk_mul_f32 v[202:203], v[202:203], v[214:215]
  v_cvt_pk_bf16_f32 v216, v196, v197
  v_cvt_pk_bf16_f32 v217, v198, v199
  v_cvt_pk_bf16_f32 v218, v200, v201
  v_cvt_pk_bf16_f32 v219, v202, v203
  ds_write_b128 v10, v[216:219] offset:2048
  v_add_u32 v9, s60, v8
  global_load_dwordx4 a[144:147], v9, s[8:9]
  v_add_u32 v9, s61, v8
  global_load_dwordx4 a[152:155], v9, s[8:9]
  v_add_u32 v9, s62, v8
  global_load_dwordx4 a[160:163], v9, s[8:9]
  v_add_u32 v9, s63, v8
  global_load_dwordx4 a[168:171], v9, s[8:9]
  v_add_u32 v9, s64, v8
  global_load_dwordx4 a[176:179], v9, s[8:9]
  v_add_u32 v9, s65, v8
  global_load_dwordx4 a[184:187], v9, s[8:9]
  v_add_u32 v9, s66, v8
  global_load_dwordx4 a[192:195], v9, s[8:9]
  v_add_u32 v9, s67, v8
  global_load_dwordx4 a[200:203], v9, s[8:9]
  v_add_u32 v9, s68, v8
  global_load_dwordx4 a[208:211], v9, s[8:9]
  v_add_u32 v8, 65536, v8
  v_add_u32 v9, s60, v8
  global_load_dwordx4 a[148:151], v9, s[8:9]
  v_add_u32 v9, s61, v8
  global_load_dwordx4 a[156:159], v9, s[8:9]
  v_add_u32 v9, s62, v8
  global_load_dwordx4 a[164:167], v9, s[8:9]
  v_add_u32 v9, s63, v8
  global_load_dwordx4 a[172:175], v9, s[8:9]
  v_add_u32 v9, s64, v8
  global_load_dwordx4 a[180:183], v9, s[8:9]
  v_add_u32 v9, s65, v8
  global_load_dwordx4 a[188:191], v9, s[8:9]
  v_add_u32 v9, s66, v8
  global_load_dwordx4 a[196:199], v9, s[8:9]
  v_add_u32 v9, s67, v8
  global_load_dwordx4 a[204:207], v9, s[8:9]
  v_add_u32 v9, s68, v8
  global_load_dwordx4 a[212:215], v9, s[8:9]
  v_add_u32 v8, 65536, v8
  s_waitcnt vmcnt(18)
  v_mfma_f32_16x16x32_bf16 v[88:91], a[72:75], v[208:211], v[16:19]
  v_mfma_f32_16x16x32_bf16 v[92:95], a[76:79], v[208:211], v[20:23]
  v_mfma_f32_16x16x32_bf16 v[96:99], a[80:83], v[208:211], v[24:27]
  v_mfma_f32_16x16x32_bf16 v[100:103], a[84:87], v[208:211], v[28:31]
  v_mfma_f32_16x16x32_bf16 v[104:107], a[88:91], v[208:211], v[32:35]
  v_mfma_f32_16x16x32_bf16 v[108:111], a[92:95], v[208:211], v[36:39]
  v_mfma_f32_16x16x32_bf16 v[112:115], a[96:99], v[208:211], v[40:43]
  v_mfma_f32_16x16x32_bf16 v[116:119], a[100:103], v[208:211], v[44:47]
  v_mfma_f32_16x16x32_bf16 v[120:123], a[104:107], v[208:211], v[48:51]
  v_mfma_f32_16x16x32_bf16 v[124:127], a[108:111], v[208:211], v[52:55]
  v_mfma_f32_16x16x32_bf16 v[128:131], a[112:115], v[208:211], v[56:59]
  v_mfma_f32_16x16x32_bf16 v[132:135], a[116:119], v[208:211], v[60:63]
  v_mfma_f32_16x16x32_bf16 v[136:139], a[120:123], v[208:211], v[64:67]
  v_mfma_f32_16x16x32_bf16 v[140:143], a[124:127], v[208:211], v[68:71]
  v_mfma_f32_16x16x32_bf16 v[144:147], a[128:131], v[208:211], v[72:75]
  v_mfma_f32_16x16x32_bf16 v[148:151], a[132:135], v[208:211], v[76:79]
  v_mfma_f32_16x16x32_bf16 v[152:155], a[136:139], v[208:211], v[80:83]
  v_mfma_f32_16x16x32_bf16 v[156:159], a[140:143], v[208:211], v[84:87]
  v_max3_f32 v212, v88, v89, v90
  v_max3_f32 v213, v91, v92, v93
  v_max3_f32 v212, v212, v94, v95
  v_max3_f32 v213, v213, v96, v97
  v_max3_f32 v212, v212, v98, v99
  v_max3_f32 v213, v213, v100, v101
  v_max3_f32 v212, v212, v102, v103
  v_max3_f32 v213, v213, v104, v105
  v_max3_f32 v212, v212, v106, v107
  v_max3_f32 v213, v213, v108, v109
  v_max3_f32 v212, v212, v110, v111
  v_max3_f32 v213, v213, v112, v113
  v_max3_f32 v212, v212, v114, v115
  v_max3_f32 v213, v213, v116, v117
  v_max3_f32 v212, v212, v118, v119
  v_max3_f32 v213, v213, v120, v121
  v_max3_f32 v212, v212, v122, v123
  v_max3_f32 v213, v213, v124, v125
  v_max3_f32 v212, v212, v126, v127
  v_max3_f32 v213, v213, v128, v129
  v_max3_f32 v212, v212, v130, v131
  v_max3_f32 v213, v213, v132, v133
  v_max3_f32 v212, v212, v134, v135
  v_max3_f32 v213, v213, v136, v137
  v_max3_f32 v212, v212, v138, v139
  v_max3_f32 v213, v213, v140, v141
  v_max3_f32 v212, v212, v142, v143
  v_max3_f32 v213, v213, v144, v145
  v_max3_f32 v212, v212, v146, v147
  v_max3_f32 v213, v213, v148, v149
  v_max3_f32 v212, v212, v150, v151
  v_max3_f32 v213, v213, v152, v153
  v_max3_f32 v212, v212, v154, v155
  v_max3_f32 v213, v213, v156, v157
  v_max3_f32 v212, v212, v158, v159
  v_max_f32 v212, v212, v213
  v_mov_b32 v213, v212
  s_nop 1
  v_permlane16_swap_b32 v212, v213
  v_max_f32 v212, v212, v213
  v_mov_b32 v213, v212
  s_nop 1
  v_permlane32_swap_b32 v212, v213
  v_max_f32 v212, v212, v213
  v_mov_b32 v213, v212
  v_pk_add_f32 v[88:89], v[88:89], v[212:213] neg_lo:[0,1] neg_hi:[0,1]
  v_pk_add_f32 v[90:91], v[90:91], v[212:213] neg_lo:[0,1] neg_hi:[0,1]
  v_pk_add_f32 v[92:93], v[92:93], v[212:213] neg_lo:[0,1] neg_hi:[0,1]
  v_pk_add_f32 v[94:95], v[94:95], v[212:213] neg_lo:[0,1] neg_hi:[0,1]
  v_pk_add_f32 v[96:97], v[96:97], v[212:213] neg_lo:[0,1] neg_hi:[0,1]
  v_pk_add_f32 v[98:99], v[98:99], v[212:213] neg_lo:[0,1] neg_hi:[0,1]
  v_pk_add_f32 v[100:101], v[100:101], v[212:213] neg_lo:[0,1] neg_hi:[0,1]
  v_pk_add_f32 v[102:103], v[102:103], v[212:213] neg_lo:[0,1] neg_hi:[0,1]
  v_pk_add_f32 v[104:105], v[104:105], v[212:213] neg_lo:[0,1] neg_hi:[0,1]
  v_pk_add_f32 v[106:107], v[106:107], v[212:213] neg_lo:[0,1] neg_hi:[0,1]
  v_pk_add_f32 v[108:109], v[108:109], v[212:213] neg_lo:[0,1] neg_hi:[0,1]
  v_pk_add_f32 v[110:111], v[110:111], v[212:213] neg_lo:[0,1] neg_hi:[0,1]
  v_pk_add_f32 v[112:113], v[112:113], v[212:213] neg_lo:[0,1] neg_hi:[0,1]
  v_pk_add_f32 v[114:115], v[114:115], v[212:213] neg_lo:[0,1] neg_hi:[0,1]
  v_pk_add_f32 v[116:117], v[116:117], v[212:213] neg_lo:[0,1] neg_hi:[0,1]
  v_pk_add_f32 v[118:119], v[118:119], v[212:213] neg_lo:[0,1] neg_hi:[0,1]
  v_pk_add_f32 v[120:121], v[120:121], v[212:213] neg_lo:[0,1] neg_hi:[0,1]
  v_pk_add_f32 v[122:123], v[122:123], v[212:213] neg_lo:[0,1] neg_hi:[0,1]
  v_pk_add_f32 v[124:125], v[124:125], v[212:213] neg_lo:[0,1] neg_hi:[0,1]
  v_pk_add_f32 v[126:127], v[126:127], v[212:213] neg_lo:[0,1] neg_hi:[0,1]
  v_pk_add_f32 v[128:129], v[128:129], v[212:213] neg_lo:[0,1] neg_hi:[0,1]
  v_pk_add_f32 v[130:131], v[130:131], v[212:213] neg_lo:[0,1] neg_hi:[0,1]
  v_pk_add_f32 v[132:133], v[132:133], v[212:213] neg_lo:[0,1] neg_hi:[0,1]
  v_pk_add_f32 v[134:135], v[134:135], v[212:213] neg_lo:[0,1] neg_hi:[0,1]
  v_pk_add_f32 v[136:137], v[136:137], v[212:213] neg_lo:[0,1] neg_hi:[0,1]
  v_pk_add_f32 v[138:139], v[138:139], v[212:213] neg_lo:[0,1] neg_hi:[0,1]
  v_pk_add_f32 v[140:141], v[140:141], v[212:213] neg_lo:[0,1] neg_hi:[0,1]
  v_pk_add_f32 v[142:143], v[142:143], v[212:213] neg_lo:[0,1] neg_hi:[0,1]
  v_pk_add_f32 v[144:145], v[144:145], v[212:213] neg_lo:[0,1] neg_hi:[0,1]
  v_pk_add_f32 v[146:147], v[146:147], v[212:213] neg_lo:[0,1] neg_hi:[0,1]
  v_pk_add_f32 v[148:149], v[148:149], v[212:213] neg_lo:[0,1] neg_hi:[0,1]
  v_pk_add_f32 v[150:151], v[150:151], v[212:213] neg_lo:[0,1] neg_hi:[0,1]
  v_pk_add_f32 v[152:153], v[152:153], v[212:213] neg_lo:[0,1] neg_hi:[0,1]
  v_pk_add_f32 v[154:155], v[154:155], v[212:213] neg_lo:[0,1] neg_hi:[0,1]
  v_pk_add_f32 v[156:157], v[156:157], v[212:213] neg_lo:[0,1] neg_hi:[0,1]
  v_pk_add_f32 v[158:159], v[158:159], v[212:213] neg_lo:[0,1] neg_hi:[0,1]
  v_exp_f32 v88, v88
  v_exp_f32 v89, v89
  v_exp_f32 v90, v90
  v_exp_f32 v91, v91
  v_exp_f32 v92, v92
  v_exp_f32 v93, v93
  v_exp_f32 v94, v94
  v_exp_f32 v95, v95
  v_exp_f32 v96, v96
  v_exp_f32 v97, v97
  v_exp_f32 v98, v98
  v_exp_f32 v99, v99
  v_exp_f32 v100, v100
  v_exp_f32 v101, v101
  v_exp_f32 v102, v102
  v_exp_f32 v103, v103
  v_exp_f32 v104, v104
  v_exp_f32 v105, v105
  v_exp_f32 v106, v106
  v_exp_f32 v107, v107
  v_exp_f32 v108, v108
  v_exp_f32 v109, v109
  v_exp_f32 v110, v110
  v_exp_f32 v111, v111
  v_exp_f32 v112, v112
  v_exp_f32 v113, v113
  v_exp_f32 v114, v114
  v_exp_f32 v115, v115
  v_exp_f32 v116, v116
  v_exp_f32 v117, v117
  v_exp_f32 v118, v118
  v_exp_f32 v119, v119
  v_exp_f32 v120, v120
  v_exp_f32 v121, v121
  v_exp_f32 v122, v122
  v_exp_f32 v123, v123
  v_exp_f32 v124, v124
  v_exp_f32 v125, v125
  v_exp_f32 v126, v126
  v_exp_f32 v127, v127
  v_exp_f32 v128, v128
  v_exp_f32 v129, v129
  v_exp_f32 v130, v130
  v_exp_f32 v131, v131
  v_exp_f32 v132, v132
  v_exp_f32 v133, v133
  v_exp_f32 v134, v134
  v_exp_f32 v135, v135
  v_exp_f32 v136, v136
  v_exp_f32 v137, v137
  v_exp_f32 v138, v138
  v_exp_f32 v139, v139
  v_exp_f32 v140, v140
  v_exp_f32 v141, v141
  v_exp_f32 v142, v142
  v_exp_f32 v143, v143
  v_exp_f32 v144, v144
  v_exp_f32 v145, v145
  v_exp_f32 v146, v146
  v_exp_f32 v147, v147
  v_exp_f32 v148, v148
  v_exp_f32 v149, v149
  v_exp_f32 v150, v150
  v_exp_f32 v151, v151
  v_exp_f32 v152, v152
  v_exp_f32 v153, v153
  v_exp_f32 v154, v154
  v_exp_f32 v155, v155
  v_exp_f32 v156, v156
  v_exp_f32 v157, v157
  v_exp_f32 v158, v158
  v_exp_f32 v159, v159
  v_pk_add_f32 v[214:215], v[88:89], v[90:91]
  v_pk_add_f32 v[216:217], v[92:93], v[94:95]
  v_pk_add_f32 v[214:215], v[214:215], v[96:97]
  v_pk_add_f32 v[216:217], v[216:217], v[98:99]
  v_pk_add_f32 v[214:215], v[214:215], v[100:101]
  v_pk_add_f32 v[216:217], v[216:217], v[102:103]
  v_pk_add_f32 v[214:215], v[214:215], v[104:105]
  v_pk_add_f32 v[216:217], v[216:217], v[106:107]
  v_pk_add_f32 v[214:215], v[214:215], v[108:109]
  v_pk_add_f32 v[216:217], v[216:217], v[110:111]
  v_pk_add_f32 v[214:215], v[214:215], v[112:113]
  v_pk_add_f32 v[216:217], v[216:217], v[114:115]
  v_pk_add_f32 v[214:215], v[214:215], v[116:117]
  v_pk_add_f32 v[216:217], v[216:217], v[118:119]
  v_pk_add_f32 v[214:215], v[214:215], v[120:121]
  v_pk_add_f32 v[216:217], v[216:217], v[122:123]
  v_pk_add_f32 v[214:215], v[214:215], v[124:125]
  v_pk_add_f32 v[216:217], v[216:217], v[126:127]
  v_pk_add_f32 v[214:215], v[214:215], v[128:129]
  v_pk_add_f32 v[216:217], v[216:217], v[130:131]
  v_pk_add_f32 v[214:215], v[214:215], v[132:133]
  v_pk_add_f32 v[216:217], v[216:217], v[134:135]
  v_pk_add_f32 v[214:215], v[214:215], v[136:137]
  v_pk_add_f32 v[216:217], v[216:217], v[138:139]
  v_pk_add_f32 v[214:215], v[214:215], v[140:141]
  v_pk_add_f32 v[216:217], v[216:217], v[142:143]
  v_pk_add_f32 v[214:215], v[214:215], v[144:145]
  v_pk_add_f32 v[216:217], v[216:217], v[146:147]
  v_pk_add_f32 v[214:215], v[214:215], v[148:149]
  v_pk_add_f32 v[216:217], v[216:217], v[150:151]
  v_pk_add_f32 v[214:215], v[214:215], v[152:153]
  v_pk_add_f32 v[216:217], v[216:217], v[154:155]
  v_pk_add_f32 v[214:215], v[214:215], v[156:157]
  v_pk_add_f32 v[216:217], v[216:217], v[158:159]
  v_cvt_pk_bf16_f32 v160, v88, v89
  v_cvt_pk_bf16_f32 v161, v90, v91
  v_cvt_pk_bf16_f32 v162, v92, v93
  v_cvt_pk_bf16_f32 v163, v94, v95
  v_cvt_pk_bf16_f32 v164, v96, v97
  v_cvt_pk_bf16_f32 v165, v98, v99
  v_cvt_pk_bf16_f32 v166, v100, v101
  v_cvt_pk_bf16_f32 v167, v102, v103
  v_cvt_pk_bf16_f32 v168, v104, v105
  v_cvt_pk_bf16_f32 v169, v106, v107
  v_cvt_pk_bf16_f32 v170, v108, v109
  v_cvt_pk_bf16_f32 v171, v110, v111
  v_cvt_pk_bf16_f32 v172, v112, v113
  v_cvt_pk_bf16_f32 v173, v114, v115
  v_cvt_pk_bf16_f32 v174, v116, v117
  v_cvt_pk_bf16_f32 v175, v118, v119
  v_cvt_pk_bf16_f32 v176, v120, v121
  v_cvt_pk_bf16_f32 v177, v122, v123
  v_cvt_pk_bf16_f32 v178, v124, v125
  v_cvt_pk_bf16_f32 v179, v126, v127
  v_cvt_pk_bf16_f32 v180, v128, v129
  v_cvt_pk_bf16_f32 v181, v130, v131
  v_cvt_pk_bf16_f32 v182, v132, v133
  v_cvt_pk_bf16_f32 v183, v134, v135
  v_cvt_pk_bf16_f32 v184, v136, v137
  v_cvt_pk_bf16_f32 v185, v138, v139
  v_cvt_pk_bf16_f32 v186, v140, v141
  v_cvt_pk_bf16_f32 v187, v142, v143
  v_cvt_pk_bf16_f32 v188, v144, v145
  v_cvt_pk_bf16_f32 v189, v146, v147
  v_cvt_pk_bf16_f32 v190, v148, v149
  v_cvt_pk_bf16_f32 v191, v150, v151
  v_cvt_pk_bf16_f32 v192, v152, v153
  v_cvt_pk_bf16_f32 v193, v154, v155
  v_cvt_pk_bf16_f32 v194, v156, v157
  v_cvt_pk_bf16_f32 v195, v158, v159
  v_pk_add_f32 v[214:215], v[214:215], v[216:217]
  v_add_f32 v214, v214, v215
  s_waitcnt vmcnt(0)
  v_mfma_f32_16x16x32_bf16 v[196:199], a[144:147], v[160:163], 0
  v_mfma_f32_16x16x32_bf16 v[200:203], a[148:151], v[160:163], 0
  v_mfma_f32_16x16x32_bf16 v[196:199], a[152:155], v[164:167], v[196:199]
  v_mfma_f32_16x16x32_bf16 v[200:203], a[156:159], v[164:167], v[200:203]
  v_mfma_f32_16x16x32_bf16 v[196:199], a[160:163], v[168:171], v[196:199]
  v_mfma_f32_16x16x32_bf16 v[200:203], a[164:167], v[168:171], v[200:203]
  v_mfma_f32_16x16x32_bf16 v[196:199], a[168:171], v[172:175], v[196:199]
  v_mfma_f32_16x16x32_bf16 v[200:203], a[172:175], v[172:175], v[200:203]
  v_mfma_f32_16x16x32_bf16 v[196:199], a[176:179], v[176:179], v[196:199]
  v_mfma_f32_16x16x32_bf16 v[200:203], a[180:183], v[176:179], v[200:203]
  v_mfma_f32_16x16x32_bf16 v[196:199], a[184:187], v[180:183], v[196:199]
  v_mfma_f32_16x16x32_bf16 v[200:203], a[188:191], v[180:183], v[200:203]
  v_mfma_f32_16x16x32_bf16 v[196:199], a[192:195], v[184:187], v[196:199]
  v_mfma_f32_16x16x32_bf16 v[200:203], a[196:199], v[184:187], v[200:203]
  v_mfma_f32_16x16x32_bf16 v[196:199], a[200:203], v[188:191], v[196:199]
  v_mfma_f32_16x16x32_bf16 v[200:203], a[204:207], v[188:191], v[200:203]
  v_mfma_f32_16x16x32_bf16 v[196:199], a[208:211], v[192:195], v[196:199]
  v_mfma_f32_16x16x32_bf16 v[200:203], a[212:215], v[192:195], v[200:203]
  v_mov_b32 v215, v214
  s_nop 1
  v_permlane16_swap_b32 v214, v215
  v_add_f32 v214, v214, v215
  v_mov_b32 v215, v214
  s_nop 1
  v_permlane32_swap_b32 v214, v215
  v_add_f32 v214, v214, v215
  v_rcp_f32 v214, v214
  s_nop 0
  v_mov_b32 v215, v214
  v_pk_mul_f32 v[196:197], v[196:197], v[214:215]
  v_pk_mul_f32 v[198:199], v[198:199], v[214:215]
  v_pk_mul_f32 v[200:201], v[200:201], v[214:215]
  v_pk_mul_f32 v[202:203], v[202:203], v[214:215]
  v_cvt_pk_bf16_f32 v216, v196, v197
  v_cvt_pk_bf16_f32 v217, v198, v199
  v_cvt_pk_bf16_f32 v218, v200, v201
  v_cvt_pk_bf16_f32 v219, v202, v203
  ds_write_b128 v10, v[216:219] offset:3072
  s_mul_i32 s14, s10, 114688
  s_add_u32 s14, s14, 16056320
  v_add_u32 v9, s14, v3
  s_mul_i32 s14, s40, 28672
  s_mul_i32 s15, s10, 7168
  s_add_u32 s14, s14, s15
  s_add_u32 s14, s14, 81526784
  v_add_u32 v11, s14, v3
  global_load_dwordx4 a[0:3], v9, s[8:9] offset:0
  global_load_dwordx4 a[4:7], v9, s[8:9] offset:1024
  global_load_dwordx4 a[8:11], v9, s[8:9] offset:2048
  global_load_dwordx4 a[12:15], v9, s[8:9] offset:3072
  v_add_u32 v9, 4096, v9
  global_load_dwordx4 a[16:19], v9, s[8:9] offset:0
  global_load_dwordx4 a[20:23], v9, s[8:9] offset:1024
  global_load_dwordx4 a[24:27], v9, s[8:9] offset:2048
  global_load_dwordx4 a[28:31], v9, s[8:9] offset:3072
  v_add_u32 v9, 4096, v9
  global_load_dwordx4 a[32:35], v9, s[8:9] offset:0
  global_load_dwordx4 a[36:39], v9, s[8:9] offset:1024
  global_load_dwordx4 a[40:43], v9, s[8:9] offset:2048
  global_load_dwordx4 a[44:47], v9, s[8:9] offset:3072
  v_add_u32 v9, 4096, v9
  global_load_dwordx4 a[48:51], v9, s[8:9] offset:0
  global_load_dwordx4 a[52:55], v9, s[8:9] offset:1024
  global_load_dwordx4 a[56:59], v9, s[8:9] offset:2048
  global_load_dwordx4 a[60:63], v9, s[8:9] offset:3072
  v_add_u32 v9, 4096, v9
  global_load_dwordx4 a[64:67], v9, s[8:9] offset:0
  global_load_dwordx4 a[68:71], v9, s[8:9] offset:1024
  global_load_dwordx4 a[72:75], v9, s[8:9] offset:2048
  global_load_dwordx4 a[76:79], v9, s[8:9] offset:3072
  v_add_u32 v9, 4096, v9
  global_load_dwordx4 a[80:83], v9, s[8:9] offset:0
  global_load_dwordx4 a[84:87], v9, s[8:9] offset:1024
  global_load_dwordx4 a[88:91], v9, s[8:9] offset:2048
  global_load_dwordx4 a[92:95], v9, s[8:9] offset:3072
  v_add_u32 v9, 4096, v9
  global_load_dwordx4 a[96:99], v9, s[8:9] offset:0
  global_load_dwordx4 a[100:103], v9, s[8:9] offset:1024
  global_load_dwordx4 a[104:107], v9, s[8:9] offset:2048
  global_load_dwordx4 a[108:111], v9, s[8:9] offset:3072
  v_add_u32 v9, 4096, v9
  global_load_dwordx4 a[112:115], v9, s[8:9] offset:0
  global_load_dwordx4 a[116:119], v9, s[8:9] offset:1024
  global_load_dwordx4 a[120:123], v9, s[8:9] offset:2048
  global_load_dwordx4 a[124:127], v9, s[8:9] offset:3072
  v_add_u32 v9, 4096, v9
  s_waitcnt lgkmcnt(0)
  s_barrier
  ds_read_b128 v[16:19], v3 offset:0
  ds_read_b128 v[20:23], v3 offset:1024
  ds_read_b128 v[24:27], v3 offset:2048
  ds_read_b128 v[28:31], v3 offset:3072
  ds_read_b128 v[32:35], v3 offset:4096
  ds_read_b128 v[36:39], v3 offset:5120
  ds_read_b128 v[40:43], v3 offset:6144
  ds_read_b128 v[44:47], v3 offset:7168
  ds_read_b128 v[48:51], v3 offset:8192
  ds_read_b128 v[52:55], v3 offset:9216
  ds_read_b128 v[56:59], v3 offset:10240
  ds_read_b128 v[60:63], v3 offset:11264
  ds_read_b128 v[64:67], v3 offset:12288
  ds_read_b128 v[68:71], v3 offset:13312
  ds_read_b128 v[72:75], v3 offset:14336
  ds_read_b128 v[76:79], v3 offset:15360
  global_load_dwordx4 a[128:131], v9, s[8:9] offset:0
  global_load_dwordx4 a[132:135], v9, s[8:9] offset:1024
  global_load_dwordx4 a[136:139], v9, s[8:9] offset:2048
  global_load_dwordx4 a[140:143], v9, s[8:9] offset:3072
  v_add_u32 v9, 4096, v9
  global_load_dwordx4 a[144:147], v9, s[8:9] offset:0
  global_load_dwordx4 a[148:151], v9, s[8:9] offset:1024
  global_load_dwordx4 a[152:155], v9, s[8:9] offset:2048
  global_load_dwordx4 a[156:159], v9, s[8:9] offset:3072
  v_add_u32 v9, 4096, v9
  global_load_dwordx4 a[160:163], v9, s[8:9] offset:0
  global_load_dwordx4 a[164:167], v9, s[8:9] offset:1024
  global_load_dwordx4 a[168:171], v9, s[8:9] offset:2048
  global_load_dwordx4 a[172:175], v9, s[8:9] offset:3072
  v_add_u32 v9, 4096, v9
  global_load_dwordx4 a[176:179], v9, s[8:9] offset:0
  global_load_dwordx4 a[180:183], v9, s[8:9] offset:1024
  global_load_dwordx4 a[184:187], v9, s[8:9] offset:2048
  global_load_dwordx4 a[188:191], v9, s[8:9] offset:3072
  v_add_u32 v9, 4096, v9
  s_waitcnt vmcnt(32) lgkmcnt(0)
  v_mfma_f32_16x16x32_bf16 v[88:91], a[0:3], v[16:19], 0
  v_mfma_f32_16x16x32_bf16 v[92:95], a[4:7], v[20:23], 0
  v_mfma_f32_16x16x32_bf16 v[88:91], a[8:11], v[24:27], v[88:91]
  v_mfma_f32_16x16x32_bf16 v[92:95], a[12:15], v[28:31], v[92:95]
  v_mfma_f32_16x16x32_bf16 v[88:91], a[16:19], v[32:35], v[88:91]
  v_mfma_f32_16x16x32_bf16 v[92:95], a[20:23], v[36:39], v[92:95]
  v_mfma_f32_16x16x32_bf16 v[88:91], a[24:27], v[40:43], v[88:91]
  v_mfma_f32_16x16x32_bf16 v[92:95], a[28:31], v[44:47], v[92:95]
  v_mfma_f32_16x16x32_bf16 v[88:91], a[32:35], v[48:51], v[88:91]
  v_mfma_f32_16x16x32_bf16 v[92:95], a[36:39], v[52:55], v[92:95]
  v_mfma_f32_16x16x32_bf16 v[88:91], a[40:43], v[56:59], v[88:91]
  v_mfma_f32_16x16x32_bf16 v[92:95], a[44:47], v[60:63], v[92:95]
  v_mfma_f32_16x16x32_bf16 v[88:91], a[48:51], v[64:67], v[88:91]
  v_mfma_f32_16x16x32_bf16 v[92:95], a[52:55], v[68:71], v[92:95]
  v_mfma_f32_16x16x32_bf16 v[88:91], a[56:59], v[72:75], v[88:91]
  v_mfma_f32_16x16x32_bf16 v[92:95], a[60:63], v[76:79], v[92:95]
  s_nop 7
  v_pk_add_f32 v[88:89], v[88:89], v[92:93]
  v_pk_add_f32 v[90:91], v[90:91], v[94:95]
  global_store_dwordx4 v11, v[88:91], s[8:9] sc0 sc1
  s_nop 1
  v_add_u32 v11, 1024, v11
  global_load_dwordx4 a[0:3], v9, s[8:9] offset:0
  global_load_dwordx4 a[4:7], v9, s[8:9] offset:1024
  global_load_dwordx4 a[8:11], v9, s[8:9] offset:2048
  global_load_dwordx4 a[12:15], v9, s[8:9] offset:3072
  v_add_u32 v9, 4096, v9
  global_load_dwordx4 a[16:19], v9, s[8:9] offset:0
  global_load_dwordx4 a[20:23], v9, s[8:9] offset:1024
  global_load_dwordx4 a[24:27], v9, s[8:9] offset:2048
  global_load_dwordx4 a[28:31], v9, s[8:9] offset:3072
  v_add_u32 v9, 4096, v9
  global_load_dwordx4 a[32:35], v9, s[8:9] offset:0
  global_load_dwordx4 a[36:39], v9, s[8:9] offset:1024
  global_load_dwordx4 a[40:43], v9, s[8:9] offset:2048
  global_load_dwordx4 a[44:47], v9, s[8:9] offset:3072
  v_add_u32 v9, 4096, v9
  global_load_dwordx4 a[48:51], v9, s[8:9] offset:0
  global_load_dwordx4 a[52:55], v9, s[8:9] offset:1024
  global_load_dwordx4 a[56:59], v9, s[8:9] offset:2048
  global_load_dwordx4 a[60:63], v9, s[8:9] offset:3072
  v_add_u32 v9, 4096, v9
  s_waitcnt vmcnt(33) lgkmcnt(0)
  v_mfma_f32_16x16x32_bf16 v[96:99], a[64:67], v[16:19], 0
  v_mfma_f32_16x16x32_bf16 v[100:103], a[68:71], v[20:23], 0
  v_mfma_f32_16x16x32_bf16 v[96:99], a[72:75], v[24:27], v[96:99]
  v_mfma_f32_16x16x32_bf16 v[100:103], a[76:79], v[28:31], v[100:103]
  v_mfma_f32_16x16x32_bf16 v[96:99], a[80:83], v[32:35], v[96:99]
  v_mfma_f32_16x16x32_bf16 v[100:103], a[84:87], v[36:39], v[100:103]
  v_mfma_f32_16x16x32_bf16 v[96:99], a[88:91], v[40:43], v[96:99]
  v_mfma_f32_16x16x32_bf16 v[100:103], a[92:95], v[44:47], v[100:103]
  v_mfma_f32_16x16x32_bf16 v[96:99], a[96:99], v[48:51], v[96:99]
  v_mfma_f32_16x16x32_bf16 v[100:103], a[100:103], v[52:55], v[100:103]
  v_mfma_f32_16x16x32_bf16 v[96:99], a[104:107], v[56:59], v[96:99]
  v_mfma_f32_16x16x32_bf16 v[100:103], a[108:111], v[60:63], v[100:103]
  v_mfma_f32_16x16x32_bf16 v[96:99], a[112:115], v[64:67], v[96:99]
  v_mfma_f32_16x16x32_bf16 v[100:103], a[116:119], v[68:71], v[100:103]
  v_mfma_f32_16x16x32_bf16 v[96:99], a[120:123], v[72:75], v[96:99]
  v_mfma_f32_16x16x32_bf16 v[100:103], a[124:127], v[76:79], v[100:103]
  s_nop 7
  v_pk_add_f32 v[96:97], v[96:97], v[100:101]
  v_pk_add_f32 v[98:99], v[98:99], v[102:103]
  global_store_dwordx4 v11, v[96:99], s[8:9] sc0 sc1
  s_nop 1
  v_add_u32 v11, 1024, v11
  global_load_dwordx4 a[64:67], v9, s[8:9] offset:0
  global_load_dwordx4 a[68:71], v9, s[8:9] offset:1024
  global_load_dwordx4 a[72:75], v9, s[8:9] offset:2048
  global_load_dwordx4 a[76:79], v9, s[8:9] offset:3072
  v_add_u32 v9, 4096, v9
  global_load_dwordx4 a[80:83], v9, s[8:9] offset:0
  global_load_dwordx4 a[84:87], v9, s[8:9] offset:1024
  global_load_dwordx4 a[88:91], v9, s[8:9] offset:2048
  global_load_dwordx4 a[92:95], v9, s[8:9] offset:3072
  v_add_u32 v9, 4096, v9
  global_load_dwordx4 a[96:99], v9, s[8:9] offset:0
  global_load_dwordx4 a[100:103], v9, s[8:9] offset:1024
  global_load_dwordx4 a[104:107], v9, s[8:9] offset:2048
  global_load_dwordx4 a[108:111], v9, s[8:9] offset:3072
  v_add_u32 v9, 4096, v9
  global_load_dwordx4 a[112:115], v9, s[8:9] offset:0
  global_load_dwordx4 a[116:119], v9, s[8:9] offset:1024
  global_load_dwordx4 a[120:123], v9, s[8:9] offset:2048
  global_load_dwordx4 a[124:127], v9, s[8:9] offset:3072
  v_add_u32 v9, 4096, v9
  s_waitcnt vmcnt(33) lgkmcnt(0)
  v_mfma_f32_16x16x32_bf16 v[88:91], a[128:131], v[16:19], 0
  v_mfma_f32_16x16x32_bf16 v[92:95], a[132:135], v[20:23], 0
  v_mfma_f32_16x16x32_bf16 v[88:91], a[136:139], v[24:27], v[88:91]
  v_mfma_f32_16x16x32_bf16 v[92:95], a[140:143], v[28:31], v[92:95]
  v_mfma_f32_16x16x32_bf16 v[88:91], a[144:147], v[32:35], v[88:91]
  v_mfma_f32_16x16x32_bf16 v[92:95], a[148:151], v[36:39], v[92:95]
  v_mfma_f32_16x16x32_bf16 v[88:91], a[152:155], v[40:43], v[88:91]
  v_mfma_f32_16x16x32_bf16 v[92:95], a[156:159], v[44:47], v[92:95]
  v_mfma_f32_16x16x32_bf16 v[88:91], a[160:163], v[48:51], v[88:91]
  v_mfma_f32_16x16x32_bf16 v[92:95], a[164:167], v[52:55], v[92:95]
  v_mfma_f32_16x16x32_bf16 v[88:91], a[168:171], v[56:59], v[88:91]
  v_mfma_f32_16x16x32_bf16 v[92:95], a[172:175], v[60:63], v[92:95]
  v_mfma_f32_16x16x32_bf16 v[88:91], a[176:179], v[64:67], v[88:91]
  v_mfma_f32_16x16x32_bf16 v[92:95], a[180:183], v[68:71], v[92:95]
  v_mfma_f32_16x16x32_bf16 v[88:91], a[184:187], v[72:75], v[88:91]
  v_mfma_f32_16x16x32_bf16 v[92:95], a[188:191], v[76:79], v[92:95]
  s_nop 7
  v_pk_add_f32 v[88:89], v[88:89], v[92:93]
  v_pk_add_f32 v[90:91], v[90:91], v[94:95]
  global_store_dwordx4 v11, v[88:91], s[8:9] sc0 sc1
  s_nop 1
  v_add_u32 v11, 1024, v11
  global_load_dwordx4 a[128:131], v9, s[8:9] offset:0
  global_load_dwordx4 a[132:135], v9, s[8:9] offset:1024
  global_load_dwordx4 a[136:139], v9, s[8:9] offset:2048
  global_load_dwordx4 a[140:143], v9, s[8:9] offset:3072
  v_add_u32 v9, 4096, v9
  global_load_dwordx4 a[144:147], v9, s[8:9] offset:0
  global_load_dwordx4 a[148:151], v9, s[8:9] offset:1024
  global_load_dwordx4 a[152:155], v9, s[8:9] offset:2048
  global_load_dwordx4 a[156:159], v9, s[8:9] offset:3072
  v_add_u32 v9, 4096, v9
  global_load_dwordx4 a[160:163], v9, s[8:9] offset:0
  global_load_dwordx4 a[164:167], v9, s[8:9] offset:1024
  global_load_dwordx4 a[168:171], v9, s[8:9] offset:2048
  global_load_dwordx4 a[172:175], v9, s[8:9] offset:3072
  v_add_u32 v9, 4096, v9
  global_load_dwordx4 a[176:179], v9, s[8:9] offset:0
  global_load_dwordx4 a[180:183], v9, s[8:9] offset:1024
  global_load_dwordx4 a[184:187], v9, s[8:9] offset:2048
  global_load_dwordx4 a[188:191], v9, s[8:9] offset:3072
  v_add_u32 v9, 4096, v9
  s_waitcnt vmcnt(33) lgkmcnt(0)
  v_mfma_f32_16x16x32_bf16 v[96:99], a[0:3], v[16:19], 0
  v_mfma_f32_16x16x32_bf16 v[100:103], a[4:7], v[20:23], 0
  v_mfma_f32_16x16x32_bf16 v[96:99], a[8:11], v[24:27], v[96:99]
  v_mfma_f32_16x16x32_bf16 v[100:103], a[12:15], v[28:31], v[100:103]
  v_mfma_f32_16x16x32_bf16 v[96:99], a[16:19], v[32:35], v[96:99]
  v_mfma_f32_16x16x32_bf16 v[100:103], a[20:23], v[36:39], v[100:103]
  v_mfma_f32_16x16x32_bf16 v[96:99], a[24:27], v[40:43], v[96:99]
  v_mfma_f32_16x16x32_bf16 v[100:103], a[28:31], v[44:47], v[100:103]
  v_mfma_f32_16x16x32_bf16 v[96:99], a[32:35], v[48:51], v[96:99]
  v_mfma_f32_16x16x32_bf16 v[100:103], a[36:39], v[52:55], v[100:103]
  v_mfma_f32_16x16x32_bf16 v[96:99], a[40:43], v[56:59], v[96:99]
  v_mfma_f32_16x16x32_bf16 v[100:103], a[44:47], v[60:63], v[100:103]
  v_mfma_f32_16x16x32_bf16 v[96:99], a[48:51], v[64:67], v[96:99]
  v_mfma_f32_16x16x32_bf16 v[100:103], a[52:55], v[68:71], v[100:103]
  v_mfma_f32_16x16x32_bf16 v[96:99], a[56:59], v[72:75], v[96:99]
  v_mfma_f32_16x16x32_bf16 v[100:103], a[60:63], v[76:79], v[100:103]
  s_nop 7
  v_pk_add_f32 v[96:97], v[96:97], v[100:101]
  v_pk_add_f32 v[98:99], v[98:99], v[102:103]
  global_store_dwordx4 v11, v[96:99], s[8:9] sc0 sc1
  s_nop 1
  v_add_u32 v11, 1024, v11
  global_load_dwordx4 a[0:3], v9, s[8:9] offset:0
  global_load_dwordx4 a[4:7], v9, s[8:9] offset:1024
  global_load_dwordx4 a[8:11], v9, s[8:9] offset:2048
  global_load_dwordx4 a[12:15], v9, s[8:9] offset:3072
  v_add_u32 v9, 4096, v9
  global_load_dwordx4 a[16:19], v9, s[8:9] offset:0
  global_load_dwordx4 a[20:23], v9, s[8:9] offset:1024
  global_load_dwordx4 a[24:27], v9, s[8:9] offset:2048
  global_load_dwordx4 a[28:31], v9, s[8:9] offset:3072
  v_add_u32 v9, 4096, v9
  global_load_dwordx4 a[32:35], v9, s[8:9] offset:0
  global_load_dwordx4 a[36:39], v9, s[8:9] offset:1024
  global_load_dwordx4 a[40:43], v9, s[8:9] offset:2048
  global_load_dwordx4 a[44:47], v9, s[8:9] offset:3072
  v_add_u32 v9, 4096, v9
  global_load_dwordx4 a[48:51], v9, s[8:9] offset:0
  global_load_dwordx4 a[52:55], v9, s[8:9] offset:1024
  global_load_dwordx4 a[56:59], v9, s[8:9] offset:2048
  global_load_dwordx4 a[60:63], v9, s[8:9] offset:3072
  v_add_u32 v9, 4096, v9
  s_waitcnt vmcnt(33) lgkmcnt(0)
  v_mfma_f32_16x16x32_bf16 v[88:91], a[64:67], v[16:19], 0
  v_mfma_f32_16x16x32_bf16 v[92:95], a[68:71], v[20:23], 0
  v_mfma_f32_16x16x32_bf16 v[88:91], a[72:75], v[24:27], v[88:91]
  v_mfma_f32_16x16x32_bf16 v[92:95], a[76:79], v[28:31], v[92:95]
  v_mfma_f32_16x16x32_bf16 v[88:91], a[80:83], v[32:35], v[88:91]
  v_mfma_f32_16x16x32_bf16 v[92:95], a[84:87], v[36:39], v[92:95]
  v_mfma_f32_16x16x32_bf16 v[88:91], a[88:91], v[40:43], v[88:91]
  v_mfma_f32_16x16x32_bf16 v[92:95], a[92:95], v[44:47], v[92:95]
  v_mfma_f32_16x16x32_bf16 v[88:91], a[96:99], v[48:51], v[88:91]
  v_mfma_f32_16x16x32_bf16 v[92:95], a[100:103], v[52:55], v[92:95]
  v_mfma_f32_16x16x32_bf16 v[88:91], a[104:107], v[56:59], v[88:91]
  v_mfma_f32_16x16x32_bf16 v[92:95], a[108:111], v[60:63], v[92:95]
  v_mfma_f32_16x16x32_bf16 v[88:91], a[112:115], v[64:67], v[88:91]
  v_mfma_f32_16x16x32_bf16 v[92:95], a[116:119], v[68:71], v[92:95]
  v_mfma_f32_16x16x32_bf16 v[88:91], a[120:123], v[72:75], v[88:91]
  v_mfma_f32_16x16x32_bf16 v[92:95], a[124:127], v[76:79], v[92:95]
  s_nop 7
  v_pk_add_f32 v[88:89], v[88:89], v[92:93]
  v_pk_add_f32 v[90:91], v[90:91], v[94:95]
  global_store_dwordx4 v11, v[88:91], s[8:9] sc0 sc1
  s_nop 1
  v_add_u32 v11, 1024, v11
  s_waitcnt vmcnt(17) lgkmcnt(0)
  v_mfma_f32_16x16x32_bf16 v[96:99], a[128:131], v[16:19], 0
  v_mfma_f32_16x16x32_bf16 v[100:103], a[132:135], v[20:23], 0
  v_mfma_f32_16x16x32_bf16 v[96:99], a[136:139], v[24:27], v[96:99]
  v_mfma_f32_16x16x32_bf16 v[100:103], a[140:143], v[28:31], v[100:103]
  v_mfma_f32_16x16x32_bf16 v[96:99], a[144:147], v[32:35], v[96:99]
  v_mfma_f32_16x16x32_bf16 v[100:103], a[148:151], v[36:39], v[100:103]
  v_mfma_f32_16x16x32_bf16 v[96:99], a[152:155], v[40:43], v[96:99]
  v_mfma_f32_16x16x32_bf16 v[100:103], a[156:159], v[44:47], v[100:103]
  v_mfma_f32_16x16x32_bf16 v[96:99], a[160:163], v[48:51], v[96:99]
  v_mfma_f32_16x16x32_bf16 v[100:103], a[164:167], v[52:55], v[100:103]
  v_mfma_f32_16x16x32_bf16 v[96:99], a[168:171], v[56:59], v[96:99]
  v_mfma_f32_16x16x32_bf16 v[100:103], a[172:175], v[60:63], v[100:103]
  v_mfma_f32_16x16x32_bf16 v[96:99], a[176:179], v[64:67], v[96:99]
  v_mfma_f32_16x16x32_bf16 v[100:103], a[180:183], v[68:71], v[100:103]
  v_mfma_f32_16x16x32_bf16 v[96:99], a[184:187], v[72:75], v[96:99]
  v_mfma_f32_16x16x32_bf16 v[100:103], a[188:191], v[76:79], v[100:103]
  s_nop 7
  v_pk_add_f32 v[96:97], v[96:97], v[100:101]
  v_pk_add_f32 v[98:99], v[98:99], v[102:103]
  global_store_dwordx4 v11, v[96:99], s[8:9] sc0 sc1
  s_nop 1
  v_add_u32 v11, 1024, v11
  s_waitcnt vmcnt(2) lgkmcnt(0)
  v_mfma_f32_16x16x32_bf16 v[88:91], a[0:3], v[16:19], 0
  v_mfma_f32_16x16x32_bf16 v[92:95], a[4:7], v[20:23], 0
  v_mfma_f32_16x16x32_bf16 v[88:91], a[8:11], v[24:27], v[88:91]
  v_mfma_f32_16x16x32_bf16 v[92:95], a[12:15], v[28:31], v[92:95]
  v_mfma_f32_16x16x32_bf16 v[88:91], a[16:19], v[32:35], v[88:91]
  v_mfma_f32_16x16x32_bf16 v[92:95], a[20:23], v[36:39], v[92:95]
  v_mfma_f32_16x16x32_bf16 v[88:91], a[24:27], v[40:43], v[88:91]
  v_mfma_f32_16x16x32_bf16 v[92:95], a[28:31], v[44:47], v[92:95]
  v_mfma_f32_16x16x32_bf16 v[88:91], a[32:35], v[48:51], v[88:91]
  v_mfma_f32_16x16x32_bf16 v[92:95], a[36:39], v[52:55], v[92:95]
  v_mfma_f32_16x16x32_bf16 v[88:91], a[40:43], v[56:59], v[88:91]
  v_mfma_f32_16x16x32_bf16 v[92:95], a[44:47], v[60:63], v[92:95]
  v_mfma_f32_16x16x32_bf16 v[88:91], a[48:51], v[64:67], v[88:91]
  v_mfma_f32_16x16x32_bf16 v[92:95], a[52:55], v[68:71], v[92:95]
  v_mfma_f32_16x16x32_bf16 v[88:91], a[56:59], v[72:75], v[88:91]
  v_mfma_f32_16x16x32_bf16 v[92:95], a[60:63], v[76:79], v[92:95]
  s_nop 7
  v_pk_add_f32 v[88:89], v[88:89], v[92:93]
  v_pk_add_f32 v[90:91], v[90:91], v[94:95]
  global_store_dwordx4 v11, v[88:91], s[8:9] sc0 sc1
  s_nop 1
  v_add_u32 v11, 1024, v11
  s_waitcnt vmcnt(0)
  s_lshl_b32 s14, s40, 4
  s_lshl_b32 s15, s10, 2
  s_add_u32 s14, s14, s15
  s_add_u32 s14, s14, 103346176
  v_mov_b32 v9, s14
  v_mov_b32 v10, 4
  global_store_dword v9, v10, s[8:9] sc0 sc1
  s_barrier
  s_nop 1
  s_branch WLOOP_71
WT4_77:
  s_sub_u32 s40, s40, 128
  s_cmp_ge_u32 s40, 512
  s_nop 1
  s_cbranch_scc1 CEXIT_1
  v_lshlrev_b32 v3, 4, v2
  v_and_b32 v4, 15, v2
  v_lshrrev_b32 v5, 4, v2
  s_lshr_b32 s41, s40, 2
  s_and_b32 s42, s40, 3
  s_lshr_b32 s12, s40, 3
  s_lshr_b32 s13, s40, 4
  s_lshl_b32 s13, s13, 8
  s_add_u32 s13, s13, 103337984
  v_lshl_add_u32 v9, v2, 2, s13
  s_lshl_b32 s14, s40, 2
  s_add_u32 s14, s14, 103346176
  v_mov_b32 v10, s14
  v_cmp_gt_u32 vcc, 56, v2
  s_nop 1
  v_cndmask_b32 v9, v10, v9, vcc
  s_mul_i32 s13, s12, 28672
  v_mul_u32_u24 v7, 896, v4
  v_lshl_add_u32 v7, v5, 3, v7
  v_add_u32 v7, s13, v7
  v_add_u32 v8, 14336, v7
  global_load_dwordx2 v[120:121], v7, s[4:5] offset:0
  global_load_dwordx2 v[122:123], v7, s[4:5] offset:32
  global_load_dwordx2 v[124:125], v7, s[4:5] offset:64
  global_load_dwordx2 v[126:127], v7, s[4:5] offset:96
  global_load_dwordx2 v[128:129], v7, s[4:5] offset:128
  global_load_dwordx2 v[130:131], v7, s[4:5] offset:160
  global_load_dwordx2 v[132:133], v7, s[4:5] offset:192
  global_load_dwordx2 v[134:135], v7, s[4:5] offset:224
  global_load_dwordx2 v[136:137], v7, s[4:5] offset:256
  global_load_dwordx2 v[138:139], v7, s[4:5] offset:288
  global_load_dwordx2 v[140:141], v7, s[4:5] offset:320
  global_load_dwordx2 v[142:143], v7, s[4:5] offset:352
  global_load_dwordx2 v[144:145], v7, s[4:5] offset:384
  global_load_dwordx2 v[146:147], v7, s[4:5] offset:416
  global_load_dwordx2 v[148:149], v7, s[4:5] offset:448
  global_load_dwordx2 v[150:151], v7, s[4:5] offset:480
  global_load_dwordx2 v[152:153], v7, s[4:5] offset:512
  global_load_dwordx2 v[154:155], v7, s[4:5] offset:544
  global_load_dwordx2 v[156:157], v7, s[4:5] offset:576
  global_load_dwordx2 v[158:159], v7, s[4:5] offset:608
  global_load_dwordx2 v[160:161], v7, s[4:5] offset:640
  global_load_dwordx2 v[162:163], v7, s[4:5] offset:672
  global_load_dwordx2 v[164:165], v7, s[4:5] offset:704
  global_load_dwordx2 v[166:167], v7, s[4:5] offset:736
  global_load_dwordx2 v[168:169], v7, s[4:5] offset:768
  global_load_dwordx2 v[170:171], v7, s[4:5] offset:800
  global_load_dwordx2 v[172:173], v7, s[4:5] offset:832
  global_load_dwordx2 v[174:175], v7, s[4:5] offset:864
  global_load_dwordx2 v[176:177], v8, s[4:5] offset:0
  global_load_dwordx2 v[178:179], v8, s[4:5] offset:32
  global_load_dwordx2 v[180:181], v8, s[4:5] offset:64
  global_load_dwordx2 v[182:183], v8, s[4:5] offset:96
  global_load_dwordx2 v[184:185], v8, s[4:5] offset:128
  global_load_dwordx2 v[186:187], v8, s[4:5] offset:160
  global_load_dwordx2 v[188:189], v8, s[4:5] offset:192
  global_load_dwordx2 v[190:191], v8, s[4:5] offset:224
  global_load_dwordx2 v[192:193], v8, s[4:5] offset:256
  global_load_dwordx2 v[194:195], v8, s[4:5] offset:288
  global_load_dwordx2 v[196:197], v8, s[4:5] offset:320
  global_load_dwordx2 v[198:199], v8, s[4:5] offset:352
  global_load_dwordx2 v[200:201], v8, s[4:5] offset:384
  global_load_dwordx2 v[202:203], v8, s[4:5] offset:416
  global_load_dwordx2 v[204:205], v8, s[4:5] offset:448
  global_load_dwordx2 v[206:207], v8, s[4:5] offset:480
  global_load_dwordx2 v[208:209], v8, s[4:5] offset:512
  global_load_dwordx2 v[210:211], v8, s[4:5] offset:544
  global_load_dwordx2 v[212:213], v8, s[4:5] offset:576
  global_load_dwordx2 v[214:215], v8, s[4:5] offset:608
  global_load_dwordx2 v[216:217], v8, s[4:5] offset:640
  global_load_dwordx2 v[218:219], v8, s[4:5] offset:672
  global_load_dwordx2 v[220:221], v8, s[4:5] offset:704
  global_load_dwordx2 v[222:223], v8, s[4:5] offset:736
  global_load_dwordx2 v[224:225], v8, s[4:5] offset:768
  global_load_dwordx2 v[226:227], v8, s[4:5] offset:800
  global_load_dwordx2 v[228:229], v8, s[4:5] offset:832
  global_load_dwordx2 v[230:231], v8, s[4:5] offset:864
  s_mov_b32 s14, 4096
  s_nop 1
XW_99:
  global_load_dword v10, v9, s[8:9] sc0 sc1
  s_waitcnt vmcnt(0)
  v_cmp_gt_u32 vcc, 4, v10
  s_nop 4
  s_cbranch_vccz XWD_100
  s_sleep 16
  s_sub_u32 s14, s14, 1
  s_nop 1
  s_cbranch_scc0 XW_99
XWD_100:
  s_mul_i32 s13, s41, 229376
  s_mul_i32 s14, s10, 57344
  s_add_u32 s13, s13, s14
  s_add_u32 s13, s13, 16515072
  v_add_u32 v6, s13, v3
  s_waitcnt vmcnt(0)
  global_load_dwordx4 a[0:3], v6, s[8:9] offset:0
  global_load_dwordx4 a[4:7], v6, s[8:9] offset:1024
  global_load_dwordx4 a[8:11], v6, s[8:9] offset:2048
  global_load_dwordx4 a[12:15], v6, s[8:9] offset:3072
  v_add_u32 v6, 4096, v6
  global_load_dwordx4 a[16:19], v6, s[8:9] offset:0
  global_load_dwordx4 a[20:23], v6, s[8:9] offset:1024
  global_load_dwordx4 a[24:27], v6, s[8:9] offset:2048
  global_load_dwordx4 a[28:31], v6, s[8:9] offset:3072
  v_add_u32 v6, 4096, v6
  global_load_dwordx4 a[32:35], v6, s[8:9] offset:0
  global_load_dwordx4 a[36:39], v6, s[8:9] offset:1024
  global_load_dwordx4 a[40:43], v6, s[8:9] offset:2048
  global_load_dwordx4 a[44:47], v6, s[8:9] offset:3072
  v_add_u32 v6, 4096, v6
  global_load_dwordx4 a[48:51], v6, s[8:9] offset:0
  global_load_dwordx4 a[52:55], v6, s[8:9] offset:1024
  global_load_dwordx4 a[56:59], v6, s[8:9] offset:2048
  global_load_dwordx4 a[60:63], v6, s[8:9] offset:3072
  v_add_u32 v6, 4096, v6
  global_load_dwordx4 a[64:67], v6, s[8:9] offset:0
  global_load_dwordx4 a[68:71], v6, s[8:9] offset:1024
  global_load_dwordx4 a[72:75], v6, s[8:9] offset:2048
  global_load_dwordx4 a[76:79], v6, s[8:9] offset:3072
  v_add_u32 v6, 4096, v6
  global_load_dwordx4 a[80:83], v6, s[8:9] offset:0
  global_load_dwordx4 a[84:87], v6, s[8:9] offset:1024
  global_load_dwordx4 a[88:91], v6, s[8:9] offset:2048
  global_load_dwordx4 a[92:95], v6, s[8:9] offset:3072
  v_add_u32 v6, 4096, v6
  global_load_dwordx4 a[96:99], v6, s[8:9] offset:0
  global_load_dwordx4 a[100:103], v6, s[8:9] offset:1024
  global_load_dwordx4 a[104:107], v6, s[8:9] offset:2048
  global_load_dwordx4 a[108:111], v6, s[8:9] offset:3072
  v_add_u32 v6, 4096, v6
  global_load_dwordx4 a[112:115], v6, s[8:9] offset:0
  global_load_dwordx4 a[116:119], v6, s[8:9] offset:1024
  global_load_dwordx4 a[120:123], v6, s[8:9] offset:2048
  global_load_dwordx4 a[124:127], v6, s[8:9] offset:3072
  v_add_u32 v6, 4096, v6
  global_load_dwordx4 a[128:131], v6, s[8:9] offset:0
  global_load_dwordx4 a[132:135], v6, s[8:9] offset:1024
  global_load_dwordx4 a[136:139], v6, s[8:9] offset:2048
  global_load_dwordx4 a[140:143], v6, s[8:9] offset:3072
  v_add_u32 v6, 4096, v6
  global_load_dwordx4 a[144:147], v6, s[8:9] offset:0
  global_load_dwordx4 a[148:151], v6, s[8:9] offset:1024
  global_load_dwordx4 a[152:155], v6, s[8:9] offset:2048
  global_load_dwordx4 a[156:159], v6, s[8:9] offset:3072
  v_add_u32 v6, 4096, v6
  global_load_dwordx4 a[160:163], v6, s[8:9] offset:0
  global_load_dwordx4 a[164:167], v6, s[8:9] offset:1024
  global_load_dwordx4 a[168:171], v6, s[8:9] offset:2048
  global_load_dwordx4 a[172:175], v6, s[8:9] offset:3072
  v_add_u32 v6, 4096, v6
  global_load_dwordx4 a[176:179], v6, s[8:9] offset:0
  global_load_dwordx4 a[180:183], v6, s[8:9] offset:1024
  global_load_dwordx4 a[184:187], v6, s[8:9] offset:2048
  global_load_dwordx4 a[188:191], v6, s[8:9] offset:3072
  v_add_u32 v6, 4096, v6
  global_load_dwordx4 a[192:195], v6, s[8:9] offset:0
  global_load_dwordx4 a[196:199], v6, s[8:9] offset:1024
  global_load_dwordx4 a[200:203], v6, s[8:9] offset:2048
  global_load_dwordx4 a[204:207], v6, s[8:9] offset:3072
  v_add_u32 v6, 4096, v6
  global_load_dwordx4 a[208:211], v6, s[8:9] offset:0
  global_load_dwordx4 a[212:215], v6, s[8:9] offset:1024
  global_load_dwordx4 a[216:219], v6, s[8:9] offset:2048
  global_load_dwordx4 a[220:223], v6, s[8:9] offset:3072
  v_add_u32 v6, 4096, v6
  s_and_b32 s13, s41, 1
  s_lshl_b32 s13, s13, 4
  v_add_u32 v10, s13, v4
  v_lshlrev_b32 v11, 2, v5
  v_sub_u32 v10, v10, v11
  v_mov_b32 v14, 0xf149f2ca
  v_cmp_gt_u32 vcc, 2, v5
  s_nop 1
  v_cndmask_b32 v12, 0, 1.0, vcc
  v_cmp_le_i32 vcc, 0, v10
  s_nop 1
  v_cndmask_b32 v232, v14, 0, vcc
  v_cmp_le_i32 vcc, 1, v10
  s_nop 1
  v_cndmask_b32 v233, v14, 0, vcc
  v_cmp_le_i32 vcc, 2, v10
  s_nop 1
  v_cndmask_b32 v234, v14, 0, vcc
  v_cmp_le_i32 vcc, 3, v10
  s_nop 1
  v_cndmask_b32 v235, v14, 0, vcc
  v_cmp_le_i32 vcc, 16, v10
  s_nop 1
  v_cndmask_b32 v236, v14, 0, vcc
  v_cmp_le_i32 vcc, 17, v10
  s_nop 1
  v_cndmask_b32 v237, v14, 0, vcc
  v_cmp_le_i32 vcc, 18, v10
  s_nop 1
  v_cndmask_b32 v238, v14, 0, vcc
  v_cmp_le_i32 vcc, 19, v10
  s_nop 1
  v_cndmask_b32 v239, v14, 0, vcc
  s_waitcnt vmcnt(28)
  v_mfma_f32_16x16x32_bf16 v[20:23], v[120:123], a[0:3], v[232:235]
  v_mfma_f32_16x16x32_bf16 v[24:27], v[176:179], a[0:3], v[236:239]
  v_mfma_f32_16x16x32_bf16 v[32:35], v[120:123], a[56:59], v[232:235]
  v_mfma_f32_16x16x32_bf16 v[36:39], v[176:179], a[56:59], v[236:239]
  v_mfma_f32_16x16x32_bf16 v[20:23], v[124:127], a[4:7], v[20:23]
  v_mfma_f32_16x16x32_bf16 v[24:27], v[180:183], a[4:7], v[24:27]
  v_mfma_f32_16x16x32_bf16 v[32:35], v[124:127], a[60:63], v[32:35]
  v_mfma_f32_16x16x32_bf16 v[36:39], v[180:183], a[60:63], v[36:39]
  v_mfma_f32_16x16x32_bf16 v[20:23], v[128:131], a[8:11], v[20:23]
  v_mfma_f32_16x16x32_bf16 v[24:27], v[184:187], a[8:11], v[24:27]
  v_mfma_f32_16x16x32_bf16 v[32:35], v[128:131], a[64:67], v[32:35]
  v_mfma_f32_16x16x32_bf16 v[36:39], v[184:187], a[64:67], v[36:39]
  v_mfma_f32_16x16x32_bf16 v[20:23], v[132:135], a[12:15], v[20:23]
  v_mfma_f32_16x16x32_bf16 v[24:27], v[188:191], a[12:15], v[24:27]
  v_mfma_f32_16x16x32_bf16 v[32:35], v[132:135], a[68:71], v[32:35]
  v_mfma_f32_16x16x32_bf16 v[36:39], v[188:191], a[68:71], v[36:39]
  v_mfma_f32_16x16x32_bf16 v[20:23], v[136:139], a[16:19], v[20:23]
  v_mfma_f32_16x16x32_bf16 v[24:27], v[192:195], a[16:19], v[24:27]
  v_mfma_f32_16x16x32_bf16 v[32:35], v[136:139], a[72:75], v[32:35]
  v_mfma_f32_16x16x32_bf16 v[36:39], v[192:195], a[72:75], v[36:39]
  v_mfma_f32_16x16x32_bf16 v[20:23], v[140:143], a[20:23], v[20:23]
  v_mfma_f32_16x16x32_bf16 v[24:27], v[196:199], a[20:23], v[24:27]
  v_mfma_f32_16x16x32_bf16 v[32:35], v[140:143], a[76:79], v[32:35]
  v_mfma_f32_16x16x32_bf16 v[36:39], v[196:199], a[76:79], v[36:39]
  v_mfma_f32_16x16x32_bf16 v[20:23], v[144:147], a[24:27], v[20:23]
  v_mfma_f32_16x16x32_bf16 v[24:27], v[200:203], a[24:27], v[24:27]
  v_mfma_f32_16x16x32_bf16 v[32:35], v[144:147], a[80:83], v[32:35]
  v_mfma_f32_16x16x32_bf16 v[36:39], v[200:203], a[80:83], v[36:39]
  v_mfma_f32_16x16x32_bf16 v[20:23], v[148:151], a[28:31], v[20:23]
  v_mfma_f32_16x16x32_bf16 v[24:27], v[204:207], a[28:31], v[24:27]
  v_mfma_f32_16x16x32_bf16 v[32:35], v[148:151], a[84:87], v[32:35]
  v_mfma_f32_16x16x32_bf16 v[36:39], v[204:207], a[84:87], v[36:39]
  v_mfma_f32_16x16x32_bf16 v[20:23], v[152:155], a[32:35], v[20:23]
  v_mfma_f32_16x16x32_bf16 v[24:27], v[208:211], a[32:35], v[24:27]
  v_mfma_f32_16x16x32_bf16 v[32:35], v[152:155], a[88:91], v[32:35]
  v_mfma_f32_16x16x32_bf16 v[36:39], v[208:211], a[88:91], v[36:39]
  v_mfma_f32_16x16x32_bf16 v[20:23], v[156:159], a[36:39], v[20:23]
  v_mfma_f32_16x16x32_bf16 v[24:27], v[212:215], a[36:39], v[24:27]
  v_mfma_f32_16x16x32_bf16 v[32:35], v[156:159], a[92:95], v[32:35]
  v_mfma_f32_16x16x32_bf16 v[36:39], v[212:215], a[92:95], v[36:39]
  v_mfma_f32_16x16x32_bf16 v[20:23], v[160:163], a[40:43], v[20:23]
  v_mfma_f32_16x16x32_bf16 v[24:27], v[216:219], a[40:43], v[24:27]
  v_mfma_f32_16x16x32_bf16 v[32:35], v[160:163], a[96:99], v[32:35]
  v_mfma_f32_16x16x32_bf16 v[36:39], v[216:219], a[96:99], v[36:39]
  v_mfma_f32_16x16x32_bf16 v[20:23], v[164:167], a[44:47], v[20:23]
  v_mfma_f32_16x16x32_bf16 v[24:27], v[220:223], a[44:47], v[24:27]
  v_mfma_f32_16x16x32_bf16 v[32:35], v[164:167], a[100:103], v[32:35]
  v_mfma_f32_16x16x32_bf16 v[36:39], v[220:223], a[100:103], v[36:39]
  v_mfma_f32_16x16x32_bf16 v[20:23], v[168:171], a[48:51], v[20:23]
  v_mfma_f32_16x16x32_bf16 v[24:27], v[224:227], a[48:51], v[24:27]
  v_mfma_f32_16x16x32_bf16 v[32:35], v[168:171], a[104:107], v[32:35]
  v_mfma_f32_16x16x32_bf16 v[36:39], v[224:227], a[104:107], v[36:39]
  v_mfma_f32_16x16x32_bf16 v[20:23], v[172:175], a[52:55], v[20:23]
  v_mfma_f32_16x16x32_bf16 v[24:27], v[228:231], a[52:55], v[24:27]
  v_mfma_f32_16x16x32_bf16 v[32:35], v[172:175], a[108:111], v[32:35]
  v_mfma_f32_16x16x32_bf16 v[36:39], v[228:231], a[108:111], v[36:39]
  s_waitcnt vmcnt(0)
  v_mfma_f32_16x16x32_bf16 v[44:47], v[120:123], a[112:115], v[232:235]
  v_mfma_f32_16x16x32_bf16 v[48:51], v[176:179], a[112:115], v[236:239]
  v_mfma_f32_16x16x32_bf16 v[56:59], v[120:123], a[168:171], v[232:235]
  v_mfma_f32_16x16x32_bf16 v[60:63], v[176:179], a[168:171], v[236:239]
  v_mfma_f32_16x16x32_bf16 v[44:47], v[124:127], a[116:119], v[44:47]
  v_mfma_f32_16x16x32_bf16 v[48:51], v[180:183], a[116:119], v[48:51]
  v_mfma_f32_16x16x32_bf16 v[56:59], v[124:127], a[172:175], v[56:59]
  v_mfma_f32_16x16x32_bf16 v[60:63], v[180:183], a[172:175], v[60:63]
  v_mfma_f32_16x16x32_bf16 v[44:47], v[128:131], a[120:123], v[44:47]
  v_mfma_f32_16x16x32_bf16 v[48:51], v[184:187], a[120:123], v[48:51]
  v_mfma_f32_16x16x32_bf16 v[56:59], v[128:131], a[176:179], v[56:59]
  v_mfma_f32_16x16x32_bf16 v[60:63], v[184:187], a[176:179], v[60:63]
  v_mfma_f32_16x16x32_bf16 v[44:47], v[132:135], a[124:127], v[44:47]
  v_mfma_f32_16x16x32_bf16 v[48:51], v[188:191], a[124:127], v[48:51]
  v_mfma_f32_16x16x32_bf16 v[56:59], v[132:135], a[180:183], v[56:59]
  v_mfma_f32_16x16x32_bf16 v[60:63], v[188:191], a[180:183], v[60:63]
  v_mfma_f32_16x16x32_bf16 v[44:47], v[136:139], a[128:131], v[44:47]
  v_mfma_f32_16x16x32_bf16 v[48:51], v[192:195], a[128:131], v[48:51]
  v_mfma_f32_16x16x32_bf16 v[56:59], v[136:139], a[184:187], v[56:59]
  v_mfma_f32_16x16x32_bf16 v[60:63], v[192:195], a[184:187], v[60:63]
  v_mfma_f32_16x16x32_bf16 v[44:47], v[140:143], a[132:135], v[44:47]
  v_mfma_f32_16x16x32_bf16 v[48:51], v[196:199], a[132:135], v[48:51]
  v_mfma_f32_16x16x32_bf16 v[56:59], v[140:143], a[188:191], v[56:59]
  v_mfma_f32_16x16x32_bf16 v[60:63], v[196:199], a[188:191], v[60:63]
  v_mfma_f32_16x16x32_bf16 v[44:47], v[144:147], a[136:139], v[44:47]
  v_mfma_f32_16x16x32_bf16 v[48:51], v[200:203], a[136:139], v[48:51]
  v_mfma_f32_16x16x32_bf16 v[56:59], v[144:147], a[192:195], v[56:59]
  v_mfma_f32_16x16x32_bf16 v[60:63], v[200:203], a[192:195], v[60:63]
  v_mfma_f32_16x16x32_bf16 v[44:47], v[148:151], a[140:143], v[44:47]
  v_mfma_f32_16x16x32_bf16 v[48:51], v[204:207], a[140:143], v[48:51]
  v_mfma_f32_16x16x32_bf16 v[56:59], v[148:151], a[196:199], v[56:59]
  v_mfma_f32_16x16x32_bf16 v[60:63], v[204:207], a[196:199], v[60:63]
  v_mfma_f32_16x16x32_bf16 v[44:47], v[152:155], a[144:147], v[44:47]
  v_mfma_f32_16x16x32_bf16 v[48:51], v[208:211], a[144:147], v[48:51]
  v_mfma_f32_16x16x32_bf16 v[56:59], v[152:155], a[200:203], v[56:59]
  v_mfma_f32_16x16x32_bf16 v[60:63], v[208:211], a[200:203], v[60:63]
  v_mfma_f32_16x16x32_bf16 v[44:47], v[156:159], a[148:151], v[44:47]
  v_mfma_f32_16x16x32_bf16 v[48:51], v[212:215], a[148:151], v[48:51]
  v_mfma_f32_16x16x32_bf16 v[56:59], v[156:159], a[204:207], v[56:59]
  v_mfma_f32_16x16x32_bf16 v[60:63], v[212:215], a[204:207], v[60:63]
  v_mfma_f32_16x16x32_bf16 v[44:47], v[160:163], a[152:155], v[44:47]
  v_mfma_f32_16x16x32_bf16 v[48:51], v[216:219], a[152:155], v[48:51]
  v_mfma_f32_16x16x32_bf16 v[56:59], v[160:163], a[208:211], v[56:59]
  v_mfma_f32_16x16x32_bf16 v[60:63], v[216:219], a[208:211], v[60:63]
  v_mfma_f32_16x16x32_bf16 v[44:47], v[164:167], a[156:159], v[44:47]
  v_mfma_f32_16x16x32_bf16 v[48:51], v[220:223], a[156:159], v[48:51]
  v_mfma_f32_16x16x32_bf16 v[56:59], v[164:167], a[212:215], v[56:59]
  v_mfma_f32_16x16x32_bf16 v[60:63], v[220:223], a[212:215], v[60:63]
  v_mfma_f32_16x16x32_bf16 v[44:47], v[168:171], a[160:163], v[44:47]
  v_mfma_f32_16x16x32_bf16 v[48:51], v[224:227], a[160:163], v[48:51]
  v_mfma_f32_16x16x32_bf16 v[56:59], v[168:171], a[216:219], v[56:59]
  v_mfma_f32_16x16x32_bf16 v[60:63], v[224:227], a[216:219], v[60:63]
  v_mfma_f32_16x16x32_bf16 v[44:47], v[172:175], a[164:167], v[44:47]
  v_mfma_f32_16x16x32_bf16 v[48:51], v[228:231], a[164:167], v[48:51]
  v_mfma_f32_16x16x32_bf16 v[56:59], v[172:175], a[220:223], v[56:59]
  v_mfma_f32_16x16x32_bf16 v[60:63], v[228:231], a[220:223], v[60:63]
  s_mul_i32 s13, s12, 458752
  s_lshl_b32 s14, s10, 13
  s_add_u32 s13, s13, s14
  s_add_u32 s13, s13, 45879296
  v_add_u32 v6, s13, v3
  s_mul_i32 s13, s12, 229376
  s_lshl_b32 s14, s10, 12
  s_add_u32 s13, s13, s14
  s_add_u32 s13, s13, 86319104
  v_add_u32 v7, s13, v3
  s_mul_i32 s16, s42, 7
  s_add_u32 s13, s16, 0
  s_lshr_b32 s14, s13, 1
  s_and_b32 s13, s13, 1
  s_lshl_b32 s13, s13, 10
  s_lshl_b32 s15, s14, 15
  s_add_u32 s15, s15, s13
  v_add_u32 v8, s15, v6
  s_lshl_b32 s15, s14, 14
  s_add_u32 s60, s15, s13
  global_load_dwordx4 v[120:123], v8, s[8:9] offset:-4096
  global_load_dwordx4 v[124:127], v8, s[8:9] offset:-2048
  global_load_dwordx4 v[128:131], v8, s[8:9] offset:0
  global_load_dwordx4 v[132:135], v8, s[8:9] offset:2048
  s_add_u32 s13, s16, 1
  s_lshr_b32 s14, s13, 1
  s_and_b32 s13, s13, 1
  s_lshl_b32 s13, s13, 10
  s_lshl_b32 s15, s14, 15
  s_add_u32 s15, s15, s13
  v_add_u32 v8, s15, v6
  s_lshl_b32 s15, s14, 14
  s_add_u32 s61, s15, s13
  global_load_dwordx4 v[136:139], v8, s[8:9] offset:-4096
  global_load_dwordx4 v[140:143], v8, s[8:9] offset:-2048
  global_load_dwordx4 v[144:147], v8, s[8:9] offset:0
  global_load_dwordx4 v[148:151], v8, s[8:9] offset:2048
  s_add_u32 s13, s16, 2
  s_lshr_b32 s14, s13, 1
  s_and_b32 s13, s13, 1
  s_lshl_b32 s13, s13, 10
  s_lshl_b32 s15, s14, 15
  s_add_u32 s15, s15, s13
  v_add_u32 v8, s15, v6
  s_lshl_b32 s15, s14, 14
  s_add_u32 s62, s15, s13
  global_load_dwordx4 v[152:155], v8, s[8:9] offset:-4096
  global_load_dwordx4 v[156:159], v8, s[8:9] offset:-2048
  global_load_dwordx4 v[160:163], v8, s[8:9] offset:0
  global_load_dwordx4 v[164:167], v8, s[8:9] offset:2048
  s_add_u32 s13, s16, 3
  s_lshr_b32 s14, s13, 1
  s_and_b32 s13, s13, 1
  s_lshl_b32 s13, s13, 10
  s_lshl_b32 s15, s14, 15
  s_add_u32 s15, s15, s13
  v_add_u32 v8, s15, v6
  s_lshl_b32 s15, s14, 14
  s_add_u32 s63, s15, s13
  global_load_dwordx4 v[168:171], v8, s[8:9] offset:-4096
  global_load_dwordx4 v[172:175], v8, s[8:9] offset:-2048
  global_load_dwordx4 v[176:179], v8, s[8:9] offset:0
  global_load_dwordx4 v[180:183], v8, s[8:9] offset:2048
  s_add_u32 s13, s16, 4
  s_lshr_b32 s14, s13, 1
  s_and_b32 s13, s13, 1
  s_lshl_b32 s13, s13, 10
  s_lshl_b32 s15, s14, 15
  s_add_u32 s15, s15, s13
  v_add_u32 v8, s15, v6
  s_lshl_b32 s15, s14, 14
  s_add_u32 s64, s15, s13
  global_load_dwordx4 v[184:187], v8, s[8:9] offset:-4096
  global_load_dwordx4 v[188:191], v8, s[8:9] offset:-2048
  global_load_dwordx4 v[192:195], v8, s[8:9] offset:0
  global_load_dwordx4 v[196:199], v8, s[8:9] offset:2048
  s_add_u32 s13, s16, 5
  s_lshr_b32 s14, s13, 1
  s_and_b32 s13, s13, 1
  s_lshl_b32 s13, s13, 10
  s_lshl_b32 s15, s14, 15
  s_add_u32 s15, s15, s13
  v_add_u32 v8, s15, v6
  s_lshl_b32 s15, s14, 14
  s_add_u32 s65, s15, s13
  global_load_dwordx4 v[200:203], v8, s[8:9] offset:-4096
  global_load_dwordx4 v[204:207], v8, s[8:9] offset:-2048
  global_load_dwordx4 v[208:211], v8, s[8:9] offset:0
  global_load_dwordx4 v[212:215], v8, s[8:9] offset:2048
  s_add_u32 s13, s16, 6
  s_lshr_b32 s14, s13, 1
  s_and_b32 s13, s13, 1
  s_lshl_b32 s13, s13, 10
  s_lshl_b32 s15, s14, 15
  s_add_u32 s15, s15, s13
  v_add_u32 v8, s15, v6
  s_lshl_b32 s15, s14, 14
  s_add_u32 s66, s15, s13
  global_load_dwordx4 v[216:219], v8, s[8:9] offset:-4096
  global_load_dwordx4 v[220:223], v8, s[8:9] offset:-2048
  global_load_dwordx4 v[224:227], v8, s[8:9] offset:0
  global_load_dwordx4 v[228:231], v8, s[8:9] offset:2048
  s_mul_i32 s13, s12, 7168
  s_add_u32 s13, s13, 101010944
  v_and_b32 v9, 7, v2
  v_lshlrev_b32 v9, 4, v9
  v_lshrrev_b32 v10, 1, v5
  v_lshl_add_u32 v9, v10, 7, v9
  v_and_b32 v10, 1, v5
  v_lshl_add_u32 v9, v10, 3, v9
  v_add_u32 v9, s13, v9
  s_mul_i32 s14, s41, 28672
  s_mul_i32 s15, s42, 7168
  s_add_u32 s14, s14, s15
  s_lshl_b32 s15, s10, 10
  s_add_u32 s14, s14, s15
  s_add_u32 s14, s14, 81526784
  v_add_u32 v11, s14, v3
  s_cmp_eq_u32 s10, 3
  s_cselect_b32 s14, 0, 4096
  v_add_u32 v13, s14, v11
  s_lshl_b32 s14, s41, 6
  s_add_u32 s14, s14, 100999168
  v_lshlrev_b32 v10, 2, v4
  v_add_u32 v10, s14, v10
  global_load_dword v14, v10, s[8:9]
  s_cmp_lg_u32 s10, 0
  s_nop 1
  s_cbranch_scc1 XSK_103
  s_max_u32 s13, s12, 1
  s_mul_i32 s13, s13, 7168
  s_add_u32 s13, s13, 101007344
  v_mov_b32 v10, s13
  s_mov_b32 s14, 8192
  s_mov_b64 exec, 1
  s_nop 1
XP_101:
  global_load_dword v15, v10, s[8:9] sc0 sc1
  s_waitcnt vmcnt(0)
  v_cmp_eq_u32 vcc, -1, v15
  s_nop 4
  s_cbranch_vccz XPD_102
  s_sleep 24
  s_sub_u32 s14, s14, 1
  s_nop 1
  s_cbranch_scc0 XP_101
XPD_102:
  s_mov_b64 exec, 0xff
  s_mul_i32 s13, s12, 7168
  s_add_u32 s13, s13, 101008240
  v_and_b32 v10, 7, v2
  v_mul_u32_u24 v10, 896, v10
  v_add_u32 v10, s13, v10
  s_mov_b64 exec, 0xff
  s_nop 1
XP5_110:
  global_load_dword v15, v10, s[8:9] sc0 sc1
  s_waitcnt vmcnt(0)
  v_cmp_eq_u32 vcc, -1, v15
  s_nop 4
  s_cbranch_vccz XD5_111
  s_sleep 4
  s_sub_u32 s14, s14, 1
  s_nop 1
  s_cbranch_scc0 XP5_110
XD5_111:
  s_mov_b64 exec, -1
  s_nop 1
XSK_103:
  s_waitcnt vmcnt(0)
  s_barrier
  s_mov_b32 s14, 4096
  s_waitcnt vmcnt(0)
  s_nop 1
XP3_106:
  global_load_dwordx2 v[64:65], v9, s[8:9] offset:-3584 sc0 sc1
  global_load_dwordx2 v[66:67], v9, s[8:9] offset:-3328 sc0 sc1
  global_load_dwordx2 v[68:69], v9, s[8:9] offset:-3072 sc0 sc1
  global_load_dwordx2 v[70:71], v9, s[8:9] offset:-2816 sc0 sc1
  global_load_dwordx2 v[72:73], v9, s[8:9] offset:-2560 sc0 sc1
  global_load_dwordx2 v[74:75], v9, s[8:9] offset:-2304 sc0 sc1
  global_load_dwordx2 v[76:77], v9, s[8:9] offset:-2048 sc0 sc1
  global_load_dwordx2 v[78:79], v9, s[8:9] offset:-1792 sc0 sc1
  global_load_dwordx2 v[80:81], v9, s[8:9] offset:-1536 sc0 sc1
  global_load_dwordx2 v[82:83], v9, s[8:9] offset:-1280 sc0 sc1
  global_load_dwordx2 v[84:85], v9, s[8:9] offset:-1024 sc0 sc1
  global_load_dwordx2 v[86:87], v9, s[8:9] offset:-768 sc0 sc1
  global_load_dwordx2 v[88:89], v9, s[8:9] offset:-512 sc0 sc1
  global_load_dwordx2 v[90:91], v9, s[8:9] offset:-256 sc0 sc1
  global_load_dwordx2 v[92:93], v9, s[8:9] offset:0 sc0 sc1
  global_load_dwordx2 v[94:95], v9, s[8:9] offset:256 sc0 sc1
  global_load_dwordx2 v[96:97], v9, s[8:9] offset:512 sc0 sc1
  global_load_dwordx2 v[98:99], v9, s[8:9] offset:768 sc0 sc1
  global_load_dwordx2 v[100:101], v9, s[8:9] offset:1024 sc0 sc1
  global_load_dwordx2 v[102:103], v9, s[8:9] offset:1280 sc0 sc1
  global_load_dwordx2 v[104:105], v9, s[8:9] offset:1536 sc0 sc1
  global_load_dwordx2 v[106:107], v9, s[8:9] offset:1792 sc0 sc1
  global_load_dwordx2 v[108:109], v9, s[8:9] offset:2048 sc0 sc1
  global_load_dwordx2 v[110:111], v9, s[8:9] offset:2304 sc0 sc1
  global_load_dwordx2 v[112:113], v9, s[8:9] offset:2560 sc0 sc1
  global_load_dwordx2 v[114:115], v9, s[8:9] offset:2816 sc0 sc1
  global_load_dwordx2 v[116:117], v9, s[8:9] offset:3072 sc0 sc1
  global_load_dwordx2 v[118:119], v9, s[8:9] offset:3328 sc0 sc1
  s_waitcnt vmcnt(14)
  v_max_u32 v8, v64, v65
  v_max_u32 v10, v66, v67
  v_max3_u32 v8, v8, v68, v69
  v_max3_u32 v10, v10, v70, v71
  v_max3_u32 v8, v8, v72, v73
  v_max3_u32 v10, v10, v74, v75
  v_max3_u32 v8, v8, v76, v77
  v_max3_u32 v10, v10, v78, v79
  v_max3_u32 v8, v8, v80, v81
  v_max3_u32 v10, v10, v82, v83
  v_max3_u32 v8, v8, v84, v85
  v_max3_u32 v10, v10, v86, v87
  v_max3_u32 v8, v8, v88, v89
  v_max3_u32 v10, v10, v90, v91
  s_waitcnt vmcnt(0)
  v_max3_u32 v8, v8, v92, v93
  v_max3_u32 v10, v10, v94, v95
  v_max3_u32 v8, v8, v96, v97
  v_max3_u32 v10, v10, v98, v99
  v_max3_u32 v8, v8, v100, v101
  v_max3_u32 v10, v10, v102, v103
  v_max3_u32 v8, v8, v104, v105
  v_max3_u32 v10, v10, v106, v107
  v_max3_u32 v8, v8, v108, v109
  v_max3_u32 v10, v10, v110, v111
  v_max3_u32 v8, v8, v112, v113
  v_max3_u32 v10, v10, v114, v115
  v_max3_u32 v8, v8, v116, v117
  v_max3_u32 v10, v10, v118, v119
  v_max_u32 v8, v8, v10
  v_cmp_eq_u32 vcc, -1, v8
  s_nop 4
  s_cbranch_vccz XD3_107
  s_sleep 8
  s_sub_u32 s14, s14, 1
  s_nop 1
  s_cbranch_scc0 XP3_106
XD3_107:
  v_mfma_f32_16x16x32_bf16 v[16:19], v[64:67], a[0:3], 0
  v_mfma_f32_16x16x32_bf16 v[28:31], v[64:67], a[56:59], 0
  v_mfma_f32_16x16x32_bf16 v[40:43], v[64:67], a[112:115], 0
  v_mfma_f32_16x16x32_bf16 v[52:55], v[64:67], a[168:171], 0
  v_mfma_f32_16x16x32_bf16 v[16:19], v[68:71], a[4:7], v[16:19]
  v_mfma_f32_16x16x32_bf16 v[28:31], v[68:71], a[60:63], v[28:31]
  v_mfma_f32_16x16x32_bf16 v[40:43], v[68:71], a[116:119], v[40:43]
  v_mfma_f32_16x16x32_bf16 v[52:55], v[68:71], a[172:175], v[52:55]
  v_mfma_f32_16x16x32_bf16 v[16:19], v[72:75], a[8:11], v[16:19]
  v_mfma_f32_16x16x32_bf16 v[28:31], v[72:75], a[64:67], v[28:31]
  v_mfma_f32_16x16x32_bf16 v[40:43], v[72:75], a[120:123], v[40:43]
  v_mfma_f32_16x16x32_bf16 v[52:55], v[72:75], a[176:179], v[52:55]
  v_mfma_f32_16x16x32_bf16 v[16:19], v[76:79], a[12:15], v[16:19]
  v_mfma_f32_16x16x32_bf16 v[28:31], v[76:79], a[68:71], v[28:31]
  v_mfma_f32_16x16x32_bf16 v[40:43], v[76:79], a[124:127], v[40:43]
  v_mfma_f32_16x16x32_bf16 v[52:55], v[76:79], a[180:183], v[52:55]
  v_mfma_f32_16x16x32_bf16 v[16:19], v[80:83], a[16:19], v[16:19]
  v_mfma_f32_16x16x32_bf16 v[28:31], v[80:83], a[72:75], v[28:31]
  v_mfma_f32_16x16x32_bf16 v[40:43], v[80:83], a[128:131], v[40:43]
  v_mfma_f32_16x16x32_bf16 v[52:55], v[80:83], a[184:187], v[52:55]
  v_mfma_f32_16x16x32_bf16 v[16:19], v[84:87], a[20:23], v[16:19]
  v_mfma_f32_16x16x32_bf16 v[28:31], v[84:87], a[76:79], v[28:31]
  v_mfma_f32_16x16x32_bf16 v[40:43], v[84:87], a[132:135], v[40:43]
  v_mfma_f32_16x16x32_bf16 v[52:55], v[84:87], a[188:191], v[52:55]
  v_mfma_f32_16x16x32_bf16 v[16:19], v[88:91], a[24:27], v[16:19]
  v_mfma_f32_16x16x32_bf16 v[28:31], v[88:91], a[80:83], v[28:31]
  v_mfma_f32_16x16x32_bf16 v[40:43], v[88:91], a[136:139], v[40:43]
  v_mfma_f32_16x16x32_bf16 v[52:55], v[88:91], a[192:195], v[52:55]
  v_mfma_f32_16x16x32_bf16 v[16:19], v[92:95], a[28:31], v[16:19]
  v_mfma_f32_16x16x32_bf16 v[28:31], v[92:95], a[84:87], v[28:31]
  v_mfma_f32_16x16x32_bf16 v[40:43], v[92:95], a[140:143], v[40:43]
  v_mfma_f32_16x16x32_bf16 v[52:55], v[92:95], a[196:199], v[52:55]
  v_mfma_f32_16x16x32_bf16 v[16:19], v[96:99], a[32:35], v[16:19]
  v_mfma_f32_16x16x32_bf16 v[28:31], v[96:99], a[88:91], v[28:31]
  v_mfma_f32_16x16x32_bf16 v[40:43], v[96:99], a[144:147], v[40:43]
  v_mfma_f32_16x16x32_bf16 v[52:55], v[96:99], a[200:203], v[52:55]
  v_mfma_f32_16x16x32_bf16 v[16:19], v[100:103], a[36:39], v[16:19]
  v_mfma_f32_16x16x32_bf16 v[28:31], v[100:103], a[92:95], v[28:31]
  v_mfma_f32_16x16x32_bf16 v[40:43], v[100:103], a[148:151], v[40:43]
  v_mfma_f32_16x16x32_bf16 v[52:55], v[100:103], a[204:207], v[52:55]
  v_mfma_f32_16x16x32_bf16 v[16:19], v[104:107], a[40:43], v[16:19]
  v_mfma_f32_16x16x32_bf16 v[28:31], v[104:107], a[96:99], v[28:31]
  v_mfma_f32_16x16x32_bf16 v[40:43], v[104:107], a[152:155], v[40:43]
  v_mfma_f32_16x16x32_bf16 v[52:55], v[104:107], a[208:211], v[52:55]
  v_mfma_f32_16x16x32_bf16 v[16:19], v[108:111], a[44:47], v[16:19]
  v_mfma_f32_16x16x32_bf16 v[28:31], v[108:111], a[100:103], v[28:31]
  v_mfma_f32_16x16x32_bf16 v[40:43], v[108:111], a[156:159], v[40:43]
  v_mfma_f32_16x16x32_bf16 v[52:55], v[108:111], a[212:215], v[52:55]
  v_mfma_f32_16x16x32_bf16 v[16:19], v[112:115], a[48:51], v[16:19]
  v_mfma_f32_16x16x32_bf16 v[28:31], v[112:115], a[104:107], v[28:31]
  v_mfma_f32_16x16x32_bf16 v[40:43], v[112:115], a[160:163], v[40:43]
  v_mfma_f32_16x16x32_bf16 v[52:55], v[112:115], a[216:219], v[52:55]
  v_mfma_f32_16x16x32_bf16 v[16:19], v[116:119], a[52:55], v[16:19]
  v_mfma_f32_16x16x32_bf16 v[28:31], v[116:119], a[108:111], v[28:31]
  v_mfma_f32_16x16x32_bf16 v[40:43], v[116:119], a[164:167], v[40:43]
  v_mfma_f32_16x16x32_bf16 v[52:55], v[116:119], a[220:223], v[52:55]
  global_load_dwordx4 v[100:103], v11, s[8:9]
  global_load_dwordx4 v[104:107], v13, s[8:9]
  s_nop 2
  v_max3_f32 v92, v16, v17, v18
  v_max3_f32 v94, v28, v29, v30
  v_max3_f32 v96, v40, v41, v42
  v_max3_f32 v98, v52, v53, v54
  v_max3_f32 v93, v19, v20, v21
  v_max3_f32 v95, v31, v32, v33
  v_max3_f32 v97, v43, v44, v45
  v_max3_f32 v99, v55, v56, v57
  v_max3_f32 v92, v92, v22, v23
  v_max3_f32 v94, v94, v34, v35
  v_max3_f32 v96, v96, v46, v47
  v_max3_f32 v98, v98, v58, v59
  v_max3_f32 v93, v93, v24, v25
  v_max3_f32 v95, v95, v36, v37
  v_max3_f32 v97, v97, v48, v49
  v_max3_f32 v99, v99, v60, v61
  v_max3_f32 v92, v92, v26, v27
  v_max3_f32 v94, v94, v38, v39
  v_max3_f32 v96, v96, v50, v51
  v_max3_f32 v98, v98, v62, v63
  v_max_f32 v92, v92, v93
  v_max_f32 v94, v94, v95
  v_max_f32 v96, v96, v97
  v_max_f32 v98, v98, v99
  v_mov_b32 v93, v92
  v_mov_b32 v95, v94
  v_mov_b32 v97, v96
  v_mov_b32 v99, v98
  v_permlane16_swap_b32 v92, v93
  v_permlane16_swap_b32 v94, v95
  v_permlane16_swap_b32 v96, v97
  v_permlane16_swap_b32 v98, v99
  v_max_f32 v92, v92, v93
  v_max_f32 v94, v94, v95
  v_max_f32 v96, v96, v97
  v_max_f32 v98, v98, v99
  v_mov_b32 v93, v92
  v_mov_b32 v95, v94
  v_mov_b32 v97, v96
  v_mov_b32 v99, v98
  v_permlane32_swap_b32 v92, v93
  v_permlane32_swap_b32 v94, v95
  v_permlane32_swap_b32 v96, v97
  v_permlane32_swap_b32 v98, v99
  v_max_f32 v92, v92, v93
  v_max_f32 v94, v94, v95
  v_max_f32 v96, v96, v97
  v_max_f32 v98, v98, v99
  v_mov_b32 v93, v92
  v_mov_b32 v95, v94
  v_mov_b32 v97, v96
  v_mov_b32 v99, v98
  v_pk_add_f32 v[16:17], v[16:17], v[92:93] neg_lo:[0,1] neg_hi:[0,1]
  v_pk_add_f32 v[28:29], v[28:29], v[94:95] neg_lo:[0,1] neg_hi:[0,1]
  v_pk_add_f32 v[40:41], v[40:41], v[96:97] neg_lo:[0,1] neg_hi:[0,1]
  v_pk_add_f32 v[52:53], v[52:53], v[98:99] neg_lo:[0,1] neg_hi:[0,1]
  v_pk_add_f32 v[18:19], v[18:19], v[92:93] neg_lo:[0,1] neg_hi:[0,1]
  v_pk_add_f32 v[30:31], v[30:31], v[94:95] neg_lo:[0,1] neg_hi:[0,1]
  v_pk_add_f32 v[42:43], v[42:43], v[96:97] neg_lo:[0,1] neg_hi:[0,1]
  v_pk_add_f32 v[54:55], v[54:55], v[98:99] neg_lo:[0,1] neg_hi:[0,1]
  v_pk_add_f32 v[20:21], v[20:21], v[92:93] neg_lo:[0,1] neg_hi:[0,1]
  v_pk_add_f32 v[32:33], v[32:33], v[94:95] neg_lo:[0,1] neg_hi:[0,1]
  v_pk_add_f32 v[44:45], v[44:45], v[96:97] neg_lo:[0,1] neg_hi:[0,1]
  v_pk_add_f32 v[56:57], v[56:57], v[98:99] neg_lo:[0,1] neg_hi:[0,1]
  v_pk_add_f32 v[22:23], v[22:23], v[92:93] neg_lo:[0,1] neg_hi:[0,1]
  v_pk_add_f32 v[34:35], v[34:35], v[94:95] neg_lo:[0,1] neg_hi:[0,1]
  v_pk_add_f32 v[46:47], v[46:47], v[96:97] neg_lo:[0,1] neg_hi:[0,1]
  v_pk_add_f32 v[58:59], v[58:59], v[98:99] neg_lo:[0,1] neg_hi:[0,1]
  v_pk_add_f32 v[24:25], v[24:25], v[92:93] neg_lo:[0,1] neg_hi:[0,1]
  v_pk_add_f32 v[36:37], v[36:37], v[94:95] neg_lo:[0,1] neg_hi:[0,1]
  v_pk_add_f32 v[48:49], v[48:49], v[96:97] neg_lo:[0,1] neg_hi:[0,1]
  v_pk_add_f32 v[60:61], v[60:61], v[98:99] neg_lo:[0,1] neg_hi:[0,1]
  v_pk_add_f32 v[26:27], v[26:27], v[92:93] neg_lo:[0,1] neg_hi:[0,1]
  v_pk_add_f32 v[38:39], v[38:39], v[94:95] neg_lo:[0,1] neg_hi:[0,1]
  v_pk_add_f32 v[50:51], v[50:51], v[96:97] neg_lo:[0,1] neg_hi:[0,1]
  v_pk_add_f32 v[62:63], v[62:63], v[98:99] neg_lo:[0,1] neg_hi:[0,1]
  v_exp_f32 v16, v16
  v_exp_f32 v28, v28
  v_exp_f32 v40, v40
  v_exp_f32 v52, v52
  v_exp_f32 v17, v17
  v_exp_f32 v29, v29
  v_exp_f32 v41, v41
  v_exp_f32 v53, v53
  v_exp_f32 v18, v18
  v_exp_f32 v30, v30
  v_exp_f32 v42, v42
  v_exp_f32 v54, v54
  v_exp_f32 v19, v19
  v_exp_f32 v31, v31
  v_exp_f32 v43, v43
  v_exp_f32 v55, v55
  v_exp_f32 v20, v20
  v_exp_f32 v32, v32
  v_exp_f32 v44, v44
  v_exp_f32 v56, v56
  v_exp_f32 v21, v21
  v_exp_f32 v33, v33
  v_exp_f32 v45, v45
  v_exp_f32 v57, v57
  v_exp_f32 v22, v22
  v_exp_f32 v34, v34
  v_exp_f32 v46, v46
  v_exp_f32 v58, v58
  v_exp_f32 v23, v23
  v_exp_f32 v35, v35
  v_exp_f32 v47, v47
  v_exp_f32 v59, v59
  v_exp_f32 v24, v24
  v_exp_f32 v36, v36
  v_exp_f32 v48, v48
  v_exp_f32 v60, v60
  v_exp_f32 v25, v25
  v_exp_f32 v37, v37
  v_exp_f32 v49, v49
  v_exp_f32 v61, v61
  v_exp_f32 v26, v26
  v_exp_f32 v38, v38
  v_exp_f32 v50, v50
  v_exp_f32 v62, v62
  v_exp_f32 v27, v27
  v_exp_f32 v39, v39
  v_exp_f32 v51, v51
  v_exp_f32 v63, v63
  v_pk_add_f32 v[92:93], v[16:17], v[18:19]
  v_pk_add_f32 v[94:95], v[28:29], v[30:31]
  v_pk_add_f32 v[96:97], v[40:41], v[42:43]
  v_pk_add_f32 v[98:99], v[52:53], v[54:55]
  v_pk_add_f32 v[108:109], v[20:21], v[22:23]
  v_pk_add_f32 v[110:111], v[32:33], v[34:35]
  v_pk_add_f32 v[112:113], v[44:45], v[46:47]
  v_pk_add_f32 v[114:115], v[56:57], v[58:59]
  v_add_f32 v92, v92, v93
  v_add_f32 v94, v94, v95
  v_add_f32 v96, v96, v97
  v_add_f32 v98, v98, v99
  v_pk_add_f32 v[108:109], v[108:109], v[24:25]
  v_pk_add_f32 v[110:111], v[110:111], v[36:37]
  v_pk_add_f32 v[112:113], v[112:113], v[48:49]
  v_pk_add_f32 v[114:115], v[114:115], v[60:61]
  v_pk_add_f32 v[108:109], v[108:109], v[26:27]
  v_pk_add_f32 v[110:111], v[110:111], v[38:39]
  v_pk_add_f32 v[112:113], v[112:113], v[50:51]
  v_pk_add_f32 v[114:115], v[114:115], v[62:63]
  v_add_f32 v108, v108, v109
  v_add_f32 v110, v110, v111
  v_add_f32 v112, v112, v113
  v_add_f32 v114, v114, v115
  v_fmac_f32 v108, v92, v12
  v_fmac_f32 v110, v94, v12
  v_fmac_f32 v112, v96, v12
  v_fmac_f32 v114, v98, v12
  v_mov_b32 v109, v108
  v_mov_b32 v111, v110
  v_mov_b32 v113, v112
  v_mov_b32 v115, v114
  v_permlane16_swap_b32 v108, v109
  v_permlane16_swap_b32 v110, v111
  v_permlane16_swap_b32 v112, v113
  v_permlane16_swap_b32 v114, v115
  v_add_f32 v108, v108, v109
  v_add_f32 v110, v110, v111
  v_add_f32 v112, v112, v113
  v_add_f32 v114, v114, v115
  v_mov_b32 v109, v108
  v_mov_b32 v111, v110
  v_mov_b32 v113, v112
  v_mov_b32 v115, v114
  v_permlane32_swap_b32 v108, v109
  v_permlane32_swap_b32 v110, v111
  v_permlane32_swap_b32 v112, v113
  v_permlane32_swap_b32 v114, v115
  v_add_f32 v108, v108, v109
  v_add_f32 v110, v110, v111
  v_add_f32 v112, v112, v113
  v_add_f32 v114, v114, v115
  v_rcp_f32 v108, v108
  v_rcp_f32 v110, v110
  v_rcp_f32 v112, v112
  v_rcp_f32 v114, v114
  v_mov_b32 v109, v108
  v_mov_b32 v111, v110
  v_mov_b32 v113, v112
  v_mov_b32 v115, v114
  v_pk_mul_f32 v[16:17], v[16:17], v[108:109]
  v_pk_mul_f32 v[28:29], v[28:29], v[110:111]
  v_pk_mul_f32 v[40:41], v[40:41], v[112:113]
  v_pk_mul_f32 v[52:53], v[52:53], v[114:115]
  v_pk_mul_f32 v[18:19], v[18:19], v[108:109]
  v_pk_mul_f32 v[30:31], v[30:31], v[110:111]
  v_pk_mul_f32 v[42:43], v[42:43], v[112:113]
  v_pk_mul_f32 v[54:55], v[54:55], v[114:115]
  v_pk_mul_f32 v[20:21], v[20:21], v[108:109]
  v_pk_mul_f32 v[32:33], v[32:33], v[110:111]
  v_pk_mul_f32 v[44:45], v[44:45], v[112:113]
  v_pk_mul_f32 v[56:57], v[56:57], v[114:115]
  v_pk_mul_f32 v[22:23], v[22:23], v[108:109]
  v_pk_mul_f32 v[34:35], v[34:35], v[110:111]
  v_pk_mul_f32 v[46:47], v[46:47], v[112:113]
  v_pk_mul_f32 v[58:59], v[58:59], v[114:115]
  v_pk_mul_f32 v[24:25], v[24:25], v[108:109]
  v_pk_mul_f32 v[36:37], v[36:37], v[110:111]
  v_pk_mul_f32 v[48:49], v[48:49], v[112:113]
  v_pk_mul_f32 v[60:61], v[60:61], v[114:115]
  v_pk_mul_f32 v[26:27], v[26:27], v[108:109]
  v_pk_mul_f32 v[38:39], v[38:39], v[110:111]
  v_pk_mul_f32 v[50:51], v[50:51], v[112:113]
  v_pk_mul_f32 v[62:63], v[62:63], v[114:115]
  v_cvt_pk_bf16_f32 v20, v20, v21
  v_cvt_pk_bf16_f32 v32, v32, v33
  v_cvt_pk_bf16_f32 v44, v44, v45
  v_cvt_pk_bf16_f32 v56, v56, v57
  v_cvt_pk_bf16_f32 v21, v22, v23
  v_cvt_pk_bf16_f32 v33, v34, v35
  v_cvt_pk_bf16_f32 v45, v46, v47
  v_cvt_pk_bf16_f32 v57, v58, v59
  v_cvt_pk_bf16_f32 v22, v24, v25
  v_cvt_pk_bf16_f32 v34, v36, v37
  v_cvt_pk_bf16_f32 v46, v48, v49
  v_cvt_pk_bf16_f32 v58, v60, v61
  v_cvt_pk_bf16_f32 v23, v26, v27
  v_cvt_pk_bf16_f32 v35, v38, v39
  v_cvt_pk_bf16_f32 v47, v50, v51
  v_cvt_pk_bf16_f32 v59, v62, v63
  v_cvt_pk_bf16_f32 v16, v16, v17
  v_cvt_pk_bf16_f32 v28, v28, v29
  v_cvt_pk_bf16_f32 v40, v40, v41
  v_cvt_pk_bf16_f32 v52, v52, v53
  v_cvt_pk_bf16_f32 v17, v18, v19
  v_cvt_pk_bf16_f32 v29, v30, v31
  v_cvt_pk_bf16_f32 v41, v42, v43
  v_cvt_pk_bf16_f32 v53, v54, v55
  v_mov_b32 v18, v28
  v_mov_b32 v19, v29
  v_mov_b32 v42, v52
  v_mov_b32 v43, v53
  v_mfma_f32_16x16x32_bf16 v[64:67], v[120:123], v[20:23], 0
  v_mfma_f32_16x16x32_bf16 v[68:71], v[136:139], v[20:23], 0
  v_mfma_f32_16x16x32_bf16 v[72:75], v[152:155], v[20:23], 0
  v_mfma_f32_16x16x32_bf16 v[76:79], v[168:171], v[20:23], 0
  v_mfma_f32_16x16x32_bf16 v[80:83], v[184:187], v[20:23], 0
  v_mfma_f32_16x16x32_bf16 v[84:87], v[200:203], v[20:23], 0
  v_mfma_f32_16x16x32_bf16 v[88:91], v[216:219], v[20:23], 0
  v_mfma_f32_16x16x32_bf16 v[64:67], v[124:127], v[32:35], v[64:67]
  v_mfma_f32_16x16x32_bf16 v[68:71], v[140:143], v[32:35], v[68:71]
  v_mfma_f32_16x16x32_bf16 v[72:75], v[156:159], v[32:35], v[72:75]
  v_mfma_f32_16x16x32_bf16 v[76:79], v[172:175], v[32:35], v[76:79]
  v_mfma_f32_16x16x32_bf16 v[80:83], v[188:191], v[32:35], v[80:83]
  v_mfma_f32_16x16x32_bf16 v[84:87], v[204:207], v[32:35], v[84:87]
  v_mfma_f32_16x16x32_bf16 v[88:91], v[220:223], v[32:35], v[88:91]
  v_mfma_f32_16x16x32_bf16 v[64:67], v[128:131], v[44:47], v[64:67]
  v_mfma_f32_16x16x32_bf16 v[68:71], v[144:147], v[44:47], v[68:71]
  v_mfma_f32_16x16x32_bf16 v[72:75], v[160:163], v[44:47], v[72:75]
  v_mfma_f32_16x16x32_bf16 v[76:79], v[176:179], v[44:47], v[76:79]
  v_mfma_f32_16x16x32_bf16 v[80:83], v[192:195], v[44:47], v[80:83]
  v_mfma_f32_16x16x32_bf16 v[84:87], v[208:211], v[44:47], v[84:87]
  v_mfma_f32_16x16x32_bf16 v[88:91], v[224:227], v[44:47], v[88:91]
  v_mfma_f32_16x16x32_bf16 v[64:67], v[132:135], v[56:59], v[64:67]
  v_mfma_f32_16x16x32_bf16 v[68:71], v[148:151], v[56:59], v[68:71]
  v_mfma_f32_16x16x32_bf16 v[72:75], v[164:167], v[56:59], v[72:75]
  v_mfma_f32_16x16x32_bf16 v[76:79], v[180:183], v[56:59], v[76:79]
  v_mfma_f32_16x16x32_bf16 v[80:83], v[196:199], v[56:59], v[80:83]
  v_mfma_f32_16x16x32_bf16 v[84:87], v[212:215], v[56:59], v[84:87]
  v_mfma_f32_16x16x32_bf16 v[88:91], v[228:231], v[56:59], v[88:91]
  s_lshl_b32 s14, s12, 8
  s_lshl_b32 s15, s10, 6
  s_add_u32 s14, s14, s15
  s_add_u32 s14, s14, 103350272
  v_min_u32 v10, 13, v4
  v_lshl_add_u32 v10, v10, 2, s14
  s_mov_b32 s14, 8192
  s_nop 1
XP4_108:
  global_load_dword v15, v10, s[8:9] sc0 sc1
  s_waitcnt vmcnt(0)
  v_cmp_eq_u32 vcc, 0, v15
  s_nop 4
  s_cbranch_vccz XD4_109
  s_sleep 2
  s_sub_u32 s14, s14, 1
  s_nop 1
  s_cbranch_scc0 XP4_108
XD4_109:
  s_waitcnt vmcnt(0)
  v_add_u32 v8, s60, v7
  global_load_dwordx4 a[224:227], v8, s[8:9] offset:0
  global_load_dwordx4 a[228:231], v8, s[8:9] offset:2048
  v_add_u32 v8, s61, v7
  global_load_dwordx4 a[232:235], v8, s[8:9] offset:0
  global_load_dwordx4 a[236:239], v8, s[8:9] offset:2048
  v_add_u32 v8, s62, v7
  global_load_dwordx4 a[240:243], v8, s[8:9] offset:0
  global_load_dwordx4 a[244:247], v8, s[8:9] offset:2048
  v_add_u32 v8, s63, v7
  global_load_dwordx4 a[248:251], v8, s[8:9] offset:0
  global_load_dwordx4 a[252:255], v8, s[8:9] offset:2048
  v_add_u32 v8, s64, v7
  global_load_dwordx4 v[232:235], v8, s[8:9] offset:0
  global_load_dwordx4 v[236:239], v8, s[8:9] offset:2048
  v_add_u32 v8, s65, v7
  global_load_dwordx4 v[240:243], v8, s[8:9] offset:0
  global_load_dwordx4 v[244:247], v8, s[8:9] offset:2048
  v_add_u32 v8, s66, v7
  global_load_dwordx4 v[248:251], v8, s[8:9] offset:0
  global_load_dwordx4 v[252:255], v8, s[8:9] offset:2048
  s_mul_i32 s14, s10, 7168
  v_add_u32 v8, s14, v3
  s_lshl_b32 s14, s10, 10
  v_add_u32 v9, s14, v3
  s_waitcnt vmcnt(12)
  v_mfma_f32_16x16x32_bf16 v[64:67], a[224:227], v[16:19], v[64:67]
  v_mfma_f32_16x16x32_bf16 v[64:67], a[228:231], v[40:43], v[64:67]
  s_waitcnt vmcnt(10)
  v_mfma_f32_16x16x32_bf16 v[68:71], a[232:235], v[16:19], v[68:71]
  v_mfma_f32_16x16x32_bf16 v[68:71], a[236:239], v[40:43], v[68:71]
  s_waitcnt vmcnt(8)
  v_mfma_f32_16x16x32_bf16 v[72:75], a[240:243], v[16:19], v[72:75]
  v_mfma_f32_16x16x32_bf16 v[72:75], a[244:247], v[40:43], v[72:75]
  s_waitcnt vmcnt(6)
  v_mfma_f32_16x16x32_bf16 v[76:79], a[248:251], v[16:19], v[76:79]
  v_mfma_f32_16x16x32_bf16 v[76:79], a[252:255], v[40:43], v[76:79]
  s_waitcnt vmcnt(4)
  v_mfma_f32_16x16x32_bf16 v[80:83], v[232:235], v[16:19], v[80:83]
  v_mfma_f32_16x16x32_bf16 v[80:83], v[236:239], v[40:43], v[80:83]
  s_waitcnt vmcnt(2)
  v_mfma_f32_16x16x32_bf16 v[84:87], v[240:243], v[16:19], v[84:87]
  v_mfma_f32_16x16x32_bf16 v[84:87], v[244:247], v[40:43], v[84:87]
  s_waitcnt vmcnt(0)
  v_mfma_f32_16x16x32_bf16 v[88:91], v[248:251], v[16:19], v[88:91]
  v_mfma_f32_16x16x32_bf16 v[88:91], v[252:255], v[40:43], v[88:91]
  ds_write_b128 v8, v[64:67] offset:0
  ds_write_b128 v8, v[68:71] offset:1024
  ds_write_b128 v8, v[72:75] offset:2048
  ds_write_b128 v8, v[76:79] offset:3072
  ds_write_b128 v8, v[80:83] offset:4096
  ds_write_b128 v8, v[84:87] offset:5120
  s_nop 1
  ds_write_b128 v8, v[88:91] offset:6144
  s_mul_i32 s14, s41, 14336
  s_mul_i32 s15, s42, 224
  s_add_u32 s14, s14, s15
  s_lshl_b32 s15, s10, 5
  s_add_u32 s14, s14, s15
  v_mul_u32_u24 v10, 896, v4
  v_lshl_add_u32 v10, v5, 3, v10
  v_add_u32 v10, s14, v10
  v_sub_f32 v15, 1.0, v14
  s_waitcnt vmcnt(0) lgkmcnt(0)
  s_barrier
  ds_read_b128 v[16:19], v9 offset:0
  ds_read_b128 v[20:23], v9 offset:7168
  ds_read_b128 v[24:27], v9 offset:14336
  ds_read_b128 v[28:31], v9 offset:21504
  v_mul_f32 v100, v100, v14
  v_mul_f32 v101, v101, v14
  v_mul_f32 v102, v102, v14
  v_mul_f32 v103, v103, v14
  s_waitcnt lgkmcnt(0)
  v_pk_add_f32 v[16:17], v[16:17], v[20:21]
  v_pk_add_f32 v[18:19], v[18:19], v[22:23]
  v_pk_add_f32 v[24:25], v[24:25], v[28:29]
  v_pk_add_f32 v[26:27], v[26:27], v[30:31]
  v_pk_add_f32 v[16:17], v[16:17], v[24:25]
  v_pk_add_f32 v[18:19], v[18:19], v[26:27]
  v_fmac_f32 v100, v16, v15
  v_fmac_f32 v101, v17, v15
  v_fmac_f32 v102, v18, v15
  v_fmac_f32 v103, v19, v15
  v_cvt_pk_bf16_f32 v32, v100, v101
  v_cvt_pk_bf16_f32 v33, v102, v103
  global_store_dwordx2 v10, v[32:33], s[90:91] offset:0
  s_cmp_eq_u32 s10, 3
  s_nop 1
  s_cbranch_scc1 XW3_105
  ds_read_b128 v[16:19], v9 offset:4096
  ds_read_b128 v[20:23], v9 offset:11264
  ds_read_b128 v[24:27], v9 offset:18432
  ds_read_b128 v[28:31], v9 offset:25600
  v_mul_f32 v104, v104, v14
  v_mul_f32 v105, v105, v14
  v_mul_f32 v106, v106, v14
  v_mul_f32 v107, v107, v14
  s_waitcnt lgkmcnt(0)
  v_pk_add_f32 v[16:17], v[16:17], v[20:21]
  v_pk_add_f32 v[18:19], v[18:19], v[22:23]
  v_pk_add_f32 v[24:25], v[24:25], v[28:29]
  v_pk_add_f32 v[26:27], v[26:27], v[30:31]
  v_pk_add_f32 v[16:17], v[16:17], v[24:25]
  v_pk_add_f32 v[18:19], v[18:19], v[26:27]
  v_fmac_f32 v104, v16, v15
  v_fmac_f32 v105, v17, v15
  v_fmac_f32 v106, v18, v15
  v_fmac_f32 v107, v19, v15
  v_cvt_pk_bf16_f32 v34, v104, v105
  v_cvt_pk_bf16_f32 v35, v106, v107
  global_store_dwordx2 v10, v[34:35], s[90:91] offset:128
  s_nop 1
XW3_105:
  s_waitcnt vmcnt(0)
  s_barrier
  s_nop 1
  s_branch WLOOP_71
WTS_67:
  s_mov_b32 s2, s40
  s_cmp_ge_u32 s2, 24
  s_nop 1
  s_cbranch_scc1 K1N_112
  s_load_dwordx2 s[14:15], s[0:1], 8
  s_lshl_b32 s12, s2, 2
  s_add_u32 s12, s12, s10
  s_lshr_b32 s13, s12, 5
  s_mul_i32 s13, s13, 448
  s_bfe_u32 s16, s12, 0x40001
  s_mul_i32 s16, s16, 28
  s_add_u32 s13, s13, s16
  s_and_b32 s16, s12, 1
  s_lshl_b32 s16, s16, 4
  s_add_u32 s13, s13, s16
  v_and_b32 v3, 15, v2
  v_lshrrev_b32 v4, 4, v2
  v_lshrrev_b32 v6, 1, v4
  v_lshlrev_b32 v5, 4, v6
  v_and_b32 v6, 1, v4
  v_lshl_add_u32 v5, v6, 2, v5
  v_mul_u32_u24 v5, 2688, v5
  v_add_u32 v6, s13, v3
  v_lshl_add_u32 v5, v6, 1, v5
  v_add_u32 v7, 21504, v5
  s_mul_i32 s13, s12, 14336
  v_lshlrev_b32 v6, 4, v2
  v_add_u32 v6, s13, v6
  v_add_u32 v6, 14680064, v6
  v_add_u32 v8, s16, v3
  v_mov_b32 v80, 0
  v_mov_b32 v81, 0
  v_mov_b32 v82, 0
  v_mov_b32 v83, 0
  v_mov_b32 v84, 0
  v_mov_b32 v85, 0
  v_mov_b32 v86, 0
  v_mov_b32 v87, 0
  v_mov_b32 v88, 0
  v_mov_b32 v89, 0
  v_mov_b32 v90, 0
  v_mov_b32 v91, 0
  v_mov_b32 v92, 0
  v_mov_b32 v93, 0
  v_mov_b32 v94, 0
  v_mov_b32 v95, 0
  v_mov_b32 v96, 0
  v_mov_b32 v97, 0
  v_mov_b32 v98, 0
  v_mov_b32 v99, 0
  v_mov_b32 v100, 0
  v_mov_b32 v101, 0
  v_mov_b32 v102, 0
  v_mov_b32 v103, 0
  v_mov_b32 v104, 0
  v_mov_b32 v105, 0
  v_mov_b32 v106, 0
  v_mov_b32 v107, 0
  v_mov_b32 v108, 0
  v_mov_b32 v109, 0
  v_mov_b32 v110, 0
  v_mov_b32 v111, 0
  v_mov_b32 v112, 0
  v_mov_b32 v113, 0
  v_mov_b32 v114, 0
  v_mov_b32 v115, 0
  v_mov_b32 v116, 0
  v_mov_b32 v117, 0
  v_mov_b32 v118, 0
  v_mov_b32 v119, 0
  v_mov_b32 v120, 0
  v_mov_b32 v121, 0
  v_mov_b32 v122, 0
  v_mov_b32 v123, 0
  v_mov_b32 v124, 0
  v_mov_b32 v125, 0
  v_mov_b32 v126, 0
  v_mov_b32 v127, 0
  v_mov_b32 v128, 0
  v_mov_b32 v129, 0
  v_mov_b32 v130, 0
  v_mov_b32 v131, 0
  v_mov_b32 v132, 0
  v_mov_b32 v133, 0
  v_mov_b32 v134, 0
  v_mov_b32 v135, 0
  v_mov_b32 v136, 0
  v_mov_b32 v137, 0
  v_mov_b32 v138, 0
  v_mov_b32 v139, 0
  v_mov_b32 v140, 0
  v_mov_b32 v141, 0
  v_mov_b32 v142, 0
  v_mov_b32 v143, 0
  v_mov_b32 v144, 0
  v_mov_b32 v145, 0
  v_mov_b32 v146, 0
  v_mov_b32 v147, 0
  v_mov_b32 v148, 0
  v_mov_b32 v149, 0
  v_mov_b32 v150, 0
  v_mov_b32 v151, 0
  v_mov_b32 v152, 0
  v_mov_b32 v153, 0
  v_mov_b32 v154, 0
  v_mov_b32 v155, 0
  v_mov_b32 v156, 0
  v_mov_b32 v157, 0
  v_mov_b32 v158, 0
  v_mov_b32 v159, 0
  v_mov_b32 v160, 0
  v_mov_b32 v161, 0
  v_mov_b32 v162, 0
  v_mov_b32 v163, 0
  v_mov_b32 v164, 0
  v_mov_b32 v165, 0
  v_mov_b32 v166, 0
  v_mov_b32 v167, 0
  v_mov_b32 v168, 0
  v_mov_b32 v169, 0
  v_mov_b32 v170, 0
  v_mov_b32 v171, 0
  v_mov_b32 v172, 0
  v_mov_b32 v173, 0
  v_mov_b32 v174, 0
  v_mov_b32 v175, 0
  v_mov_b32 v176, 0
  v_mov_b32 v177, 0
  v_mov_b32 v178, 0
  v_mov_b32 v179, 0
  v_mov_b32 v180, 0
  v_mov_b32 v181, 0
  v_mov_b32 v182, 0
  v_mov_b32 v183, 0
  v_mov_b32 v184, 0
  v_mov_b32 v185, 0
  v_mov_b32 v186, 0
  v_mov_b32 v187, 0
  v_mov_b32 v188, 0
  v_mov_b32 v189, 0
  v_mov_b32 v190, 0
  v_mov_b32 v191, 0
  s_waitcnt lgkmcnt(0)
  v_cmp_gt_u32 vcc, 28, v8
  s_mov_b64 exec, vcc
  v_add_u32 v5, 2688, v5
  v_add_u32 v7, 2688, v7
  global_load_ushort v80, v5, s[14:15] offset:-2688
  global_load_ushort v81, v5, s[14:15] offset:0
  global_load_ushort v82, v7, s[14:15] offset:-2688
  global_load_ushort v83, v7, s[14:15] offset:0
  global_load_ushort v84, v5, s[14:15] offset:2688
  global_load_ushort v86, v7, s[14:15] offset:2688
  v_add_u32 v5, 5376, v5
  v_add_u32 v7, 5376, v7
  global_load_ushort v85, v5, s[14:15]
  global_load_ushort v87, v7, s[14:15]
  v_add_u32 v5, 80640, v5
  v_add_u32 v7, 80640, v7
  global_load_ushort v88, v5, s[14:15] offset:-2688
  global_load_ushort v89, v5, s[14:15] offset:0
  global_load_ushort v90, v7, s[14:15] offset:-2688
  global_load_ushort v91, v7, s[14:15] offset:0
  global_load_ushort v92, v5, s[14:15] offset:2688
  global_load_ushort v94, v7, s[14:15] offset:2688
  v_add_u32 v5, 5376, v5
  v_add_u32 v7, 5376, v7
  global_load_ushort v93, v5, s[14:15]
  global_load_ushort v95, v7, s[14:15]
  v_add_u32 v5, 80640, v5
  v_add_u32 v7, 80640, v7
  global_load_ushort v96, v5, s[14:15] offset:-2688
  global_load_ushort v97, v5, s[14:15] offset:0
  global_load_ushort v98, v7, s[14:15] offset:-2688
  global_load_ushort v99, v7, s[14:15] offset:0
  global_load_ushort v100, v5, s[14:15] offset:2688
  global_load_ushort v102, v7, s[14:15] offset:2688
  v_add_u32 v5, 5376, v5
  v_add_u32 v7, 5376, v7
  global_load_ushort v101, v5, s[14:15]
  global_load_ushort v103, v7, s[14:15]
  v_add_u32 v5, 80640, v5
  v_add_u32 v7, 80640, v7
  global_load_ushort v104, v5, s[14:15] offset:-2688
  global_load_ushort v105, v5, s[14:15] offset:0
  global_load_ushort v106, v7, s[14:15] offset:-2688
  global_load_ushort v107, v7, s[14:15] offset:0
  global_load_ushort v108, v5, s[14:15] offset:2688
  global_load_ushort v110, v7, s[14:15] offset:2688
  v_add_u32 v5, 5376, v5
  v_add_u32 v7, 5376, v7
  global_load_ushort v109, v5, s[14:15]
  global_load_ushort v111, v7, s[14:15]
  v_add_u32 v5, 80640, v5
  v_add_u32 v7, 80640, v7
  s_waitcnt vmcnt(16)
  global_load_ushort v112, v5, s[14:15] offset:-2688
  global_load_ushort v113, v5, s[14:15] offset:0
  global_load_ushort v114, v7, s[14:15] offset:-2688
  global_load_ushort v115, v7, s[14:15] offset:0
  global_load_ushort v116, v5, s[14:15] offset:2688
  global_load_ushort v118, v7, s[14:15] offset:2688
  v_add_u32 v5, 5376, v5
  v_add_u32 v7, 5376, v7
  global_load_ushort v117, v5, s[14:15]
  global_load_ushort v119, v7, s[14:15]
  v_add_u32 v5, 80640, v5
  v_add_u32 v7, 80640, v7
  global_load_ushort v120, v5, s[14:15] offset:-2688
  global_load_ushort v121, v5, s[14:15] offset:0
  global_load_ushort v122, v7, s[14:15] offset:-2688
  global_load_ushort v123, v7, s[14:15] offset:0
  global_load_ushort v124, v5, s[14:15] offset:2688
  global_load_ushort v126, v7, s[14:15] offset:2688
  v_add_u32 v5, 5376, v5
  v_add_u32 v7, 5376, v7
  global_load_ushort v125, v5, s[14:15]
  global_load_ushort v127, v7, s[14:15]
  v_add_u32 v5, 80640, v5
  v_add_u32 v7, 80640, v7
  global_load_ushort v128, v5, s[14:15] offset:-2688
  global_load_ushort v129, v5, s[14:15] offset:0
  global_load_ushort v130, v7, s[14:15] offset:-2688
  global_load_ushort v131, v7, s[14:15] offset:0
  global_load_ushort v132, v5, s[14:15] offset:2688
  global_load_ushort v134, v7, s[14:15] offset:2688
  v_add_u32 v5, 5376, v5
  v_add_u32 v7, 5376, v7
  global_load_ushort v133, v5, s[14:15]
  global_load_ushort v135, v7, s[14:15]
  v_add_u32 v5, 80640, v5
  v_add_u32 v7, 80640, v7
  global_load_ushort v136, v5, s[14:15] offset:-2688
  global_load_ushort v137, v5, s[14:15] offset:0
  global_load_ushort v138, v7, s[14:15] offset:-2688
  global_load_ushort v139, v7, s[14:15] offset:0
  global_load_ushort v140, v5, s[14:15] offset:2688
  global_load_ushort v142, v7, s[14:15] offset:2688
  v_add_u32 v5, 5376, v5
  v_add_u32 v7, 5376, v7
  global_load_ushort v141, v5, s[14:15]
  global_load_ushort v143, v7, s[14:15]
  v_add_u32 v5, 80640, v5
  v_add_u32 v7, 80640, v7
  s_waitcnt vmcnt(16)
  global_load_ushort v144, v5, s[14:15] offset:-2688
  global_load_ushort v145, v5, s[14:15] offset:0
  global_load_ushort v146, v7, s[14:15] offset:-2688
  global_load_ushort v147, v7, s[14:15] offset:0
  global_load_ushort v148, v5, s[14:15] offset:2688
  global_load_ushort v150, v7, s[14:15] offset:2688
  v_add_u32 v5, 5376, v5
  v_add_u32 v7, 5376, v7
  global_load_ushort v149, v5, s[14:15]
  global_load_ushort v151, v7, s[14:15]
  v_add_u32 v5, 80640, v5
  v_add_u32 v7, 80640, v7
  global_load_ushort v152, v5, s[14:15] offset:-2688
  global_load_ushort v153, v5, s[14:15] offset:0
  global_load_ushort v154, v7, s[14:15] offset:-2688
  global_load_ushort v155, v7, s[14:15] offset:0
  global_load_ushort v156, v5, s[14:15] offset:2688
  global_load_ushort v158, v7, s[14:15] offset:2688
  v_add_u32 v5, 5376, v5
  v_add_u32 v7, 5376, v7
  global_load_ushort v157, v5, s[14:15]
  global_load_ushort v159, v7, s[14:15]
  v_add_u32 v5, 80640, v5
  v_add_u32 v7, 80640, v7
  global_load_ushort v160, v5, s[14:15] offset:-2688
  global_load_ushort v161, v5, s[14:15] offset:0
  global_load_ushort v162, v7, s[14:15] offset:-2688
  global_load_ushort v163, v7, s[14:15] offset:0
  global_load_ushort v164, v5, s[14:15] offset:2688
  global_load_ushort v166, v7, s[14:15] offset:2688
  v_add_u32 v5, 5376, v5
  v_add_u32 v7, 5376, v7
  global_load_ushort v165, v5, s[14:15]
  global_load_ushort v167, v7, s[14:15]
  v_add_u32 v5, 80640, v5
  v_add_u32 v7, 80640, v7
  global_load_ushort v168, v5, s[14:15] offset:-2688
  global_load_ushort v169, v5, s[14:15] offset:0
  global_load_ushort v170, v7, s[14:15] offset:-2688
  global_load_ushort v171, v7, s[14:15] offset:0
  global_load_ushort v172, v5, s[14:15] offset:2688
  global_load_ushort v174, v7, s[14:15] offset:2688
  v_add_u32 v5, 5376, v5
  v_add_u32 v7, 5376, v7
  global_load_ushort v173, v5, s[14:15]
  global_load_ushort v175, v7, s[14:15]
  v_add_u32 v5, 80640, v5
  v_add_u32 v7, 80640, v7
  s_waitcnt vmcnt(16)
  global_load_ushort v176, v5, s[14:15] offset:-2688
  global_load_ushort v177, v5, s[14:15] offset:0
  global_load_ushort v178, v7, s[14:15] offset:-2688
  global_load_ushort v179, v7, s[14:15] offset:0
  global_load_ushort v180, v5, s[14:15] offset:2688
  global_load_ushort v182, v7, s[14:15] offset:2688
  v_add_u32 v5, 5376, v5
  v_add_u32 v7, 5376, v7
  global_load_ushort v181, v5, s[14:15]
  global_load_ushort v183, v7, s[14:15]
  v_add_u32 v5, 80640, v5
  v_add_u32 v7, 80640, v7
  global_load_ushort v184, v5, s[14:15] offset:-2688
  global_load_ushort v185, v5, s[14:15] offset:0
  global_load_ushort v186, v7, s[14:15] offset:-2688
  global_load_ushort v187, v7, s[14:15] offset:0
  global_load_ushort v188, v5, s[14:15] offset:2688
  global_load_ushort v190, v7, s[14:15] offset:2688
  v_add_u32 v5, 5376, v5
  v_add_u32 v7, 5376, v7
  global_load_ushort v189, v5, s[14:15]
  global_load_ushort v191, v7, s[14:15]
  v_add_u32 v5, 80640, v5
  v_add_u32 v7, 80640, v7
  s_mov_b64 exec, -1
  s_waitcnt vmcnt(0)
  v_lshl_or_b32 v16, v81, 16, v80
  v_lshl_or_b32 v17, v83, 16, v82
  v_lshl_or_b32 v18, v85, 16, v84
  v_lshl_or_b32 v19, v87, 16, v86
  v_lshl_or_b32 v20, v89, 16, v88
  v_lshl_or_b32 v21, v91, 16, v90
  v_lshl_or_b32 v22, v93, 16, v92
  v_lshl_or_b32 v23, v95, 16, v94
  v_lshl_or_b32 v24, v97, 16, v96
  v_lshl_or_b32 v25, v99, 16, v98
  v_lshl_or_b32 v26, v101, 16, v100
  v_lshl_or_b32 v27, v103, 16, v102
  v_lshl_or_b32 v28, v105, 16, v104
  v_lshl_or_b32 v29, v107, 16, v106
  v_lshl_or_b32 v30, v109, 16, v108
  v_lshl_or_b32 v31, v111, 16, v110
  v_lshl_or_b32 v32, v113, 16, v112
  v_lshl_or_b32 v33, v115, 16, v114
  v_lshl_or_b32 v34, v117, 16, v116
  v_lshl_or_b32 v35, v119, 16, v118
  v_lshl_or_b32 v36, v121, 16, v120
  v_lshl_or_b32 v37, v123, 16, v122
  v_lshl_or_b32 v38, v125, 16, v124
  v_lshl_or_b32 v39, v127, 16, v126
  v_lshl_or_b32 v40, v129, 16, v128
  v_lshl_or_b32 v41, v131, 16, v130
  v_lshl_or_b32 v42, v133, 16, v132
  v_lshl_or_b32 v43, v135, 16, v134
  v_lshl_or_b32 v44, v137, 16, v136
  v_lshl_or_b32 v45, v139, 16, v138
  v_lshl_or_b32 v46, v141, 16, v140
  v_lshl_or_b32 v47, v143, 16, v142
  v_lshl_or_b32 v48, v145, 16, v144
  v_lshl_or_b32 v49, v147, 16, v146
  v_lshl_or_b32 v50, v149, 16, v148
  v_lshl_or_b32 v51, v151, 16, v150
  v_lshl_or_b32 v52, v153, 16, v152
  v_lshl_or_b32 v53, v155, 16, v154
  v_lshl_or_b32 v54, v157, 16, v156
  v_lshl_or_b32 v55, v159, 16, v158
  v_lshl_or_b32 v56, v161, 16, v160
  v_lshl_or_b32 v57, v163, 16, v162
  v_lshl_or_b32 v58, v165, 16, v164
  v_lshl_or_b32 v59, v167, 16, v166
  v_lshl_or_b32 v60, v169, 16, v168
  v_lshl_or_b32 v61, v171, 16, v170
  v_lshl_or_b32 v62, v173, 16, v172
  v_lshl_or_b32 v63, v175, 16, v174
  v_lshl_or_b32 v64, v177, 16, v176
  v_lshl_or_b32 v65, v179, 16, v178
  v_lshl_or_b32 v66, v181, 16, v180
  v_lshl_or_b32 v67, v183, 16, v182
  v_lshl_or_b32 v68, v185, 16, v184
  v_lshl_or_b32 v69, v187, 16, v186
  v_lshl_or_b32 v70, v189, 16, v188
  v_lshl_or_b32 v71, v191, 16, v190
  global_store_dwordx4 v6, v[16:19], s[8:9] offset:0 sc0 sc1
  global_store_dwordx4 v6, v[20:23], s[8:9] offset:1024 sc0 sc1
  global_store_dwordx4 v6, v[24:27], s[8:9] offset:2048 sc0 sc1
  global_store_dwordx4 v6, v[28:31], s[8:9] offset:3072 sc0 sc1
  s_nop 1
  v_add_u32 v6, 4096, v6
  global_store_dwordx4 v6, v[32:35], s[8:9] offset:0 sc0 sc1
  global_store_dwordx4 v6, v[36:39], s[8:9] offset:1024 sc0 sc1
  global_store_dwordx4 v6, v[40:43], s[8:9] offset:2048 sc0 sc1
  global_store_dwordx4 v6, v[44:47], s[8:9] offset:3072 sc0 sc1
  s_nop 1
  v_add_u32 v6, 4096, v6
  global_store_dwordx4 v6, v[48:51], s[8:9] offset:0 sc0 sc1
  global_store_dwordx4 v6, v[52:55], s[8:9] offset:1024 sc0 sc1
  global_store_dwordx4 v6, v[56:59], s[8:9] offset:2048 sc0 sc1
  global_store_dwordx4 v6, v[60:63], s[8:9] offset:3072 sc0 sc1
  s_nop 1
  v_add_u32 v6, 4096, v6
  global_store_dwordx4 v6, v[64:67], s[8:9] offset:0 sc0 sc1
  global_store_dwordx4 v6, v[68:71], s[8:9] offset:1024 sc0 sc1
  s_nop 1
  s_branch WSE_70
K1N_112:
  s_sub_u32 s2, s2, 24
  s_cmp_ge_u32 s2, 32
  s_nop 1
  s_cbranch_scc1 K1N_113
  s_load_dwordx2 s[14:15], s[0:1], 80
  s_lshl_b32 s12, s2, 2
  s_add_u32 s12, s12, s10
  s_mul_i32 s13, s12, 14336
  v_and_b32 v3, 15, v2
  v_lshrrev_b32 v4, 4, v2
  v_mul_u32_u24 v5, 896, v3
  v_mul_u32_u24 v6, 224, v4
  v_add_u32 v5, v5, v6
  v_add_u32 v5, s13, v5
  v_mov_b32 v8, 0
  v_mov_b32 v9, 0
  s_waitcnt lgkmcnt(0)
  global_load_dwordx4 v[16:19], v5, s[4:5] offset:0
  global_load_dwordx4 v[80:83], v6, s[14:15] offset:0
  global_load_dwordx4 v[20:23], v5, s[4:5] offset:16
  global_load_dwordx4 v[84:87], v6, s[14:15] offset:16
  global_load_dwordx4 v[24:27], v5, s[4:5] offset:32
  global_load_dwordx4 v[88:91], v6, s[14:15] offset:32
  global_load_dwordx4 v[28:31], v5, s[4:5] offset:48
  global_load_dwordx4 v[92:95], v6, s[14:15] offset:48
  global_load_dwordx4 v[32:35], v5, s[4:5] offset:64
  global_load_dwordx4 v[96:99], v6, s[14:15] offset:64
  global_load_dwordx4 v[36:39], v5, s[4:5] offset:80
  global_load_dwordx4 v[100:103], v6, s[14:15] offset:80
  global_load_dwordx4 v[40:43], v5, s[4:5] offset:96
  global_load_dwordx4 v[104:107], v6, s[14:15] offset:96
  global_load_dwordx4 v[44:47], v5, s[4:5] offset:112
  global_load_dwordx4 v[108:111], v6, s[14:15] offset:112
  global_load_dwordx4 v[48:51], v5, s[4:5] offset:128
  global_load_dwordx4 v[112:115], v6, s[14:15] offset:128
  global_load_dwordx4 v[52:55], v5, s[4:5] offset:144
  global_load_dwordx4 v[116:119], v6, s[14:15] offset:144
  global_load_dwordx4 v[56:59], v5, s[4:5] offset:160
  global_load_dwordx4 v[120:123], v6, s[14:15] offset:160
  global_load_dwordx4 v[60:63], v5, s[4:5] offset:176
  global_load_dwordx4 v[124:127], v6, s[14:15] offset:176
  global_load_dwordx4 v[64:67], v5, s[4:5] offset:192
  global_load_dwordx4 v[128:131], v6, s[14:15] offset:192
  global_load_dwordx4 v[68:71], v5, s[4:5] offset:208
  global_load_dwordx4 v[132:135], v6, s[14:15] offset:208
  s_waitcnt vmcnt(0)
  v_lshlrev_b32 v10, 16, v16
  v_lshlrev_b32 v11, 16, v80
  v_and_b32 v12, 0xffff0000, v16
  v_and_b32 v13, 0xffff0000, v80
  v_fmac_f32 v8, v10, v11
  v_fmac_f32 v9, v12, v13
  v_lshlrev_b32 v10, 16, v17
  v_lshlrev_b32 v11, 16, v81
  v_and_b32 v12, 0xffff0000, v17
  v_and_b32 v13, 0xffff0000, v81
  v_fmac_f32 v8, v10, v11
  v_fmac_f32 v9, v12, v13
  v_lshlrev_b32 v10, 16, v18
  v_lshlrev_b32 v11, 16, v82
  v_and_b32 v12, 0xffff0000, v18
  v_and_b32 v13, 0xffff0000, v82
  v_fmac_f32 v8, v10, v11
  v_fmac_f32 v9, v12, v13
  v_lshlrev_b32 v10, 16, v19
  v_lshlrev_b32 v11, 16, v83
  v_and_b32 v12, 0xffff0000, v19
  v_and_b32 v13, 0xffff0000, v83
  v_fmac_f32 v8, v10, v11
  v_fmac_f32 v9, v12, v13
  v_lshlrev_b32 v10, 16, v20
  v_lshlrev_b32 v11, 16, v84
  v_and_b32 v12, 0xffff0000, v20
  v_and_b32 v13, 0xffff0000, v84
  v_fmac_f32 v8, v10, v11
  v_fmac_f32 v9, v12, v13
  v_lshlrev_b32 v10, 16, v21
  v_lshlrev_b32 v11, 16, v85
  v_and_b32 v12, 0xffff0000, v21
  v_and_b32 v13, 0xffff0000, v85
  v_fmac_f32 v8, v10, v11
  v_fmac_f32 v9, v12, v13
  v_lshlrev_b32 v10, 16, v22
  v_lshlrev_b32 v11, 16, v86
  v_and_b32 v12, 0xffff0000, v22
  v_and_b32 v13, 0xffff0000, v86
  v_fmac_f32 v8, v10, v11
  v_fmac_f32 v9, v12, v13
  v_lshlrev_b32 v10, 16, v23
  v_lshlrev_b32 v11, 16, v87
  v_and_b32 v12, 0xffff0000, v23
  v_and_b32 v13, 0xffff0000, v87
  v_fmac_f32 v8, v10, v11
  v_fmac_f32 v9, v12, v13
  v_lshlrev_b32 v10, 16, v24
  v_lshlrev_b32 v11, 16, v88
  v_and_b32 v12, 0xffff0000, v24
  v_and_b32 v13, 0xffff0000, v88
  v_fmac_f32 v8, v10, v11
  v_fmac_f32 v9, v12, v13
  v_lshlrev_b32 v10, 16, v25
  v_lshlrev_b32 v11, 16, v89
  v_and_b32 v12, 0xffff0000, v25
  v_and_b32 v13, 0xffff0000, v89
  v_fmac_f32 v8, v10, v11
  v_fmac_f32 v9, v12, v13
  v_lshlrev_b32 v10, 16, v26
  v_lshlrev_b32 v11, 16, v90
  v_and_b32 v12, 0xffff0000, v26
  v_and_b32 v13, 0xffff0000, v90
  v_fmac_f32 v8, v10, v11
  v_fmac_f32 v9, v12, v13
  v_lshlrev_b32 v10, 16, v27
  v_lshlrev_b32 v11, 16, v91
  v_and_b32 v12, 0xffff0000, v27
  v_and_b32 v13, 0xffff0000, v91
  v_fmac_f32 v8, v10, v11
  v_fmac_f32 v9, v12, v13
  v_lshlrev_b32 v10, 16, v28
  v_lshlrev_b32 v11, 16, v92
  v_and_b32 v12, 0xffff0000, v28
  v_and_b32 v13, 0xffff0000, v92
  v_fmac_f32 v8, v10, v11
  v_fmac_f32 v9, v12, v13
  v_lshlrev_b32 v10, 16, v29
  v_lshlrev_b32 v11, 16, v93
  v_and_b32 v12, 0xffff0000, v29
  v_and_b32 v13, 0xffff0000, v93
  v_fmac_f32 v8, v10, v11
  v_fmac_f32 v9, v12, v13
  v_lshlrev_b32 v10, 16, v30
  v_lshlrev_b32 v11, 16, v94
  v_and_b32 v12, 0xffff0000, v30
  v_and_b32 v13, 0xffff0000, v94
  v_fmac_f32 v8, v10, v11
  v_fmac_f32 v9, v12, v13
  v_lshlrev_b32 v10, 16, v31
  v_lshlrev_b32 v11, 16, v95
  v_and_b32 v12, 0xffff0000, v31
  v_and_b32 v13, 0xffff0000, v95
  v_fmac_f32 v8, v10, v11
  v_fmac_f32 v9, v12, v13
  v_lshlrev_b32 v10, 16, v32
  v_lshlrev_b32 v11, 16, v96
  v_and_b32 v12, 0xffff0000, v32
  v_and_b32 v13, 0xffff0000, v96
  v_fmac_f32 v8, v10, v11
  v_fmac_f32 v9, v12, v13
  v_lshlrev_b32 v10, 16, v33
  v_lshlrev_b32 v11, 16, v97
  v_and_b32 v12, 0xffff0000, v33
  v_and_b32 v13, 0xffff0000, v97
  v_fmac_f32 v8, v10, v11
  v_fmac_f32 v9, v12, v13
  v_lshlrev_b32 v10, 16, v34
  v_lshlrev_b32 v11, 16, v98
  v_and_b32 v12, 0xffff0000, v34
  v_and_b32 v13, 0xffff0000, v98
  v_fmac_f32 v8, v10, v11
  v_fmac_f32 v9, v12, v13
  v_lshlrev_b32 v10, 16, v35
  v_lshlrev_b32 v11, 16, v99
  v_and_b32 v12, 0xffff0000, v35
  v_and_b32 v13, 0xffff0000, v99
  v_fmac_f32 v8, v10, v11
  v_fmac_f32 v9, v12, v13
  v_lshlrev_b32 v10, 16, v36
  v_lshlrev_b32 v11, 16, v100
  v_and_b32 v12, 0xffff0000, v36
  v_and_b32 v13, 0xffff0000, v100
  v_fmac_f32 v8, v10, v11
  v_fmac_f32 v9, v12, v13
  v_lshlrev_b32 v10, 16, v37
  v_lshlrev_b32 v11, 16, v101
  v_and_b32 v12, 0xffff0000, v37
  v_and_b32 v13, 0xffff0000, v101
  v_fmac_f32 v8, v10, v11
  v_fmac_f32 v9, v12, v13
  v_lshlrev_b32 v10, 16, v38
  v_lshlrev_b32 v11, 16, v102
  v_and_b32 v12, 0xffff0000, v38
  v_and_b32 v13, 0xffff0000, v102
  v_fmac_f32 v8, v10, v11
  v_fmac_f32 v9, v12, v13
  v_lshlrev_b32 v10, 16, v39
  v_lshlrev_b32 v11, 16, v103
  v_and_b32 v12, 0xffff0000, v39
  v_and_b32 v13, 0xffff0000, v103
  v_fmac_f32 v8, v10, v11
  v_fmac_f32 v9, v12, v13
  v_lshlrev_b32 v10, 16, v40
  v_lshlrev_b32 v11, 16, v104
  v_and_b32 v12, 0xffff0000, v40
  v_and_b32 v13, 0xffff0000, v104
  v_fmac_f32 v8, v10, v11
  v_fmac_f32 v9, v12, v13
  v_lshlrev_b32 v10, 16, v41
  v_lshlrev_b32 v11, 16, v105
  v_and_b32 v12, 0xffff0000, v41
  v_and_b32 v13, 0xffff0000, v105
  v_fmac_f32 v8, v10, v11
  v_fmac_f32 v9, v12, v13
  v_lshlrev_b32 v10, 16, v42
  v_lshlrev_b32 v11, 16, v106
  v_and_b32 v12, 0xffff0000, v42
  v_and_b32 v13, 0xffff0000, v106
  v_fmac_f32 v8, v10, v11
  v_fmac_f32 v9, v12, v13
  v_lshlrev_b32 v10, 16, v43
  v_lshlrev_b32 v11, 16, v107
  v_and_b32 v12, 0xffff0000, v43
  v_and_b32 v13, 0xffff0000, v107
  v_fmac_f32 v8, v10, v11
  v_fmac_f32 v9, v12, v13
  v_lshlrev_b32 v10, 16, v44
  v_lshlrev_b32 v11, 16, v108
  v_and_b32 v12, 0xffff0000, v44
  v_and_b32 v13, 0xffff0000, v108
  v_fmac_f32 v8, v10, v11
  v_fmac_f32 v9, v12, v13
  v_lshlrev_b32 v10, 16, v45
  v_lshlrev_b32 v11, 16, v109
  v_and_b32 v12, 0xffff0000, v45
  v_and_b32 v13, 0xffff0000, v109
  v_fmac_f32 v8, v10, v11
  v_fmac_f32 v9, v12, v13
  v_lshlrev_b32 v10, 16, v46
  v_lshlrev_b32 v11, 16, v110
  v_and_b32 v12, 0xffff0000, v46
  v_and_b32 v13, 0xffff0000, v110
  v_fmac_f32 v8, v10, v11
  v_fmac_f32 v9, v12, v13
  v_lshlrev_b32 v10, 16, v47
  v_lshlrev_b32 v11, 16, v111
  v_and_b32 v12, 0xffff0000, v47
  v_and_b32 v13, 0xffff0000, v111
  v_fmac_f32 v8, v10, v11
  v_fmac_f32 v9, v12, v13
  v_lshlrev_b32 v10, 16, v48
  v_lshlrev_b32 v11, 16, v112
  v_and_b32 v12, 0xffff0000, v48
  v_and_b32 v13, 0xffff0000, v112
  v_fmac_f32 v8, v10, v11
  v_fmac_f32 v9, v12, v13
  v_lshlrev_b32 v10, 16, v49
  v_lshlrev_b32 v11, 16, v113
  v_and_b32 v12, 0xffff0000, v49
  v_and_b32 v13, 0xffff0000, v113
  v_fmac_f32 v8, v10, v11
  v_fmac_f32 v9, v12, v13
  v_lshlrev_b32 v10, 16, v50
  v_lshlrev_b32 v11, 16, v114
  v_and_b32 v12, 0xffff0000, v50
  v_and_b32 v13, 0xffff0000, v114
  v_fmac_f32 v8, v10, v11
  v_fmac_f32 v9, v12, v13
  v_lshlrev_b32 v10, 16, v51
  v_lshlrev_b32 v11, 16, v115
  v_and_b32 v12, 0xffff0000, v51
  v_and_b32 v13, 0xffff0000, v115
  v_fmac_f32 v8, v10, v11
  v_fmac_f32 v9, v12, v13
  v_lshlrev_b32 v10, 16, v52
  v_lshlrev_b32 v11, 16, v116
  v_and_b32 v12, 0xffff0000, v52
  v_and_b32 v13, 0xffff0000, v116
  v_fmac_f32 v8, v10, v11
  v_fmac_f32 v9, v12, v13
  v_lshlrev_b32 v10, 16, v53
  v_lshlrev_b32 v11, 16, v117
  v_and_b32 v12, 0xffff0000, v53
  v_and_b32 v13, 0xffff0000, v117
  v_fmac_f32 v8, v10, v11
  v_fmac_f32 v9, v12, v13
  v_lshlrev_b32 v10, 16, v54
  v_lshlrev_b32 v11, 16, v118
  v_and_b32 v12, 0xffff0000, v54
  v_and_b32 v13, 0xffff0000, v118
  v_fmac_f32 v8, v10, v11
  v_fmac_f32 v9, v12, v13
  v_lshlrev_b32 v10, 16, v55
  v_lshlrev_b32 v11, 16, v119
  v_and_b32 v12, 0xffff0000, v55
  v_and_b32 v13, 0xffff0000, v119
  v_fmac_f32 v8, v10, v11
  v_fmac_f32 v9, v12, v13
  v_lshlrev_b32 v10, 16, v56
  v_lshlrev_b32 v11, 16, v120
  v_and_b32 v12, 0xffff0000, v56
  v_and_b32 v13, 0xffff0000, v120
  v_fmac_f32 v8, v10, v11
  v_fmac_f32 v9, v12, v13
  v_lshlrev_b32 v10, 16, v57
  v_lshlrev_b32 v11, 16, v121
  v_and_b32 v12, 0xffff0000, v57
  v_and_b32 v13, 0xffff0000, v121
  v_fmac_f32 v8, v10, v11
  v_fmac_f32 v9, v12, v13
  v_lshlrev_b32 v10, 16, v58
  v_lshlrev_b32 v11, 16, v122
  v_and_b32 v12, 0xffff0000, v58
  v_and_b32 v13, 0xffff0000, v122
  v_fmac_f32 v8, v10, v11
  v_fmac_f32 v9, v12, v13
  v_lshlrev_b32 v10, 16, v59
  v_lshlrev_b32 v11, 16, v123
  v_and_b32 v12, 0xffff0000, v59
  v_and_b32 v13, 0xffff0000, v123
  v_fmac_f32 v8, v10, v11
  v_fmac_f32 v9, v12, v13
  v_lshlrev_b32 v10, 16, v60
  v_lshlrev_b32 v11, 16, v124
  v_and_b32 v12, 0xffff0000, v60
  v_and_b32 v13, 0xffff0000, v124
  v_fmac_f32 v8, v10, v11
  v_fmac_f32 v9, v12, v13
  v_lshlrev_b32 v10, 16, v61
  v_lshlrev_b32 v11, 16, v125
  v_and_b32 v12, 0xffff0000, v61
  v_and_b32 v13, 0xffff0000, v125
  v_fmac_f32 v8, v10, v11
  v_fmac_f32 v9, v12, v13
  v_lshlrev_b32 v10, 16, v62
  v_lshlrev_b32 v11, 16, v126
  v_and_b32 v12, 0xffff0000, v62
  v_and_b32 v13, 0xffff0000, v126
  v_fmac_f32 v8, v10, v11
  v_fmac_f32 v9, v12, v13
  v_lshlrev_b32 v10, 16, v63
  v_lshlrev_b32 v11, 16, v127
  v_and_b32 v12, 0xffff0000, v63
  v_and_b32 v13, 0xffff0000, v127
  v_fmac_f32 v8, v10, v11
  v_fmac_f32 v9, v12, v13
  v_lshlrev_b32 v10, 16, v64
  v_lshlrev_b32 v11, 16, v128
  v_and_b32 v12, 0xffff0000, v64
  v_and_b32 v13, 0xffff0000, v128
  v_fmac_f32 v8, v10, v11
  v_fmac_f32 v9, v12, v13
  v_lshlrev_b32 v10, 16, v65
  v_lshlrev_b32 v11, 16, v129
  v_and_b32 v12, 0xffff0000, v65
  v_and_b32 v13, 0xffff0000, v129
  v_fmac_f32 v8, v10, v11
  v_fmac_f32 v9, v12, v13
  v_lshlrev_b32 v10, 16, v66
  v_lshlrev_b32 v11, 16, v130
  v_and_b32 v12, 0xffff0000, v66
  v_and_b32 v13, 0xffff0000, v130
  v_fmac_f32 v8, v10, v11
  v_fmac_f32 v9, v12, v13
  v_lshlrev_b32 v10, 16, v67
  v_lshlrev_b32 v11, 16, v131
  v_and_b32 v12, 0xffff0000, v67
  v_and_b32 v13, 0xffff0000, v131
  v_fmac_f32 v8, v10, v11
  v_fmac_f32 v9, v12, v13
  v_lshlrev_b32 v10, 16, v68
  v_lshlrev_b32 v11, 16, v132
  v_and_b32 v12, 0xffff0000, v68
  v_and_b32 v13, 0xffff0000, v132
  v_fmac_f32 v8, v10, v11
  v_fmac_f32 v9, v12, v13
  v_lshlrev_b32 v10, 16, v69
  v_lshlrev_b32 v11, 16, v133
  v_and_b32 v12, 0xffff0000, v69
  v_and_b32 v13, 0xffff0000, v133
  v_fmac_f32 v8, v10, v11
  v_fmac_f32 v9, v12, v13
  v_lshlrev_b32 v10, 16, v70
  v_lshlrev_b32 v11, 16, v134
  v_and_b32 v12, 0xffff0000, v70
  v_and_b32 v13, 0xffff0000, v134
  v_fmac_f32 v8, v10, v11
  v_fmac_f32 v9, v12, v13
  v_lshlrev_b32 v10, 16, v71
  v_lshlrev_b32 v11, 16, v135
  v_and_b32 v12, 0xffff0000, v71
  v_and_b32 v13, 0xffff0000, v135
  v_fmac_f32 v8, v10, v11
  v_fmac_f32 v9, v12, v13
  v_add_f32 v8, v8, v9
  v_mov_b32 v9, v8
  s_nop 1
  v_permlane16_swap_b32 v8, v9
  v_add_f32 v8, v8, v9
  v_mov_b32 v9, v8
  s_nop 1
  v_permlane32_swap_b32 v8, v9
  v_add_f32 v8, v8, v9
  v_mul_f32 v8, 0xbfb8aa3b, v8
  v_exp_f32 v8, v8
  s_nop 0
  v_add_f32 v8, 1.0, v8
  v_rcp_f32 v8, v8
  s_lshl_b32 s13, s12, 6
  s_add_u32 s13, s13, 100999168
  v_lshlrev_b32 v5, 2, v3
  v_add_u32 v5, s13, v5
  s_mov_b64 exec, 0xffff
  global_store_dword v5, v8, s[8:9] sc0 sc1
  s_mov_b64 exec, -1
  s_nop 1
  s_branch WSE_70
K1N_113:
  s_sub_u32 s2, s2, 32
  s_cmp_ge_u32 s2, 7
  s_nop 1
  s_cbranch_scc1 K1N_114
  s_load_dwordx2 s[14:15], s[0:1], 16
  s_lshl_b32 s12, s2, 2
  s_add_u32 s12, s12, s10
  v_and_b32 v3, 15, v2
  v_lshrrev_b32 v4, 4, v2
  v_mul_u32_u24 v5, 3584, v4
  s_lshl_b32 s13, s12, 5
  v_lshl_add_u32 v5, v3, 1, v5
  v_add_u32 v5, s13, v5
  v_add_u32 v7, 14336, v5
  s_lshl_b32 s13, s12, 14
  v_lshlrev_b32 v6, 4, v2
  v_add_u32 v6, s13, v6
  v_add_u32 v6, 16056320, v6
  v_mov_b32 v80, 0
  v_mov_b32 v81, 0
  v_mov_b32 v82, 0
  v_mov_b32 v83, 0
  v_mov_b32 v84, 0
  v_mov_b32 v85, 0
  v_mov_b32 v86, 0
  v_mov_b32 v87, 0
  v_mov_b32 v88, 0
  v_mov_b32 v89, 0
  v_mov_b32 v90, 0
  v_mov_b32 v91, 0
  v_mov_b32 v92, 0
  v_mov_b32 v93, 0
  v_mov_b32 v94, 0
  v_mov_b32 v95, 0
  v_mov_b32 v96, 0
  v_mov_b32 v97, 0
  v_mov_b32 v98, 0
  v_mov_b32 v99, 0
  v_mov_b32 v100, 0
  v_mov_b32 v101, 0
  v_mov_b32 v102, 0
  v_mov_b32 v103, 0
  v_mov_b32 v104, 0
  v_mov_b32 v105, 0
  v_mov_b32 v106, 0
  v_mov_b32 v107, 0
  v_mov_b32 v108, 0
  v_mov_b32 v109, 0
  v_mov_b32 v110, 0
  v_mov_b32 v111, 0
  v_mov_b32 v112, 0
  v_mov_b32 v113, 0
  v_mov_b32 v114, 0
  v_mov_b32 v115, 0
  v_mov_b32 v116, 0
  v_mov_b32 v117, 0
  v_mov_b32 v118, 0
  v_mov_b32 v119, 0
  v_mov_b32 v120, 0
  v_mov_b32 v121, 0
  v_mov_b32 v122, 0
  v_mov_b32 v123, 0
  v_mov_b32 v124, 0
  v_mov_b32 v125, 0
  v_mov_b32 v126, 0
  v_mov_b32 v127, 0
  v_mov_b32 v128, 0
  v_mov_b32 v129, 0
  v_mov_b32 v130, 0
  v_mov_b32 v131, 0
  v_mov_b32 v132, 0
  v_mov_b32 v133, 0
  v_mov_b32 v134, 0
  v_mov_b32 v135, 0
  v_mov_b32 v136, 0
  v_mov_b32 v137, 0
  v_mov_b32 v138, 0
  v_mov_b32 v139, 0
  v_mov_b32 v140, 0
  v_mov_b32 v141, 0
  v_mov_b32 v142, 0
  v_mov_b32 v143, 0
  v_mov_b32 v144, 0
  v_mov_b32 v145, 0
  v_mov_b32 v146, 0
  v_mov_b32 v147, 0
  v_mov_b32 v148, 0
  v_mov_b32 v149, 0
  v_mov_b32 v150, 0
  v_mov_b32 v151, 0
  v_mov_b32 v152, 0
  v_mov_b32 v153, 0
  v_mov_b32 v154, 0
  v_mov_b32 v155, 0
  v_mov_b32 v156, 0
  v_mov_b32 v157, 0
  v_mov_b32 v158, 0
  v_mov_b32 v159, 0
  v_mov_b32 v160, 0
  v_mov_b32 v161, 0
  v_mov_b32 v162, 0
  v_mov_b32 v163, 0
  v_mov_b32 v164, 0
  v_mov_b32 v165, 0
  v_mov_b32 v166, 0
  v_mov_b32 v167, 0
  v_mov_b32 v168, 0
  v_mov_b32 v169, 0
  v_mov_b32 v170, 0
  v_mov_b32 v171, 0
  v_mov_b32 v172, 0
  v_mov_b32 v173, 0
  v_mov_b32 v174, 0
  v_mov_b32 v175, 0
  v_mov_b32 v176, 0
  v_mov_b32 v177, 0
  v_mov_b32 v178, 0
  v_mov_b32 v179, 0
  v_mov_b32 v180, 0
  v_mov_b32 v181, 0
  v_mov_b32 v182, 0
  v_mov_b32 v183, 0
  v_mov_b32 v184, 0
  v_mov_b32 v185, 0
  v_mov_b32 v186, 0
  v_mov_b32 v187, 0
  v_mov_b32 v188, 0
  v_mov_b32 v189, 0
  v_mov_b32 v190, 0
  v_mov_b32 v191, 0
  v_mov_b32 v192, 0
  v_mov_b32 v193, 0
  v_mov_b32 v194, 0
  v_mov_b32 v195, 0
  v_mov_b32 v196, 0
  v_mov_b32 v197, 0
  v_mov_b32 v198, 0
  v_mov_b32 v199, 0
  v_mov_b32 v200, 0
  v_mov_b32 v201, 0
  v_mov_b32 v202, 0
  v_mov_b32 v203, 0
  v_mov_b32 v204, 0
  v_mov_b32 v205, 0
  v_mov_b32 v206, 0
  v_mov_b32 v207, 0
  s_waitcnt lgkmcnt(0)
  s_mov_b32 s16, -1
  s_mov_b32 s17, 0xffff
  global_load_ushort v80, v5, s[14:15] offset:0
  global_load_ushort v81, v5, s[14:15] offset:896
  global_load_ushort v82, v5, s[14:15] offset:1792
  global_load_ushort v83, v5, s[14:15] offset:2688
  s_mov_b64 exec, s[16:17]
  global_load_ushort v84, v7, s[14:15] offset:0
  global_load_ushort v85, v7, s[14:15] offset:896
  global_load_ushort v86, v7, s[14:15] offset:1792
  global_load_ushort v87, v7, s[14:15] offset:2688
  s_mov_b64 exec, -1
  v_add_u32 v5, 25088, v5
  v_add_u32 v7, 25088, v7
  global_load_ushort v88, v5, s[14:15] offset:0
  global_load_ushort v89, v5, s[14:15] offset:896
  global_load_ushort v90, v5, s[14:15] offset:1792
  global_load_ushort v91, v5, s[14:15] offset:2688
  s_mov_b64 exec, s[16:17]
  global_load_ushort v92, v7, s[14:15] offset:0
  global_load_ushort v93, v7, s[14:15] offset:896
  global_load_ushort v94, v7, s[14:15] offset:1792
  global_load_ushort v95, v7, s[14:15] offset:2688
  s_mov_b64 exec, -1
  v_add_u32 v5, 25088, v5
  v_add_u32 v7, 25088, v7
  global_load_ushort v96, v5, s[14:15] offset:0
  global_load_ushort v97, v5, s[14:15] offset:896
  global_load_ushort v98, v5, s[14:15] offset:1792
  global_load_ushort v99, v5, s[14:15] offset:2688
  s_mov_b64 exec, s[16:17]
  global_load_ushort v100, v7, s[14:15] offset:0
  global_load_ushort v101, v7, s[14:15] offset:896
  global_load_ushort v102, v7, s[14:15] offset:1792
  global_load_ushort v103, v7, s[14:15] offset:2688
  s_mov_b64 exec, -1
  v_add_u32 v5, 25088, v5
  v_add_u32 v7, 25088, v7
  global_load_ushort v104, v5, s[14:15] offset:0
  global_load_ushort v105, v5, s[14:15] offset:896
  global_load_ushort v106, v5, s[14:15] offset:1792
  global_load_ushort v107, v5, s[14:15] offset:2688
  s_mov_b64 exec, s[16:17]
  global_load_ushort v108, v7, s[14:15] offset:0
  global_load_ushort v109, v7, s[14:15] offset:896
  global_load_ushort v110, v7, s[14:15] offset:1792
  global_load_ushort v111, v7, s[14:15] offset:2688
  s_mov_b64 exec, -1
  v_add_u32 v5, 25088, v5
  v_add_u32 v7, 25088, v7
  s_waitcnt vmcnt(16)
  global_load_ushort v112, v5, s[14:15] offset:0
  global_load_ushort v113, v5, s[14:15] offset:896
  global_load_ushort v114, v5, s[14:15] offset:1792
  global_load_ushort v115, v5, s[14:15] offset:2688
  s_mov_b64 exec, s[16:17]
  global_load_ushort v116, v7, s[14:15] offset:0
  global_load_ushort v117, v7, s[14:15] offset:896
  global_load_ushort v118, v7, s[14:15] offset:1792
  global_load_ushort v119, v7, s[14:15] offset:2688
  s_mov_b64 exec, -1
  v_add_u32 v5, 25088, v5
  v_add_u32 v7, 25088, v7
  global_load_ushort v120, v5, s[14:15] offset:0
  global_load_ushort v121, v5, s[14:15] offset:896
  global_load_ushort v122, v5, s[14:15] offset:1792
  global_load_ushort v123, v5, s[14:15] offset:2688
  s_mov_b64 exec, s[16:17]
  global_load_ushort v124, v7, s[14:15] offset:0
  global_load_ushort v125, v7, s[14:15] offset:896
  global_load_ushort v126, v7, s[14:15] offset:1792
  global_load_ushort v127, v7, s[14:15] offset:2688
  s_mov_b64 exec, -1
  v_add_u32 v5, 25088, v5
  v_add_u32 v7, 25088, v7
  global_load_ushort v128, v5, s[14:15] offset:0
  global_load_ushort v129, v5, s[14:15] offset:896
  global_load_ushort v130, v5, s[14:15] offset:1792
  global_load_ushort v131, v5, s[14:15] offset:2688
  s_mov_b64 exec, s[16:17]
  global_load_ushort v132, v7, s[14:15] offset:0
  global_load_ushort v133, v7, s[14:15] offset:896
  global_load_ushort v134, v7, s[14:15] offset:1792
  global_load_ushort v135, v7, s[14:15] offset:2688
  s_mov_b64 exec, -1
  v_add_u32 v5, 25088, v5
  v_add_u32 v7, 25088, v7
  global_load_ushort v136, v5, s[14:15] offset:0
  global_load_ushort v137, v5, s[14:15] offset:896
  global_load_ushort v138, v5, s[14:15] offset:1792
  global_load_ushort v139, v5, s[14:15] offset:2688
  s_mov_b64 exec, s[16:17]
  global_load_ushort v140, v7, s[14:15] offset:0
  global_load_ushort v141, v7, s[14:15] offset:896
  global_load_ushort v142, v7, s[14:15] offset:1792
  global_load_ushort v143, v7, s[14:15] offset:2688
  s_mov_b64 exec, -1
  v_add_u32 v5, 25088, v5
  v_add_u32 v7, 25088, v7
  s_waitcnt vmcnt(16)
  global_load_ushort v144, v5, s[14:15] offset:0
  global_load_ushort v145, v5, s[14:15] offset:896
  global_load_ushort v146, v5, s[14:15] offset:1792
  global_load_ushort v147, v5, s[14:15] offset:2688
  s_mov_b64 exec, s[16:17]
  global_load_ushort v148, v7, s[14:15] offset:0
  global_load_ushort v149, v7, s[14:15] offset:896
  global_load_ushort v150, v7, s[14:15] offset:1792
  global_load_ushort v151, v7, s[14:15] offset:2688
  s_mov_b64 exec, -1
  v_add_u32 v5, 25088, v5
  v_add_u32 v7, 25088, v7
  global_load_ushort v152, v5, s[14:15] offset:0
  global_load_ushort v153, v5, s[14:15] offset:896
  global_load_ushort v154, v5, s[14:15] offset:1792
  global_load_ushort v155, v5, s[14:15] offset:2688
  s_mov_b64 exec, s[16:17]
  global_load_ushort v156, v7, s[14:15] offset:0
  global_load_ushort v157, v7, s[14:15] offset:896
  global_load_ushort v158, v7, s[14:15] offset:1792
  global_load_ushort v159, v7, s[14:15] offset:2688
  s_mov_b64 exec, -1
  v_add_u32 v5, 25088, v5
  v_add_u32 v7, 25088, v7
  global_load_ushort v160, v5, s[14:15] offset:0
  global_load_ushort v161, v5, s[14:15] offset:896
  global_load_ushort v162, v5, s[14:15] offset:1792
  global_load_ushort v163, v5, s[14:15] offset:2688
  s_mov_b64 exec, s[16:17]
  global_load_ushort v164, v7, s[14:15] offset:0
  global_load_ushort v165, v7, s[14:15] offset:896
  global_load_ushort v166, v7, s[14:15] offset:1792
  global_load_ushort v167, v7, s[14:15] offset:2688
  s_mov_b64 exec, -1
  v_add_u32 v5, 25088, v5
  v_add_u32 v7, 25088, v7
  global_load_ushort v168, v5, s[14:15] offset:0
  global_load_ushort v169, v5, s[14:15] offset:896
  global_load_ushort v170, v5, s[14:15] offset:1792
  global_load_ushort v171, v5, s[14:15] offset:2688
  s_mov_b64 exec, s[16:17]
  global_load_ushort v172, v7, s[14:15] offset:0
  global_load_ushort v173, v7, s[14:15] offset:896
  global_load_ushort v174, v7, s[14:15] offset:1792
  global_load_ushort v175, v7, s[14:15] offset:2688
  s_mov_b64 exec, -1
  v_add_u32 v5, 25088, v5
  v_add_u32 v7, 25088, v7
  s_waitcnt vmcnt(16)
  global_load_ushort v176, v5, s[14:15] offset:0
  global_load_ushort v177, v5, s[14:15] offset:896
  global_load_ushort v178, v5, s[14:15] offset:1792
  global_load_ushort v179, v5, s[14:15] offset:2688
  s_mov_b64 exec, s[16:17]
  global_load_ushort v180, v7, s[14:15] offset:0
  global_load_ushort v181, v7, s[14:15] offset:896
  global_load_ushort v182, v7, s[14:15] offset:1792
  global_load_ushort v183, v7, s[14:15] offset:2688
  s_mov_b64 exec, -1
  v_add_u32 v5, 25088, v5
  v_add_u32 v7, 25088, v7
  global_load_ushort v184, v5, s[14:15] offset:0
  global_load_ushort v185, v5, s[14:15] offset:896
  global_load_ushort v186, v5, s[14:15] offset:1792
  global_load_ushort v187, v5, s[14:15] offset:2688
  s_mov_b64 exec, s[16:17]
  global_load_ushort v188, v7, s[14:15] offset:0
  global_load_ushort v189, v7, s[14:15] offset:896
  global_load_ushort v190, v7, s[14:15] offset:1792
  global_load_ushort v191, v7, s[14:15] offset:2688
  s_mov_b64 exec, -1
  v_add_u32 v5, 25088, v5
  v_add_u32 v7, 25088, v7
  global_load_ushort v192, v5, s[14:15] offset:0
  global_load_ushort v193, v5, s[14:15] offset:896
  global_load_ushort v194, v5, s[14:15] offset:1792
  global_load_ushort v195, v5, s[14:15] offset:2688
  s_mov_b64 exec, s[16:17]
  global_load_ushort v196, v7, s[14:15] offset:0
  global_load_ushort v197, v7, s[14:15] offset:896
  global_load_ushort v198, v7, s[14:15] offset:1792
  global_load_ushort v199, v7, s[14:15] offset:2688
  s_mov_b64 exec, -1
  v_add_u32 v5, 25088, v5
  v_add_u32 v7, 25088, v7
  global_load_ushort v200, v5, s[14:15] offset:0
  global_load_ushort v201, v5, s[14:15] offset:896
  global_load_ushort v202, v5, s[14:15] offset:1792
  global_load_ushort v203, v5, s[14:15] offset:2688
  s_mov_b64 exec, s[16:17]
  global_load_ushort v204, v7, s[14:15] offset:0
  global_load_ushort v205, v7, s[14:15] offset:896
  global_load_ushort v206, v7, s[14:15] offset:1792
  global_load_ushort v207, v7, s[14:15] offset:2688
  s_mov_b64 exec, -1
  s_waitcnt vmcnt(16)
  s_waitcnt vmcnt(0)
  v_lshl_or_b32 v16, v81, 16, v80
  v_lshl_or_b32 v17, v83, 16, v82
  v_lshl_or_b32 v18, v85, 16, v84
  v_lshl_or_b32 v19, v87, 16, v86
  v_lshl_or_b32 v20, v89, 16, v88
  v_lshl_or_b32 v21, v91, 16, v90
  v_lshl_or_b32 v22, v93, 16, v92
  v_lshl_or_b32 v23, v95, 16, v94
  v_lshl_or_b32 v24, v97, 16, v96
  v_lshl_or_b32 v25, v99, 16, v98
  v_lshl_or_b32 v26, v101, 16, v100
  v_lshl_or_b32 v27, v103, 16, v102
  v_lshl_or_b32 v28, v105, 16, v104
  v_lshl_or_b32 v29, v107, 16, v106
  v_lshl_or_b32 v30, v109, 16, v108
  v_lshl_or_b32 v31, v111, 16, v110
  v_lshl_or_b32 v32, v113, 16, v112
  v_lshl_or_b32 v33, v115, 16, v114
  v_lshl_or_b32 v34, v117, 16, v116
  v_lshl_or_b32 v35, v119, 16, v118
  v_lshl_or_b32 v36, v121, 16, v120
  v_lshl_or_b32 v37, v123, 16, v122
  v_lshl_or_b32 v38, v125, 16, v124
  v_lshl_or_b32 v39, v127, 16, v126
  v_lshl_or_b32 v40, v129, 16, v128
  v_lshl_or_b32 v41, v131, 16, v130
  v_lshl_or_b32 v42, v133, 16, v132
  v_lshl_or_b32 v43, v135, 16, v134
  v_lshl_or_b32 v44, v137, 16, v136
  v_lshl_or_b32 v45, v139, 16, v138
  v_lshl_or_b32 v46, v141, 16, v140
  v_lshl_or_b32 v47, v143, 16, v142
  v_lshl_or_b32 v48, v145, 16, v144
  v_lshl_or_b32 v49, v147, 16, v146
  v_lshl_or_b32 v50, v149, 16, v148
  v_lshl_or_b32 v51, v151, 16, v150
  v_lshl_or_b32 v52, v153, 16, v152
  v_lshl_or_b32 v53, v155, 16, v154
  v_lshl_or_b32 v54, v157, 16, v156
  v_lshl_or_b32 v55, v159, 16, v158
  v_lshl_or_b32 v56, v161, 16, v160
  v_lshl_or_b32 v57, v163, 16, v162
  v_lshl_or_b32 v58, v165, 16, v164
  v_lshl_or_b32 v59, v167, 16, v166
  v_lshl_or_b32 v60, v169, 16, v168
  v_lshl_or_b32 v61, v171, 16, v170
  v_lshl_or_b32 v62, v173, 16, v172
  v_lshl_or_b32 v63, v175, 16, v174
  v_lshl_or_b32 v64, v177, 16, v176
  v_lshl_or_b32 v65, v179, 16, v178
  v_lshl_or_b32 v66, v181, 16, v180
  v_lshl_or_b32 v67, v183, 16, v182
  v_lshl_or_b32 v68, v185, 16, v184
  v_lshl_or_b32 v69, v187, 16, v186
  v_lshl_or_b32 v70, v189, 16, v188
  v_lshl_or_b32 v71, v191, 16, v190
  v_lshl_or_b32 v72, v193, 16, v192
  v_lshl_or_b32 v73, v195, 16, v194
  v_lshl_or_b32 v74, v197, 16, v196
  v_lshl_or_b32 v75, v199, 16, v198
  v_lshl_or_b32 v76, v201, 16, v200
  v_lshl_or_b32 v77, v203, 16, v202
  v_lshl_or_b32 v78, v205, 16, v204
  v_lshl_or_b32 v79, v207, 16, v206
  global_store_dwordx4 v6, v[16:19], s[8:9] offset:0 sc0 sc1
  global_store_dwordx4 v6, v[20:23], s[8:9] offset:1024 sc0 sc1
  global_store_dwordx4 v6, v[24:27], s[8:9] offset:2048 sc0 sc1
  global_store_dwordx4 v6, v[28:31], s[8:9] offset:3072 sc0 sc1
  s_nop 1
  v_add_u32 v6, 4096, v6
  global_store_dwordx4 v6, v[32:35], s[8:9] offset:0 sc0 sc1
  global_store_dwordx4 v6, v[36:39], s[8:9] offset:1024 sc0 sc1
  global_store_dwordx4 v6, v[40:43], s[8:9] offset:2048 sc0 sc1
  global_store_dwordx4 v6, v[44:47], s[8:9] offset:3072 sc0 sc1
  s_nop 1
  v_add_u32 v6, 4096, v6
  global_store_dwordx4 v6, v[48:51], s[8:9] offset:0 sc0 sc1
  global_store_dwordx4 v6, v[52:55], s[8:9] offset:1024 sc0 sc1
  global_store_dwordx4 v6, v[56:59], s[8:9] offset:2048 sc0 sc1
  global_store_dwordx4 v6, v[60:63], s[8:9] offset:3072 sc0 sc1
  s_nop 1
  v_add_u32 v6, 4096, v6
  global_store_dwordx4 v6, v[64:67], s[8:9] offset:0 sc0 sc1
  global_store_dwordx4 v6, v[68:71], s[8:9] offset:1024 sc0 sc1
  global_store_dwordx4 v6, v[72:75], s[8:9] offset:2048 sc0 sc1
  global_store_dwordx4 v6, v[76:79], s[8:9] offset:3072 sc0 sc1
  s_nop 1
  v_add_u32 v6, 4096, v6
  s_nop 1
  s_branch WSE_70
K1N_114:
  s_sub_u32 s2, s2, 7
  s_nop 1
WSE_70:
  s_mov_b64 exec, -1
  s_waitcnt vmcnt(0) lgkmcnt(0)
  s_barrier
  s_lshl_b32 s12, s40, 2
  s_add_u32 s12, s12, 103367680
  v_mov_b32 v3, s12
  v_mov_b32 v4, 1
  global_store_dword v3, v4, s[8:9] sc0 sc1
  s_nop 1
  s_branch WLOOP_71
WTZ_79:
  s_mov_b32 s14, s40
  s_mul_i32 s19, s14, 458752
  s_mul_i32 s20, s10, 114688
  s_add_u32 s19, s19, s20
  v_lshlrev_b32 v110, 4, v2
  v_add_u32 v3, s19, v110
  s_mul_i32 s19, s10, 14336
  s_add_u32 s19, s19, 16384
  v_add_u32 v111, s19, v110
  s_add_u32 s20, s8, 8357888
  s_addc_u32 s21, s9, 0
  global_load_dwordx4 v[4:7], v3, s[20:21] offset:0
  global_load_dwordx4 v[8:11], v3, s[20:21] offset:1024
  global_load_dwordx4 v[12:15], v3, s[20:21] offset:2048
  global_load_dwordx4 v[16:19], v3, s[20:21] offset:3072
  s_add_u32 s20, s20, 4096
  s_addc_u32 s21, s21, 0
  global_load_dwordx4 v[20:23], v3, s[20:21] offset:0
  global_load_dwordx4 v[24:27], v3, s[20:21] offset:1024
  global_load_dwordx4 v[28:31], v3, s[20:21] offset:2048
  global_load_dwordx4 v[32:35], v3, s[20:21] offset:3072
  s_add_u32 s20, s20, 4096
  s_addc_u32 s21, s21, 0
  global_load_dwordx4 v[36:39], v3, s[20:21] offset:0
  global_load_dwordx4 v[40:43], v3, s[20:21] offset:1024
  global_load_dwordx4 v[44:47], v3, s[20:21] offset:2048
  global_load_dwordx4 v[48:51], v3, s[20:21] offset:3072
  s_add_u32 s20, s20, 4096
  s_addc_u32 s21, s21, 0
  global_load_dwordx4 v[52:55], v3, s[20:21] offset:0
  global_load_dwordx4 v[56:59], v3, s[20:21] offset:1024
  s_waitcnt vmcnt(13)
  ds_write_b128 v111, v[4:7] offset:0
  s_waitcnt vmcnt(12)
  ds_write_b128 v111, v[8:11] offset:1024
  s_waitcnt vmcnt(11)
  ds_write_b128 v111, v[12:15] offset:2048
  s_waitcnt vmcnt(10)
  ds_write_b128 v111, v[16:19] offset:3072
  s_waitcnt vmcnt(9)
  ds_write_b128 v111, v[20:23] offset:4096
  s_waitcnt vmcnt(8)
  ds_write_b128 v111, v[24:27] offset:5120
  s_waitcnt vmcnt(7)
  ds_write_b128 v111, v[28:31] offset:6144
  s_waitcnt vmcnt(6)
  ds_write_b128 v111, v[32:35] offset:7168
  s_waitcnt vmcnt(5)
  ds_write_b128 v111, v[36:39] offset:8192
  s_waitcnt vmcnt(4)
  ds_write_b128 v111, v[40:43] offset:9216
  s_waitcnt vmcnt(3)
  ds_write_b128 v111, v[44:47] offset:10240
  s_waitcnt vmcnt(2)
  ds_write_b128 v111, v[48:51] offset:11264
  s_waitcnt vmcnt(1)
  ds_write_b128 v111, v[52:55] offset:12288
  s_waitcnt vmcnt(0)
  ds_write_b128 v111, v[56:59] offset:13312
  s_add_u32 s20, s8, 8257536
  s_addc_u32 s21, s9, 0
  global_load_dwordx4 a[0:3], v3, s[20:21] offset:0
  global_load_dwordx4 a[4:7], v3, s[20:21] offset:1024
  global_load_dwordx4 a[8:11], v3, s[20:21] offset:2048
  global_load_dwordx4 a[12:15], v3, s[20:21] offset:3072
  s_add_u32 s20, s20, 4096
  s_addc_u32 s21, s21, 0
  global_load_dwordx4 a[16:19], v3, s[20:21] offset:0
  global_load_dwordx4 a[20:23], v3, s[20:21] offset:1024
  global_load_dwordx4 a[24:27], v3, s[20:21] offset:2048
  global_load_dwordx4 a[28:31], v3, s[20:21] offset:3072
  s_add_u32 s20, s20, 4096
  s_addc_u32 s21, s21, 0
  global_load_dwordx4 a[32:35], v3, s[20:21] offset:0
  global_load_dwordx4 a[36:39], v3, s[20:21] offset:1024
  global_load_dwordx4 a[40:43], v3, s[20:21] offset:2048
  global_load_dwordx4 a[44:47], v3, s[20:21] offset:3072
  s_add_u32 s20, s20, 4096
  s_addc_u32 s21, s21, 0
  global_load_dwordx4 a[48:51], v3, s[20:21] offset:0
  global_load_dwordx4 a[52:55], v3, s[20:21] offset:1024
  s_waitcnt vmcnt(28)
  s_add_u32 s20, s8, 8286208
  s_addc_u32 s21, s9, 0
  global_load_dwordx4 a[56:59], v3, s[20:21] offset:0
  global_load_dwordx4 a[60:63], v3, s[20:21] offset:1024
  global_load_dwordx4 a[64:67], v3, s[20:21] offset:2048
  global_load_dwordx4 a[68:71], v3, s[20:21] offset:3072
  s_add_u32 s20, s20, 4096
  s_addc_u32 s21, s21, 0
  global_load_dwordx4 a[72:75], v3, s[20:21] offset:0
  global_load_dwordx4 a[76:79], v3, s[20:21] offset:1024
  global_load_dwordx4 a[80:83], v3, s[20:21] offset:2048
  global_load_dwordx4 a[84:87], v3, s[20:21] offset:3072
  s_add_u32 s20, s20, 4096
  s_addc_u32 s21, s21, 0
  global_load_dwordx4 a[88:91], v3, s[20:21] offset:0
  global_load_dwordx4 a[92:95], v3, s[20:21] offset:1024
  global_load_dwordx4 a[96:99], v3, s[20:21] offset:2048
  global_load_dwordx4 a[100:103], v3, s[20:21] offset:3072
  s_add_u32 s20, s20, 4096
  s_addc_u32 s21, s21, 0
  global_load_dwordx4 a[104:107], v3, s[20:21] offset:0
  global_load_dwordx4 a[108:111], v3, s[20:21] offset:1024
  s_waitcnt vmcnt(28)
  s_add_u32 s20, s8, 8271872
  s_addc_u32 s21, s9, 0
  global_load_dwordx4 a[112:115], v3, s[20:21] offset:0
  global_load_dwordx4 a[116:119], v3, s[20:21] offset:1024
  global_load_dwordx4 a[120:123], v3, s[20:21] offset:2048
  global_load_dwordx4 a[124:127], v3, s[20:21] offset:3072
  s_add_u32 s20, s20, 4096
  s_addc_u32 s21, s21, 0
  global_load_dwordx4 a[128:131], v3, s[20:21] offset:0
  global_load_dwordx4 a[132:135], v3, s[20:21] offset:1024
  global_load_dwordx4 a[136:139], v3, s[20:21] offset:2048
  global_load_dwordx4 a[140:143], v3, s[20:21] offset:3072
  s_add_u32 s20, s20, 4096
  s_addc_u32 s21, s21, 0
  global_load_dwordx4 a[144:147], v3, s[20:21] offset:0
  global_load_dwordx4 a[148:151], v3, s[20:21] offset:1024
  global_load_dwordx4 a[152:155], v3, s[20:21] offset:2048
  global_load_dwordx4 a[156:159], v3, s[20:21] offset:3072
  s_add_u32 s20, s20, 4096
  s_addc_u32 s21, s21, 0
  global_load_dwordx4 a[160:163], v3, s[20:21] offset:0
  global_load_dwordx4 a[164:167], v3, s[20:21] offset:1024
  s_waitcnt vmcnt(28)
  s_add_u32 s20, s8, 8300544
  s_addc_u32 s21, s9, 0
  global_load_dwordx4 a[168:171], v3, s[20:21] offset:0
  global_load_dwordx4 a[172:175], v3, s[20:21] offset:1024
  global_load_dwordx4 a[176:179], v3, s[20:21] offset:2048
  global_load_dwordx4 a[180:183], v3, s[20:21] offset:3072
  s_add_u32 s20, s20, 4096
  s_addc_u32 s21, s21, 0
  global_load_dwordx4 a[184:187], v3, s[20:21] offset:0
  global_load_dwordx4 a[188:191], v3, s[20:21] offset:1024
  global_load_dwordx4 a[192:195], v3, s[20:21] offset:2048
  global_load_dwordx4 a[196:199], v3, s[20:21] offset:3072
  s_add_u32 s20, s20, 4096
  s_addc_u32 s21, s21, 0
  global_load_dwordx4 a[200:203], v3, s[20:21] offset:0
  global_load_dwordx4 a[204:207], v3, s[20:21] offset:1024
  global_load_dwordx4 a[208:211], v3, s[20:21] offset:2048
  global_load_dwordx4 a[212:215], v3, s[20:21] offset:3072
  s_add_u32 s20, s20, 4096
  s_addc_u32 s21, s21, 0
  global_load_dwordx4 a[216:219], v3, s[20:21] offset:0
  global_load_dwordx4 a[220:223], v3, s[20:21] offset:1024
  s_waitcnt vmcnt(28)
  s_add_u32 s20, s8, 8314880
  s_addc_u32 s21, s9, 0
  global_load_dwordx4 a[224:227], v3, s[20:21] offset:0
  global_load_dwordx4 a[228:231], v3, s[20:21] offset:1024
  global_load_dwordx4 a[232:235], v3, s[20:21] offset:2048
  global_load_dwordx4 a[236:239], v3, s[20:21] offset:3072
  s_add_u32 s20, s20, 4096
  s_addc_u32 s21, s21, 0
  global_load_dwordx4 a[240:243], v3, s[20:21] offset:0
  global_load_dwordx4 a[244:247], v3, s[20:21] offset:1024
  global_load_dwordx4 a[248:251], v3, s[20:21] offset:2048
  global_load_dwordx4 a[252:255], v3, s[20:21] offset:3072
  s_add_u32 s20, s20, 4096
  s_addc_u32 s21, s21, 0
  global_load_dwordx4 v[120:123], v3, s[20:21] offset:0
  global_load_dwordx4 v[124:127], v3, s[20:21] offset:1024
  global_load_dwordx4 v[128:131], v3, s[20:21] offset:2048
  global_load_dwordx4 v[132:135], v3, s[20:21] offset:3072
  s_add_u32 s20, s20, 4096
  s_addc_u32 s21, s21, 0
  global_load_dwordx4 v[136:139], v3, s[20:21] offset:0
  global_load_dwordx4 v[140:143], v3, s[20:21] offset:1024
  s_waitcnt vmcnt(28)
  s_add_u32 s20, s8, 8343552
  s_addc_u32 s21, s9, 0
  global_load_dwordx4 v[144:147], v3, s[20:21] offset:0
  global_load_dwordx4 v[148:151], v3, s[20:21] offset:1024
  global_load_dwordx4 v[152:155], v3, s[20:21] offset:2048
  global_load_dwordx4 v[156:159], v3, s[20:21] offset:3072
  s_add_u32 s20, s20, 4096
  s_addc_u32 s21, s21, 0
  global_load_dwordx4 v[160:163], v3, s[20:21] offset:0
  global_load_dwordx4 v[164:167], v3, s[20:21] offset:1024
  global_load_dwordx4 v[168:171], v3, s[20:21] offset:2048
  global_load_dwordx4 v[172:175], v3, s[20:21] offset:3072
  s_add_u32 s20, s20, 4096
  s_addc_u32 s21, s21, 0
  global_load_dwordx4 v[176:179], v3, s[20:21] offset:0
  global_load_dwordx4 v[180:183], v3, s[20:21] offset:1024
  global_load_dwordx4 v[184:187], v3, s[20:21] offset:2048
  global_load_dwordx4 v[188:191], v3, s[20:21] offset:3072
  s_add_u32 s20, s20, 4096
  s_addc_u32 s21, s21, 0
  global_load_dwordx4 v[192:195], v3, s[20:21] offset:0
  global_load_dwordx4 v[196:199], v3, s[20:21] offset:1024
  s_waitcnt vmcnt(28)
  s_add_u32 s20, s8, 8329216
  s_addc_u32 s21, s9, 0
  global_load_dwordx4 v[200:203], v3, s[20:21] offset:0
  global_load_dwordx4 v[204:207], v3, s[20:21] offset:1024
  global_load_dwordx4 v[208:211], v3, s[20:21] offset:2048
  global_load_dwordx4 v[212:215], v3, s[20:21] offset:3072
  s_add_u32 s20, s20, 4096
  s_addc_u32 s21, s21, 0
  global_load_dwordx4 v[216:219], v3, s[20:21] offset:0
  global_load_dwordx4 v[220:223], v3, s[20:21] offset:1024
  global_load_dwordx4 v[224:227], v3, s[20:21] offset:2048
  global_load_dwordx4 v[228:231], v3, s[20:21] offset:3072
  s_add_u32 s20, s20, 4096
  s_addc_u32 s21, s21, 0
  global_load_dwordx4 v[232:235], v3, s[20:21] offset:0
  global_load_dwordx4 v[236:239], v3, s[20:21] offset:1024
  global_load_dwordx4 v[240:243], v3, s[20:21] offset:2048
  global_load_dwordx4 v[244:247], v3, s[20:21] offset:3072
  s_add_u32 s20, s20, 4096
  s_addc_u32 s21, s21, 0
  global_load_dwordx4 v[248:251], v3, s[20:21] offset:0
  global_load_dwordx4 v[252:255], v3, s[20:21] offset:1024
  s_waitcnt vmcnt(28)
  v_lshrrev_b32 v0, 4, v2
  v_and_b32 v74, 7, v2
  s_lshl_b32 s19, s10, 10
  v_add_u32 v108, s19, v110
  s_add_u32 s19, s10, 4
  s_min_u32 s19, s19, 6
  s_lshl_b32 s19, s19, 10
  v_add_u32 v109, s19, v110
  s_lshl_b32 s19, s10, 11
  v_add_u32 v112, s19, v110
  s_lshl_b32 s19, s10, 9
  s_add_u32 s19, s19, 8192
  v_and_b32 v96, 511, v110
  v_add_u32 v113, s19, v96
  s_lshl_b32 s19, s14, 15
  s_lshl_b32 s20, s10, 13
  s_add_u32 s19, s19, s20
  s_add_u32 s19, s19, 4096
  v_add_u32 v114, s19, v110
  s_lshl_b32 s19, s14, 14
  s_lshl_b32 s20, s10, 12
  s_add_u32 s19, s19, s20
  v_add_u32 v115, s19, v110
  s_lshl_b32 s19, s10, 11
  s_add_u32 s19, s19, 8192
  v_add_u32 v116, s19, v110
  v_lshrrev_b32 v96, 5, v2
  v_bfe_u32 v97, v2, 3, 2
  v_lshlrev_b32 v98, 4, v74
  v_lshl_add_u32 v99, v96, 10, v98
  v_lshl_add_u32 v99, v97, 8, v99
  v_add_u32 v117, 8192, v99
  s_lshl_b32 s19, s14, 9
  s_add_u32 s19, s19, 7168
  v_lshl_add_u32 v99, v96, 8, v98
  v_lshrrev_b32 v96, 1, v97
  v_lshl_add_u32 v99, v96, 7, v99
  v_and_b32 v96, 1, v97
  v_lshl_add_u32 v99, v96, 3, v99
  v_add_u32 v118, s19, v99
  v_and_b32 v96, 8, v2
  v_mov_b32 v119, 0x4444
  v_mov_b32 v97, 0xeeee
  v_cmp_ne_u32 vcc, 0, v96
  s_nop 1
  v_cndmask_b32 v119, v119, v97, vcc
  s_lshl_b32 s19, s10, 9
  s_add_u32 s19, s19, 8192
  v_and_b32 v96, 255, v110
  v_lshrrev_b32 v97, 5, v2
  v_lshl_add_u32 v96, v97, 8, v96
  v_add_u32 v113, s19, v96
  s_lshl_b32 s19, s10, 11
  s_add_u32 s19, s19, 8192
  v_bfe_u32 v96, v2, 4, 1
  v_mul_u32_u24 v96, 576, v96
  v_lshl_add_u32 v96, v97, 6, v96
  v_and_b32 v98, 15, v2
  v_lshl_add_u32 v96, v98, 2, v96
  v_add_u32 v116, s19, v96
  v_mul_u32_u24 v96, 144, v74
  v_lshl_add_u32 v96, v97, 6, v96
  v_bfe_u32 v98, v2, 3, 2
  v_lshl_add_u32 v96, v98, 4, v96
  v_add_u32 v117, 8192, v96
  s_lshl_b32 s19, s10, 11
  s_add_u32 s19, s19, 8192
  v_lshrrev_b32 v96, 4, v2
  v_mul_u32_u24 v96, 288, v96
  v_and_b32 v98, 15, v2
  v_lshl_add_u32 v96, v98, 2, v96
  v_add_u32 v116, s19, v96
  s_add_u32 s22, s8, 101007360
  s_addc_u32 s23, s9, 0
  s_add_u32 s24, s8, 45875200
  s_addc_u32 s25, s9, 0
  s_add_u32 s26, s8, 86319104
  s_addc_u32 s27, s9, 0
  s_add_u32 s28, s8, 85663744
  s_addc_u32 s29, s9, 0
  s_waitcnt lgkmcnt(0)
  s_mov_b32 s18, 1048576
  s_mov_b32 s30, 0
  s_mov_b32 s34, 0
  s_lshl_b32 s35, s10, 4
  s_add_u32 s35, s35, s14
  s_lshl_b32 s35, s35, 2
  s_add_u32 s35, s35, 103350016
  s_waitcnt vmcnt(0)
  v_mov_b32 v32, -1
  s_nop 1
BLOOP_115:
  v_max3_u32 v3, v32, v33, v34
  v_max3_u32 v4, v35, v36, v37
  v_max3_u32 v3, v3, v38, v39
  v_max_u32 v3, v3, v4
  v_cmp_eq_u32 vcc, -1, v3
  s_nop 4
  s_cbranch_vccz PMD_120
  global_load_dwordx4 v[32:35], v108, s[22:23] sc0 sc1
  global_load_dwordx4 v[36:39], v109, s[22:23] sc0 sc1
  s_waitcnt vmcnt(0)
  s_lshl_b32 s19, s30, 8
  s_add_u32 s19, s19, s35
  v_mov_b32 v0, s19
  v_mov_b32 v1, 1
  global_store_dword v0, v1, s[8:9] sc0 sc1
  s_nop 1
  s_branch PMC_121
PM_119:
  s_sleep 4
  global_load_dwordx4 v[32:35], v108, s[22:23] sc0 sc1
  global_load_dwordx4 v[36:39], v109, s[22:23] sc0 sc1
  s_waitcnt vmcnt(0)
  s_nop 1
PMC_121:
  v_max3_u32 v3, v32, v33, v34
  v_max3_u32 v4, v35, v36, v37
  v_max3_u32 v3, v3, v38, v39
  v_max_u32 v3, v3, v4
  v_cmp_eq_u32 vcc, -1, v3
  s_nop 4
  s_cbranch_vccz PMD_120
  s_sub_u32 s18, s18, 1
  s_nop 1
  s_cbranch_scc0 PM_119
  s_branch CEXIT_1
PMD_120:
  ds_write_b128 v108, v[32:35]
  ds_write_b128 v109, v[36:39]
  s_waitcnt lgkmcnt(0)
  s_barrier
  s_add_u32 s22, s22, 7168
  s_addc_u32 s23, s23, 0
  global_load_dwordx4 v[32:35], v108, s[22:23] sc0 sc1
  global_load_dwordx4 v[36:39], v109, s[22:23] sc0 sc1
  ds_read_b128 v[4:7], v110 offset:0
  ds_read_b128 v[8:11], v110 offset:1024
  ds_read_b128 v[12:15], v110 offset:2048
  ds_read_b128 v[16:19], v110 offset:3072
  ds_read_b128 v[20:23], v110 offset:4096
  ds_read_b128 v[24:27], v110 offset:5120
  ds_read_b128 v[28:31], v110 offset:6144
  ds_read_b128 v[88:91], v111 offset:0
  ds_read_b128 v[92:95], v111 offset:1024
  ds_read_b128 v[96:99], v111 offset:2048
  ds_read_b128 v[100:103], v111 offset:3072
  v_mov_b64 v[80:81], 0
  v_mov_b64 v[82:83], 0
  v_mov_b64 v[84:85], 0
  v_mov_b64 v[86:87], 0
  v_mov_b64 v[104:105], 0
  v_mov_b64 v[106:107], 0
  s_waitcnt lgkmcnt(10)
  v_smfmac_f32_16x16x64_bf16 v[80:83], v[4:7], a[0:7], v119
  s_waitcnt lgkmcnt(9)
  v_smfmac_f32_16x16x64_bf16 v[80:83], v[8:11], a[8:15], v119
  s_waitcnt lgkmcnt(8)
  v_smfmac_f32_16x16x64_bf16 v[80:83], v[12:15], a[16:23], v119
  s_waitcnt lgkmcnt(7)
  v_smfmac_f32_16x16x64_bf16 v[80:83], v[16:19], a[24:31], v119
  s_waitcnt lgkmcnt(6)
  v_smfmac_f32_16x16x64_bf16 v[80:83], v[20:23], a[32:39], v119
  s_waitcnt lgkmcnt(5)
  v_smfmac_f32_16x16x64_bf16 v[80:83], v[24:27], a[40:47], v119
  s_waitcnt lgkmcnt(4)
  v_smfmac_f32_16x16x64_bf16 v[80:83], v[28:31], a[48:55], v119
  s_waitcnt lgkmcnt(2)
  v_smfmac_f32_16x16x64_bf16 v[104:107], v[4:7], v[88:95], v119
  ds_read_b128 v[88:91], v111 offset:4096
  ds_read_b128 v[92:95], v111 offset:5120
  v_smfmac_f32_16x16x64_bf16 v[84:87], v[4:7], a[56:63], v119
  v_smfmac_f32_16x16x64_bf16 v[84:87], v[8:11], a[64:71], v119
  v_smfmac_f32_16x16x64_bf16 v[84:87], v[12:15], a[72:79], v119
  s_nop 0
  v_cvt_pk_bf16_f32 v64, v80, v81
  v_cvt_pk_bf16_f32 v65, v82, v83
  v_smfmac_f32_16x16x64_bf16 v[84:87], v[16:19], a[80:87], v119
  v_mov_b64 v[80:81], 0
  v_mov_b64 v[82:83], 0
  v_smfmac_f32_16x16x64_bf16 v[84:87], v[20:23], a[88:95], v119
  v_smfmac_f32_16x16x64_bf16 v[84:87], v[24:27], a[96:103], v119
  v_smfmac_f32_16x16x64_bf16 v[84:87], v[28:31], a[104:111], v119
  s_waitcnt lgkmcnt(2)
  v_smfmac_f32_16x16x64_bf16 v[104:107], v[8:11], v[96:103], v119
  ds_read_b128 v[96:99], v111 offset:6144
  ds_read_b128 v[100:103], v111 offset:7168
  v_smfmac_f32_16x16x64_bf16 v[80:83], v[4:7], a[112:119], v119
  v_smfmac_f32_16x16x64_bf16 v[80:83], v[8:11], a[120:127], v119
  v_smfmac_f32_16x16x64_bf16 v[80:83], v[12:15], a[128:135], v119
  s_nop 0
  v_cvt_pk_bf16_f32 v66, v84, v85
  v_cvt_pk_bf16_f32 v67, v86, v87
  v_smfmac_f32_16x16x64_bf16 v[80:83], v[16:19], a[136:143], v119
  v_mov_b64 v[84:85], 0
  v_mov_b64 v[86:87], 0
  v_smfmac_f32_16x16x64_bf16 v[80:83], v[20:23], a[144:151], v119
  v_smfmac_f32_16x16x64_bf16 v[80:83], v[24:27], a[152:159], v119
  v_smfmac_f32_16x16x64_bf16 v[80:83], v[28:31], a[160:167], v119
  s_waitcnt lgkmcnt(2)
  v_smfmac_f32_16x16x64_bf16 v[104:107], v[12:15], v[88:95], v119
  ds_read_b128 v[88:91], v111 offset:8192
  ds_read_b128 v[92:95], v111 offset:9216
  v_smfmac_f32_16x16x64_bf16 v[84:87], v[4:7], a[168:175], v119
  v_smfmac_f32_16x16x64_bf16 v[84:87], v[8:11], a[176:183], v119
  v_smfmac_f32_16x16x64_bf16 v[84:87], v[12:15], a[184:191], v119
  s_nop 0
  v_cvt_pk_bf16_f32 v72, v80, v81
  v_cvt_pk_bf16_f32 v73, v82, v83
  v_smfmac_f32_16x16x64_bf16 v[84:87], v[16:19], a[192:199], v119
  v_mov_b64 v[80:81], 0
  v_mov_b64 v[82:83], 0
  v_smfmac_f32_16x16x64_bf16 v[84:87], v[20:23], a[200:207], v119
  v_smfmac_f32_16x16x64_bf16 v[84:87], v[24:27], a[208:215], v119
  v_smfmac_f32_16x16x64_bf16 v[84:87], v[28:31], a[216:223], v119
  s_waitcnt lgkmcnt(2)
  v_smfmac_f32_16x16x64_bf16 v[104:107], v[16:19], v[96:103], v119
  ds_read_b128 v[96:99], v111 offset:10240
  ds_read_b128 v[100:103], v111 offset:11264
  v_smfmac_f32_16x16x64_bf16 v[80:83], v[4:7], a[224:231], v119
  v_smfmac_f32_16x16x64_bf16 v[80:83], v[8:11], a[232:239], v119
  v_smfmac_f32_16x16x64_bf16 v[80:83], v[12:15], a[240:247], v119
  s_nop 0
  v_cvt_pk_bf16_f32 v74, v84, v85
  v_cvt_pk_bf16_f32 v75, v86, v87
  v_smfmac_f32_16x16x64_bf16 v[80:83], v[16:19], a[248:255], v119
  v_mov_b64 v[84:85], 0
  v_mov_b64 v[86:87], 0
  v_smfmac_f32_16x16x64_bf16 v[80:83], v[20:23], v[120:127], v119
  v_smfmac_f32_16x16x64_bf16 v[80:83], v[24:27], v[128:135], v119
  v_smfmac_f32_16x16x64_bf16 v[80:83], v[28:31], v[136:143], v119
  s_waitcnt lgkmcnt(2)
  v_smfmac_f32_16x16x64_bf16 v[104:107], v[20:23], v[88:95], v119
  ds_read_b128 v[88:91], v111 offset:12288
  ds_read_b128 v[92:95], v111 offset:13312
  v_smfmac_f32_16x16x64_bf16 v[84:87], v[4:7], v[144:151], v119
  v_smfmac_f32_16x16x64_bf16 v[84:87], v[8:11], v[152:159], v119
  v_smfmac_f32_16x16x64_bf16 v[84:87], v[12:15], v[160:167], v119
  s_nop 0
  v_cvt_pk_bf16_f32 v68, v80, v81
  v_cvt_pk_bf16_f32 v69, v82, v83
  v_smfmac_f32_16x16x64_bf16 v[84:87], v[16:19], v[168:175], v119
  v_mov_b64 v[80:81], 0
  v_mov_b64 v[82:83], 0
  v_smfmac_f32_16x16x64_bf16 v[84:87], v[20:23], v[176:183], v119
  v_smfmac_f32_16x16x64_bf16 v[84:87], v[24:27], v[184:191], v119
  v_smfmac_f32_16x16x64_bf16 v[84:87], v[28:31], v[192:199], v119
  s_waitcnt lgkmcnt(2)
  v_smfmac_f32_16x16x64_bf16 v[104:107], v[24:27], v[96:103], v119
  v_smfmac_f32_16x16x64_bf16 v[80:83], v[4:7], v[200:207], v119
  v_smfmac_f32_16x16x64_bf16 v[80:83], v[8:11], v[208:215], v119
  v_smfmac_f32_16x16x64_bf16 v[80:83], v[12:15], v[216:223], v119
  s_nop 2
  v_cvt_pk_bf16_f32 v70, v84, v85
  v_cvt_pk_bf16_f32 v71, v86, v87
  v_smfmac_f32_16x16x64_bf16 v[80:83], v[16:19], v[224:231], v119
  v_smfmac_f32_16x16x64_bf16 v[80:83], v[20:23], v[232:239], v119
  v_smfmac_f32_16x16x64_bf16 v[80:83], v[24:27], v[240:247], v119
  v_smfmac_f32_16x16x64_bf16 v[80:83], v[28:31], v[248:255], v119
  s_waitcnt lgkmcnt(0)
  v_smfmac_f32_16x16x64_bf16 v[104:107], v[28:31], v[88:95], v119
  s_nop 5
  v_cvt_pk_bf16_f32 v76, v80, v81
  v_cvt_pk_bf16_f32 v77, v82, v83
  v_cvt_pk_bf16_f32 v78, v104, v105
  v_cvt_pk_bf16_f32 v79, v106, v107
  s_waitcnt vmcnt(0)
  s_lshl_b32 s19, s30, 8
  s_add_u32 s19, s19, s35
  v_mov_b32 v0, s19
  v_mov_b32 v1, 1
  global_store_dword v0, v1, s[8:9] sc0 sc1
  global_store_dwordx4 v115, v[64:67], s[26:27] offset:0 sc0 sc1
  global_store_dwordx4 v115, v[72:75], s[26:27] offset:1024 sc0 sc1
  global_store_dwordx4 v115, v[68:71], s[26:27] offset:2048 sc0 sc1
  global_store_dwordx4 v115, v[76:79], s[26:27] offset:3072 sc0 sc1
  s_add_u32 s26, s26, 229376
  s_addc_u32 s27, s27, 0
  s_barrier
  s_add_u32 s30, s30, 1
  s_cmp_lt_u32 s30, 63
  s_nop 1
  s_cbranch_scc1 BLOOP_115
  s_waitcnt vmcnt(0)
  s_lshl_b32 s19, s30, 8
  s_add_u32 s19, s19, s35
  v_mov_b32 v0, s19
  v_mov_b32 v1, 1
  global_store_dword v0, v1, s[8:9] sc0 sc1
  s_nop 1
  s_branch WLOOP_71
CEXIT_1:
  s_endpgm
.section .rodata,"a"
.p2align 6
.amdhsa_kernel main_kernel
  .amdhsa_next_free_vgpr 512
  .amdhsa_next_free_sgpr 102
  .amdhsa_accum_offset 256
  .amdhsa_group_segment_fixed_size 0
  .amdhsa_kernarg_size 112
  .amdhsa_user_sgpr_count 2
  .amdhsa_user_sgpr_kernarg_segment_ptr 1
  .amdhsa_system_sgpr_workgroup_id_x 1
.end_amdhsa_kernel
```
